```python
import torch

def _softmax(x, axis=-1):
    return torch.softmax(x, dim=axis)
def _gelu(x):
    return torch.nn.functional.gelu(x, approximate="tanh")
def _silu(x):
    return torch.nn.functional.silu(x)
def _sigmoid(x):
    return torch.sigmoid(x)
def _layernorm(x, axis=-1, eps=1e-5):
    m = x.mean(dim=axis, keepdim=True)
    v = x.var(dim=axis, keepdim=True, unbiased=False)
    return (x - m) / torch.sqrt(v + eps)
def _scatter_add(tgt, idx, src, axis=0):
    return tgt.clone().index_add_(axis, idx, src)
def _segment_sum(src, seg, n):
    out = torch.zeros((n,) + src.shape[1:], dtype=src.dtype)
    return out.index_add_(0, seg, src)
def _pad(x, pw):
    flat = tuple(v for pair in reversed(pw) for v in pair)
    return torch.nn.functional.pad(x, flat)

kernel_name = 'concat_heads__gqa_block_cached__gqa_block_cached__near_ridge'

def setup_inputs():

    _w = (lambda a: (lambda t: t.to(torch.bfloat16) if t.is_floating_point() else t)(torch.as_tensor(a)))
    def _A_setup():
        B, Sq, D = 16, 96, 512
        Hq, Hkv, Sk, Dh = 32, 32, 96, 128
        assert Hq % Hkv == 0, (Hq, Hkv)
        return {
            "x": _w((lambda *s: torch.randn(*s, dtype=torch.bfloat16) * 0.8)(B, Sq, D)),
            "k_cache": _w((lambda *s: torch.randn(*s, dtype=torch.bfloat16) * 0.8)(B, Hkv, Sk, Dh)),
            "v_cache": _w((lambda *s: torch.randn(*s, dtype=torch.bfloat16) * 0.05)(B, Hkv, Sk, Dh)),
            "wq": _w((lambda *s: torch.randn(*s, dtype=torch.bfloat16) * 0.8)(D, Hq * Dh) * (D ** -0.5)),
            "wo": _w((lambda *s: torch.randn(*s, dtype=torch.bfloat16) * 0.05)(Hq * Dh, D) * ((Hq * Dh) ** -0.5)),
        }
    _A_in = _A_setup()

    def _B_setup():
        B, Sq, D = 16, 96, 512
        Hq, Hkv, Sk, Dh = 32, 32, 96, 128
        assert Hq % Hkv == 0, (Hq, Hkv)
        return {
            "x": _w((lambda *s: torch.randn(*s, dtype=torch.bfloat16) * 0.8)(B, Sq, D)),
            "k_cache": _w((lambda *s: torch.randn(*s, dtype=torch.bfloat16) * 0.8)(B, Hkv, Sk, Dh)),
            "v_cache": _w((lambda *s: torch.randn(*s, dtype=torch.bfloat16) * 0.05)(B, Hkv, Sk, Dh)),
            "wq": _w((lambda *s: torch.randn(*s, dtype=torch.bfloat16) * 0.8)(D, Hq * Dh) * (D ** -0.5)),
            "wo": _w((lambda *s: torch.randn(*s, dtype=torch.bfloat16) * 0.05)(Hq * Dh, D) * ((Hq * Dh) ** -0.5)),
        }
    _B_in = _B_setup()

    return {
        "A_x": _A_in["x"],
        "A_k_cache": _A_in["k_cache"],
        "A_v_cache": _A_in["v_cache"],
        "A_wq": _A_in["wq"],
        "A_wo": _A_in["wo"],
        "B_x": _B_in["x"],
        "B_k_cache": _B_in["k_cache"],
        "B_v_cache": _B_in["v_cache"],
        "B_wq": _B_in["wq"],
        "B_wo": _B_in["wo"],
    }

def reference(A_x, A_k_cache, A_v_cache, A_wq, A_wo, B_x, B_k_cache, B_v_cache, B_wq, B_wo):
    def _A_ref(x, k_cache, v_cache, wq, wo):
        B, Sq, D = x.shape
        Hq, Dh = 32, 128
        Hkv = k_cache.shape[1]
        rep = Hq // Hkv
        q = (lambda x, *d: x.permute(*d))((x @ wq).reshape(B, Sq, Hq, Dh), 0, 2, 1, 3)
        k = (lambda x, n, axis: torch.repeat_interleave(x, n, dim=axis))(k_cache, rep, axis=1)
        v = (lambda x, n, axis: torch.repeat_interleave(x, n, dim=axis))(v_cache, rep, axis=1)
        scores = torch.einsum("bhqd,bhkd->bhqk", q, k) * (Dh ** -0.5)
        p = _softmax(scores, axis=-1)
        o = torch.einsum("bhqk,bhkd->bhqd", p, v)
        return (lambda x, *d: x.permute(*d))(o, 0, 2, 1, 3).reshape(B, Sq, Hq * Dh) @ wo

    def _B_ref(x, k_cache, v_cache, wq, wo):
        B, Sq, D = x.shape
        Hq, Dh = 32, 128
        Hkv = k_cache.shape[1]
        rep = Hq // Hkv
        q = (lambda x, *d: x.permute(*d))((x @ wq).reshape(B, Sq, Hq, Dh), 0, 2, 1, 3)
        k = (lambda x, n, axis: torch.repeat_interleave(x, n, dim=axis))(k_cache, rep, axis=1)
        v = (lambda x, n, axis: torch.repeat_interleave(x, n, dim=axis))(v_cache, rep, axis=1)
        scores = torch.einsum("bhqd,bhkd->bhqk", q, k) * (Dh ** -0.5)
        p = _softmax(scores, axis=-1)
        o = torch.einsum("bhqk,bhkd->bhqd", p, v)
        return (lambda x, *d: x.permute(*d))(o, 0, 2, 1, 3).reshape(B, Sq, Hq * Dh) @ wo

    a = _A_ref(A_x, A_k_cache, A_v_cache, A_wq, A_wo)
    b = _B_ref(B_x, B_k_cache, B_v_cache, B_wq, B_wo)
    return torch.concatenate([a, b], axis=-1)
```

```asm
; @launch grid=(256,1,1) block=(256,1,1) lds=163840
.amdgcn_target "amdgcn-amd-amdhsa--gfx950"
.text
.globl concat_heads__gqa_block_cached__gqa_block_cached__near_ridge_kernel
.p2align 8
.type concat_heads__gqa_block_cached__gqa_block_cached__near_ridge_kernel,@function
concat_heads__gqa_block_cached__gqa_block_cached__near_ridge_kernel:
L_k1_start:
    s_cmp_ge_u32 s2, 256
    s_cbranch_scc1 L_k1_end
    s_and_b32 s46, s2, 3
    s_lshr_b32 s3, s2, 7
    s_lshl_b32 s46, s46, 1
    s_add_u32 s46, s46, s3
    s_bfe_u32 s48, s2, 0x40003
    s_bfe_u32 s49, s2, 0x10002
    s_lshl_b32 s47, s49, 4
    s_add_u32 s47, s47, s48
    s_mul_i32 s3, s49, 40
    s_add_u32 s4, s0, s3
    s_addc_u32 s5, s1, 0
    s_load_dwordx8 s[8:15], s[4:5], 0
    s_load_dwordx2 s[18:19], s[4:5], 32
    s_load_dwordx2 s[16:17], s[0:1], 96
    s_load_dwordx4 s[76:79], s[0:1], 80
    s_memrealtime s[6:7]
    v_lshrrev_b32 v254, 6, v0
    v_and_b32 v255, 63, v0
    v_readfirstlane_b32 s44, v254
    s_lshl_b32 s45, s46, 2
    s_nop 0
    s_add_u32 s45, s45, s44
    s_mov_b32 s51, 8192
    s_mov_b32 s52, 16384
    s_mov_b32 s53, 24576
    s_mov_b32 s54, 32768
    s_mov_b32 s55, 40960
    s_mov_b32 s56, 49152
    s_mov_b32 s57, 57344
    s_mov_b32 s59, 4096
    s_mov_b32 s60, 8192
    s_mov_b32 s61, 12288
    s_mov_b32 s62, 16384
    s_mov_b32 s63, 20480
    s_mov_b32 s64, 0x3e0293ee
    s_mov_b32 s65, 0x05040100
    s_mov_b32 s66, 0x07060302
    s_mul_i32 s67, s44, 3072
    v_lshrrev_b32 v248, 4, v255
    v_and_b32 v249, 15, v255
    v_and_b32 v250, 3, v249
    v_lshrrev_b32 v251, 2, v249
    v_lshl_add_u32 v250, v250, 2, v251
    v_lshlrev_b32 v250, 4, v250
    v_lshl_add_u32 v227, v248, 8, v250
    v_lshlrev_b32 v250, 4, v249
    v_lshl_add_u32 v224, v248, 16, v250
    v_and_b32 v246, 7, v255
    v_lshlrev_b32 v247, 1, v248
    v_xor_b32 v246, v246, v247
    v_lshrrev_b32 v247, 3, v255
    v_lshlrev_b32 v247, 8, v247
    v_lshl_add_u32 v226, v246, 4, v247
    v_and_b32 v246, 3, v255
    v_lshlrev_b32 v227, 3, v246
    v_bfe_u32 v246, v255, 3, 2
    v_lshl_add_u32 v227, v246, 5, v227
    v_bfe_u32 v246, v255, 2, 3
    v_lshl_add_u32 v227, v246, 7, v227
    v_lshrrev_b32 v246, 5, v255
    v_lshl_add_u32 v227, v246, 11, v227
    v_lshlrev_b32 v251, 6, v248
    v_lshl_add_u32 v225, v249, 8, v251
    v_and_b32 v246, 7, v255
    v_xor_b32 v246, v246, v248
    v_lshrrev_b32 v247, 3, v255
    v_lshlrev_b32 v247, 10, v247
    s_lshl_b32 s3, s67, 3
    s_add_u32 s70, s44, 0
    s_and_b32 s70, s70, 1
    s_lshl_b32 s70, s70, 2
    v_xor_b32 v251, s70, v246
    v_lshl_add_u32 v251, v251, 4, v247
    s_add_u32 s70, s3, 0
    v_add_u32 v232, s70, v251
    s_add_u32 s70, s44, 1
    s_and_b32 s70, s70, 1
    s_lshl_b32 s70, s70, 2
    v_xor_b32 v251, s70, v246
    v_lshl_add_u32 v251, v251, 4, v247
    s_add_u32 s70, s3, 8192
    v_add_u32 v228, s70, v251
    s_add_u32 s70, s44, 2
    s_and_b32 s70, s70, 1
    s_lshl_b32 s70, s70, 2
    v_xor_b32 v251, s70, v246
    v_lshl_add_u32 v251, v251, 4, v247
    s_add_u32 s70, s3, 16384
    v_add_u32 v229, s70, v251
    s_waitcnt lgkmcnt(0)
    s_mov_b64 s[4:5], s[6:7]
    s_mov_b64 s[6:7], 0
    s_mul_i32 s3, s48, 98304
    s_add_u32 s20, s8, s3
    s_addc_u32 s21, s9, 0
    s_mov_b32 s22, 98304
    s_mov_b32 s23, 0x20000
    s_lshl_b32 s3, s45, 8
    s_add_u32 s96, s14, s3
    s_addc_u32 s97, s15, 0
    s_and_b32 s98, s48, 3
    s_lshl_b32 s98, s98, 2
    s_mov_b32 s101, s48
    s_lshr_b32 s50, s98, 1
    s_and_b32 s101, s101, 7
    s_lshl_b32 s58, s101, 1
    s_mov_b32 s26, 262144
    s_mov_b32 s27, 0x20000
    s_lshl_b32 s68, s44, 14
    s_add_u32 s68, s68, 98304
    s_lshl_b32 s69, s48, 5
    s_lshl_b32 s3, s44, 3
    s_add_u32 s69, s69, s3
    s_lshl_b32 s3, s69, 13
    s_lshl_b32 s70, s46, 10
    s_add_u32 s3, s3, s70
    s_add_u32 s72, s14, s3
    s_addc_u32 s73, s15, 0
    s_mov_b32 s74, 65536
    s_mov_b32 s75, 0x20000
    s_mov_b32 m0, s68
    v_lshlrev_b32 v254, 4, v255
    v_add_u32 v225, s68, v225
    s_getpc_b64 s[72:73]
L_pc0:
    s_sub_u32 s72, s72, L_pc0-L_k1_start
    s_subb_u32 s73, s73, 0
    s_mov_b32 s74, L_k1_code_end-L_k1_start
    s_mov_b32 m0, s68
    s_and_b32 s70, s48, 7
    s_lshl_b32 s70, s70, 2
    s_add_u32 s70, s70, s44
    s_lshl_b32 s70, s70, 11
    buffer_load_dwordx4 v254, s[72:75], s70 offen lds
    s_add_u32 s70, s70, 1024
    buffer_load_dwordx4 v254, s[72:75], s70 offen lds
    s_lshr_b32 s69, s70, 1
    s_and_b32 s69, s69, 0x7c00
    s_lshl_b32 s71, s98, 18
    s_add_u32 s24, s96, s71
    s_addc_u32 s25, s97, 0
    s_add_u32 s98, s98, 1
    s_and_b32 s98, s98, 15
    buffer_load_dwordx4 v[0:3], v224, s[24:27], 0 offen
    buffer_load_dwordx4 v[4:7], v224, s[24:27], s51 offen
    buffer_load_dwordx4 v[8:11], v224, s[24:27], s52 offen
    buffer_load_dwordx4 v[12:15], v224, s[24:27], s53 offen
    buffer_load_dwordx4 v[16:19], v224, s[24:27], s54 offen
    buffer_load_dwordx4 v[20:23], v224, s[24:27], s55 offen
    buffer_load_dwordx4 v[24:27], v224, s[24:27], s56 offen
    buffer_load_dwordx4 v[28:31], v224, s[24:27], s57 offen
    s_add_u32 s3, s50, 0
    s_and_b32 s3, s3, 7
    s_lshl_b32 s70, s3, 7
    s_mul_i32 s9, s3, 12288
    s_add_u32 s9, s9, s67
    s_add_u32 m0, s9, 0
    s_nop 0
    buffer_load_dwordx4 v232, s[20:23], s70 offen lds
    s_add_u32 m0, s9, 1024
    s_nop 0
    buffer_load_dwordx4 v228, s[20:23], s70 offen lds
    s_add_u32 m0, s9, 2048
    s_nop 0
    buffer_load_dwordx4 v229, s[20:23], s70 offen lds
    s_lshl_b32 s71, s98, 18
    s_add_u32 s24, s96, s71
    s_addc_u32 s25, s97, 0
    s_add_u32 s98, s98, 1
    s_and_b32 s98, s98, 15
    buffer_load_dwordx4 v[32:35], v224, s[24:27], 0 offen
    buffer_load_dwordx4 v[36:39], v224, s[24:27], s51 offen
    buffer_load_dwordx4 v[40:43], v224, s[24:27], s52 offen
    buffer_load_dwordx4 v[44:47], v224, s[24:27], s53 offen
    buffer_load_dwordx4 v[48:51], v224, s[24:27], s54 offen
    buffer_load_dwordx4 v[52:55], v224, s[24:27], s55 offen
    buffer_load_dwordx4 v[56:59], v224, s[24:27], s56 offen
    buffer_load_dwordx4 v[60:63], v224, s[24:27], s57 offen
    s_add_u32 s3, s50, 1
    s_and_b32 s3, s3, 7
    s_lshl_b32 s70, s3, 7
    s_mul_i32 s9, s3, 12288
    s_add_u32 s9, s9, s67
    s_add_u32 m0, s9, 0
    s_nop 0
    buffer_load_dwordx4 v232, s[20:23], s70 offen lds
    s_add_u32 m0, s9, 1024
    s_nop 0
    buffer_load_dwordx4 v228, s[20:23], s70 offen lds
    s_add_u32 m0, s9, 2048
    s_nop 0
    buffer_load_dwordx4 v229, s[20:23], s70 offen lds
    s_lshl_b32 s3, s48, 5
    s_add_u32 s3, s3, s45
    s_mul_i32 s3, s3, 24576
    s_add_u32 s28, s10, s3
    s_addc_u32 s29, s11, 0
    s_mov_b32 s30, 24576
    s_mov_b32 s31, 0x20000
    s_add_u32 s32, s12, s3
    s_addc_u32 s33, s13, 0
    s_mov_b32 s34, 24576
    s_mov_b32 s35, 0x20000
    s_lshl_b32 s3, s47, 3
    s_add_u32 s3, s3, s46
    s_mul_i32 s3, s3, 98304
    s_add_u32 s36, s16, s3
    s_addc_u32 s37, s17, 0
    s_mov_b32 s38, 98304
    s_mov_b32 s39, 0x20000
    s_lshl_b32 s3, s46, 19
    s_add_u32 s99, s18, s3
    s_addc_u32 s100, s19, 0
    s_mov_b32 s42, 65536
    s_mov_b32 s43, 0x20000
    v_and_b32 v250, 7, v249
    v_lshlrev_b32 v251, 10, v249
    v_lshrrev_b32 v250, 1, v249
    v_lshlrev_b32 v251, 7, v249
    v_add_u32 v246, 0, v248
    v_xor_b32 v246, v246, v250
    v_lshl_add_u32 v230, v246, 4, v251
    v_add_u32 v246, 4, v248
    v_xor_b32 v246, v246, v250
    v_lshl_add_u32 v231, v246, 4, v251
    s_mul_i32 s3, s44, 24576
    v_lshlrev_b32 v254, 4, v255
    v_add_u32 v253, s3, v254
    s_mov_b32 s8, s3
    s_lshl_b32 s3, s44, 8
    v_lshlrev_b32 v251, 4, v249
    v_and_b32 v251, 7, v249
    v_lshlrev_b32 v251, 4, v251
    v_lshrrev_b32 v246, 3, v249
    v_lshl_add_u32 v251, v246, 15, v251
    v_lshl_add_u32 v252, v248, 12, v251
    v_add_u32 v252, s3, v252
    s_or_b32 s3, s2, s44
    s_cbranch_scc1 L_tk0
    s_atomic_cmpswap_x2 s[4:7], s[78:79], 0
L_tk0:
    s_waitcnt vmcnt(11)
    s_barrier
    s_add_u32 s71, s50, 0
    s_and_b32 s71, s71, 7
    s_mul_i32 s71, s71, 12288
    v_add_u32 v233, s71, v230
    v_add_u32 v234, s71, v231
    ds_read_b128 v[128:131], v233 offset:0
    ds_read_b128 v[132:135], v233 offset:2048
    ds_read_b128 v[136:139], v233 offset:4096
    ds_read_b128 v[140:143], v233 offset:6144
    ds_read_b128 v[144:147], v233 offset:8192
    ds_read_b128 v[148:151], v233 offset:10240
    v_perm_b32 v176, v4, v0, s65
    v_perm_b32 v177, v12, v8, s65
    v_perm_b32 v178, v20, v16, s65
    v_perm_b32 v179, v28, v24, s65
    v_perm_b32 v180, v4, v0, s66
    v_perm_b32 v181, v12, v8, s66
    v_perm_b32 v182, v20, v16, s66
    v_perm_b32 v183, v28, v24, s66
    s_waitcnt lgkmcnt(5)
    v_mfma_f32_16x16x32_bf16 a[0:3], v[176:179], v[128:131], 0
    s_lshl_b32 s71, s98, 18
    v_perm_b32 v184, v5, v1, s65
    v_perm_b32 v185, v13, v9, s65
    v_perm_b32 v186, v21, v17, s65
    v_mfma_f32_16x16x32_bf16 a[4:7], v[180:183], v[128:131], 0
    s_waitcnt lgkmcnt(4)
    v_perm_b32 v187, v29, v25, s65
    v_perm_b32 v188, v5, v1, s66
    v_perm_b32 v189, v13, v9, s66
    v_mfma_f32_16x16x32_bf16 a[36:39], v[180:183], v[132:135], 0
    s_add_u32 s24, s96, s71
    v_perm_b32 v190, v21, v17, s66
    v_perm_b32 v191, v29, v25, s66
    v_mfma_f32_16x16x32_bf16 a[32:35], v[176:179], v[132:135], 0
    s_waitcnt lgkmcnt(3)
    s_addc_u32 s25, s97, 0
    s_add_u32 s98, s98, 1
    v_mfma_f32_16x16x32_bf16 a[64:67], v[176:179], v[136:139], 0
    buffer_load_dwordx4 v[64:67], v224, s[24:27], 0 offen
    v_mfma_f32_16x16x32_bf16 a[68:71], v[180:183], v[136:139], 0
    s_waitcnt lgkmcnt(2)
    buffer_load_dwordx4 v[68:71], v224, s[24:27], s51 offen
    v_mfma_f32_16x16x32_bf16 a[100:103], v[180:183], v[140:143], 0
    buffer_load_dwordx4 v[72:75], v224, s[24:27], s52 offen
    v_mfma_f32_16x16x32_bf16 a[96:99], v[176:179], v[140:143], 0
    s_waitcnt lgkmcnt(1)
    buffer_load_dwordx4 v[76:79], v224, s[24:27], s53 offen
    v_mfma_f32_16x16x32_bf16 a[128:131], v[176:179], v[144:147], 0
    buffer_load_dwordx4 v[80:83], v224, s[24:27], s54 offen
    v_mfma_f32_16x16x32_bf16 a[132:135], v[180:183], v[144:147], 0
    s_waitcnt lgkmcnt(0)
    buffer_load_dwordx4 v[84:87], v224, s[24:27], s55 offen
    v_mfma_f32_16x16x32_bf16 a[164:167], v[180:183], v[148:151], 0
    buffer_load_dwordx4 v[88:91], v224, s[24:27], s56 offen
    v_mfma_f32_16x16x32_bf16 a[160:163], v[176:179], v[148:151], 0
    buffer_load_dwordx4 v[92:95], v224, s[24:27], s57 offen
    v_mfma_f32_16x16x32_bf16 a[168:171], v[184:187], v[148:151], 0
    s_and_b32 s98, s98, 15
    ds_read_b128 v[152:155], v234 offset:0
    v_perm_b32 v176, v6, v2, s65
    v_mfma_f32_16x16x32_bf16 a[172:175], v[188:191], v[148:151], 0
    s_lshl_b32 s71, s98, 18
    ds_read_b128 v[156:159], v234 offset:2048
    v_perm_b32 v177, v14, v10, s65
    v_mfma_f32_16x16x32_bf16 a[140:143], v[188:191], v[144:147], 0
    s_add_u32 s24, s96, s71
    ds_read_b128 v[160:163], v234 offset:4096
    v_perm_b32 v178, v22, v18, s65
    v_mfma_f32_16x16x32_bf16 a[136:139], v[184:187], v[144:147], 0
    s_addc_u32 s25, s97, 0
    ds_read_b128 v[164:167], v234 offset:6144
    v_perm_b32 v179, v30, v26, s65
    v_mfma_f32_16x16x32_bf16 a[104:107], v[184:187], v[140:143], 0
    s_add_u32 s98, s98, 1
    ds_read_b128 v[168:171], v234 offset:8192
    v_perm_b32 v180, v6, v2, s66
    v_mfma_f32_16x16x32_bf16 a[108:111], v[188:191], v[140:143], 0
    s_and_b32 s98, s98, 15
    ds_read_b128 v[172:175], v234 offset:10240
    v_perm_b32 v181, v14, v10, s66
    v_mfma_f32_16x16x32_bf16 a[76:79], v[188:191], v[136:139], 0
    v_perm_b32 v182, v22, v18, s66
    v_perm_b32 v183, v30, v26, s66
    v_mfma_f32_16x16x32_bf16 a[72:75], v[184:187], v[136:139], 0
    v_mfma_f32_16x16x32_bf16 a[40:43], v[184:187], v[132:135], 0
    v_mfma_f32_16x16x32_bf16 a[44:47], v[188:191], v[132:135], 0
    v_mfma_f32_16x16x32_bf16 a[12:15], v[188:191], v[128:131], 0
    v_mfma_f32_16x16x32_bf16 a[8:11], v[184:187], v[128:131], 0
    buffer_load_dwordx4 v[96:99], v224, s[24:27], 0 offen
    v_mfma_f32_16x16x32_bf16 a[16:19], v[176:179], v[128:131], 0
    buffer_load_dwordx4 v[100:103], v224, s[24:27], s51 offen
    v_mfma_f32_16x16x32_bf16 a[20:23], v[180:183], v[128:131], 0
    buffer_load_dwordx4 v[104:107], v224, s[24:27], s52 offen
    v_mfma_f32_16x16x32_bf16 a[52:55], v[180:183], v[132:135], 0
    buffer_load_dwordx4 v[108:111], v224, s[24:27], s53 offen
    v_mfma_f32_16x16x32_bf16 a[48:51], v[176:179], v[132:135], 0
    buffer_load_dwordx4 v[112:115], v224, s[24:27], s54 offen
    v_mfma_f32_16x16x32_bf16 a[80:83], v[176:179], v[136:139], 0
    buffer_load_dwordx4 v[116:119], v224, s[24:27], s55 offen
    v_mfma_f32_16x16x32_bf16 a[84:87], v[180:183], v[136:139], 0
    buffer_load_dwordx4 v[120:123], v224, s[24:27], s56 offen
    v_mfma_f32_16x16x32_bf16 a[116:119], v[180:183], v[140:143], 0
    buffer_load_dwordx4 v[124:127], v224, s[24:27], s57 offen
    v_mfma_f32_16x16x32_bf16 a[112:115], v[176:179], v[140:143], 0
    s_lshl_b32 s71, s98, 18
    v_perm_b32 v184, v7, v3, s65
    v_perm_b32 v185, v15, v11, s65
    v_mfma_f32_16x16x32_bf16 a[144:147], v[176:179], v[144:147], 0
    s_add_u32 s24, s96, s71
    v_perm_b32 v186, v23, v19, s65
    v_perm_b32 v187, v31, v27, s65
    v_mfma_f32_16x16x32_bf16 a[148:151], v[180:183], v[144:147], 0
    s_addc_u32 s25, s97, 0
    v_perm_b32 v188, v7, v3, s66
    v_perm_b32 v189, v15, v11, s66
    v_mfma_f32_16x16x32_bf16 a[180:183], v[180:183], v[148:151], 0
    s_add_u32 s98, s98, 1
    v_perm_b32 v190, v23, v19, s66
    v_perm_b32 v191, v31, v27, s66
    v_mfma_f32_16x16x32_bf16 a[176:179], v[176:179], v[148:151], 0
    buffer_load_dwordx4 v[0:3], v224, s[24:27], 0 offen
    v_mfma_f32_16x16x32_bf16 a[184:187], v[184:187], v[148:151], 0
    s_waitcnt vmcnt(24)
    v_perm_b32 v176, v36, v32, s65
    v_perm_b32 v177, v44, v40, s65
    v_mfma_f32_16x16x32_bf16 a[188:191], v[188:191], v[148:151], 0
    buffer_load_dwordx4 v[4:7], v224, s[24:27], s51 offen
    v_mfma_f32_16x16x32_bf16 a[156:159], v[188:191], v[144:147], 0
    s_waitcnt vmcnt(21)
    v_perm_b32 v178, v52, v48, s65
    v_perm_b32 v179, v60, v56, s65
    v_mfma_f32_16x16x32_bf16 a[152:155], v[184:187], v[144:147], 0
    s_and_b32 s98, s98, 15
    v_perm_b32 v180, v36, v32, s66
    v_mfma_f32_16x16x32_bf16 a[120:123], v[184:187], v[140:143], 0
    buffer_load_dwordx4 v[8:11], v224, s[24:27], s52 offen
    v_mfma_f32_16x16x32_bf16 a[124:127], v[188:191], v[140:143], 0
    v_perm_b32 v181, v44, v40, s66
    v_perm_b32 v182, v52, v48, s66
    v_mfma_f32_16x16x32_bf16 a[92:95], v[188:191], v[136:139], 0
    buffer_load_dwordx4 v[12:15], v224, s[24:27], s53 offen
    v_mfma_f32_16x16x32_bf16 a[88:91], v[184:187], v[136:139], 0
    v_perm_b32 v183, v60, v56, s66
    v_mfma_f32_16x16x32_bf16 a[56:59], v[184:187], v[132:135], 0
    s_add_u32 s71, s50, 1
    s_and_b32 s71, s71, 7
    s_mul_i32 s71, s71, 12288
    v_mfma_f32_16x16x32_bf16 a[60:63], v[188:191], v[132:135], 0
    buffer_load_dwordx4 v[16:19], v224, s[24:27], s54 offen
    v_mfma_f32_16x16x32_bf16 a[28:31], v[188:191], v[128:131], 0
    s_add_u32 m0, s68, 0
    v_mfma_f32_16x16x32_bf16 a[24:27], v[184:187], v[128:131], 0
    s_waitcnt lgkmcnt(5)
    buffer_load_dwordx4 v[20:23], v224, s[24:27], s55 offen
    v_mfma_f32_16x16x32_bf16 a[0:3], v[176:179], v[152:155], a[0:3]
    v_perm_b32 v184, v37, v33, s65
    v_perm_b32 v185, v45, v41, s65
    v_perm_b32 v186, v53, v49, s65
    v_mfma_f32_16x16x32_bf16 a[4:7], v[180:183], v[152:155], a[4:7]
    s_waitcnt lgkmcnt(4)
    buffer_load_dwordx4 v[24:27], v224, s[24:27], s56 offen
    v_mfma_f32_16x16x32_bf16 a[36:39], v[180:183], v[156:159], a[36:39]
    v_perm_b32 v187, v61, v57, s65
    v_perm_b32 v188, v37, v33, s66
    v_mfma_f32_16x16x32_bf16 a[32:35], v[176:179], v[156:159], a[32:35]
    s_waitcnt lgkmcnt(3)
    v_perm_b32 v189, v45, v41, s66
    v_perm_b32 v190, v53, v49, s66
    v_mfma_f32_16x16x32_bf16 a[64:67], v[176:179], v[160:163], a[64:67]
    buffer_load_dwordx4 v[28:31], v224, s[24:27], s57 offen
    v_mfma_f32_16x16x32_bf16 a[68:71], v[180:183], v[160:163], a[68:71]
    s_waitcnt lgkmcnt(2)
    v_perm_b32 v191, v61, v57, s66
    v_add_u32 v233, s71, v230
    v_mfma_f32_16x16x32_bf16 a[100:103], v[180:183], v[164:167], a[100:103]
    s_waitcnt vmcnt(24)
    s_barrier
    v_add_u32 v234, s71, v231
    v_mfma_f32_16x16x32_bf16 a[96:99], v[176:179], v[164:167], a[96:99]
    s_waitcnt lgkmcnt(1)
    buffer_load_dwordx4 v254, s[28:31], 0 offen offset:0 lds
    v_mfma_f32_16x16x32_bf16 a[128:131], v[176:179], v[168:171], a[128:131]
    s_add_u32 m0, s68, 0
    ds_read_b128 v[128:131], v233 offset:0
    ds_read_b128 v[132:135], v233 offset:2048
    v_mfma_f32_16x16x32_bf16 a[132:135], v[180:183], v[168:171], a[132:135]
    s_waitcnt lgkmcnt(2)
    ds_read_b128 v[136:139], v233 offset:4096
    v_mfma_f32_16x16x32_bf16 a[164:167], v[180:183], v[172:175], a[164:167]
    buffer_load_dwordx4 v254, s[28:31], 0 offen offset:1024 lds
    v_mfma_f32_16x16x32_bf16 a[160:163], v[176:179], v[172:175], a[160:163]
    s_add_u32 s3, s50, 2
    ds_read_b128 v[140:143], v233 offset:6144
    v_perm_b32 v176, v38, v34, s65
    v_mfma_f32_16x16x32_bf16 a[168:171], v[184:187], v[172:175], a[168:171]
    s_and_b32 s3, s3, 7
    ds_read_b128 v[144:147], v233 offset:8192
    v_perm_b32 v177, v46, v42, s65
    v_mfma_f32_16x16x32_bf16 a[172:175], v[188:191], v[172:175], a[172:175]
    s_lshl_b32 s70, s3, 7
    ds_read_b128 v[148:151], v233 offset:10240
    v_perm_b32 v178, v54, v50, s65
    v_mfma_f32_16x16x32_bf16 a[140:143], v[188:191], v[168:171], a[140:143]
    s_mul_i32 s9, s3, 12288
    s_add_u32 s9, s9, s67
    v_perm_b32 v179, v62, v58, s65
    v_mfma_f32_16x16x32_bf16 a[136:139], v[184:187], v[168:171], a[136:139]
    s_add_u32 m0, s9, 0
    v_perm_b32 v180, v38, v34, s66
    v_mfma_f32_16x16x32_bf16 a[104:107], v[184:187], v[164:167], a[104:107]
    buffer_load_dwordx4 v232, s[20:23], s70 offen lds
    v_mfma_f32_16x16x32_bf16 a[108:111], v[188:191], v[164:167], a[108:111]
    s_add_u32 m0, s9, 1024
    v_perm_b32 v181, v46, v42, s66
    v_perm_b32 v182, v54, v50, s66
    v_mfma_f32_16x16x32_bf16 a[76:79], v[188:191], v[160:163], a[76:79]
    buffer_load_dwordx4 v228, s[20:23], s70 offen lds
    v_mfma_f32_16x16x32_bf16 a[72:75], v[184:187], v[160:163], a[72:75]
    s_add_u32 m0, s9, 2048
    v_perm_b32 v183, v62, v58, s66
    v_mfma_f32_16x16x32_bf16 a[40:43], v[184:187], v[156:159], a[40:43]
    buffer_load_dwordx4 v229, s[20:23], s70 offen lds
    v_mfma_f32_16x16x32_bf16 a[44:47], v[188:191], v[156:159], a[44:47]
    v_mfma_f32_16x16x32_bf16 a[12:15], v[188:191], v[152:155], a[12:15]
    v_mfma_f32_16x16x32_bf16 a[8:11], v[184:187], v[152:155], a[8:11]
    v_perm_b32 v184, v39, v35, s65
    v_perm_b32 v185, v47, v43, s65
    v_mfma_f32_16x16x32_bf16 a[16:19], v[176:179], v[152:155], a[16:19]
    v_perm_b32 v186, v55, v51, s65
    v_perm_b32 v187, v63, v59, s65
    v_mfma_f32_16x16x32_bf16 a[20:23], v[180:183], v[152:155], a[20:23]
    s_lshl_b32 s71, s98, 18
    s_add_u32 s24, s96, s71
    v_perm_b32 v188, v39, v35, s66
    v_mfma_f32_16x16x32_bf16 a[52:55], v[180:183], v[156:159], a[52:55]
    s_addc_u32 s25, s97, 0
    s_add_u32 s98, s98, 1
    v_perm_b32 v189, v47, v43, s66
    v_mfma_f32_16x16x32_bf16 a[48:51], v[176:179], v[156:159], a[48:51]
    s_and_b32 s98, s98, 15
    v_perm_b32 v190, v55, v51, s66
    v_mfma_f32_16x16x32_bf16 a[80:83], v[176:179], v[160:163], a[80:83]
    v_perm_b32 v191, v63, v59, s66
    v_mfma_f32_16x16x32_bf16 a[84:87], v[180:183], v[160:163], a[84:87]
    v_mfma_f32_16x16x32_bf16 a[116:119], v[180:183], v[164:167], a[116:119]
    v_mfma_f32_16x16x32_bf16 a[112:115], v[176:179], v[164:167], a[112:115]
    v_mfma_f32_16x16x32_bf16 a[144:147], v[176:179], v[168:171], a[144:147]
    v_mfma_f32_16x16x32_bf16 a[148:151], v[180:183], v[168:171], a[148:151]
    v_mfma_f32_16x16x32_bf16 a[180:183], v[180:183], v[172:175], a[180:183]
    v_mfma_f32_16x16x32_bf16 a[176:179], v[176:179], v[172:175], a[176:179]
    buffer_load_dwordx4 v[32:35], v224, s[24:27], 0 offen
    v_mfma_f32_16x16x32_bf16 a[184:187], v[184:187], v[172:175], a[184:187]
    s_waitcnt vmcnt(26)
    v_perm_b32 v176, v68, v64, s65
    v_perm_b32 v177, v76, v72, s65
    v_mfma_f32_16x16x32_bf16 a[188:191], v[188:191], v[172:175], a[188:191]
    buffer_load_dwordx4 v[36:39], v224, s[24:27], s51 offen
    v_mfma_f32_16x16x32_bf16 a[156:159], v[188:191], v[168:171], a[156:159]
    s_waitcnt vmcnt(23)
    v_perm_b32 v178, v84, v80, s65
    v_perm_b32 v179, v92, v88, s65
    v_mfma_f32_16x16x32_bf16 a[152:155], v[184:187], v[168:171], a[152:155]
    v_perm_b32 v180, v68, v64, s66
    v_mfma_f32_16x16x32_bf16 a[120:123], v[184:187], v[164:167], a[120:123]
    buffer_load_dwordx4 v[40:43], v224, s[24:27], s52 offen
    v_mfma_f32_16x16x32_bf16 a[124:127], v[188:191], v[164:167], a[124:127]
    v_perm_b32 v181, v76, v72, s66
    v_perm_b32 v182, v84, v80, s66
    v_mfma_f32_16x16x32_bf16 a[92:95], v[188:191], v[160:163], a[92:95]
    buffer_load_dwordx4 v[44:47], v224, s[24:27], s53 offen
    v_mfma_f32_16x16x32_bf16 a[88:91], v[184:187], v[160:163], a[88:91]
    v_perm_b32 v183, v92, v88, s66
    v_mfma_f32_16x16x32_bf16 a[56:59], v[184:187], v[156:159], a[56:59]
    s_add_u32 m0, s68, 0
    v_mfma_f32_16x16x32_bf16 a[60:63], v[188:191], v[156:159], a[60:63]
    buffer_load_dwordx4 v[48:51], v224, s[24:27], s54 offen
    v_mfma_f32_16x16x32_bf16 a[28:31], v[188:191], v[152:155], a[28:31]
    v_mfma_f32_16x16x32_bf16 a[24:27], v[184:187], v[152:155], a[24:27]
    s_waitcnt lgkmcnt(5)
    buffer_load_dwordx4 v[52:55], v224, s[24:27], s55 offen
    v_mfma_f32_16x16x32_bf16 a[0:3], v[176:179], v[128:131], a[0:3]
    v_perm_b32 v184, v69, v65, s65
    v_perm_b32 v185, v77, v73, s65
    v_mfma_f32_16x16x32_bf16 a[4:7], v[180:183], v[128:131], a[4:7]
    s_waitcnt lgkmcnt(4)
    buffer_load_dwordx4 v[56:59], v224, s[24:27], s56 offen
    v_mfma_f32_16x16x32_bf16 a[36:39], v[180:183], v[132:135], a[36:39]
    v_perm_b32 v186, v85, v81, s65
    v_perm_b32 v187, v93, v89, s65
    v_mfma_f32_16x16x32_bf16 a[32:35], v[176:179], v[132:135], a[32:35]
    s_waitcnt lgkmcnt(3)
    v_perm_b32 v188, v69, v65, s66
    v_perm_b32 v189, v77, v73, s66
    v_mfma_f32_16x16x32_bf16 a[64:67], v[176:179], v[136:139], a[64:67]
    buffer_load_dwordx4 v[60:63], v224, s[24:27], s57 offen
    v_mfma_f32_16x16x32_bf16 a[68:71], v[180:183], v[136:139], a[68:71]
    s_waitcnt lgkmcnt(2)
    ds_read_b128 v[152:155], v234 offset:0
    v_perm_b32 v190, v85, v81, s66
    v_mfma_f32_16x16x32_bf16 a[100:103], v[180:183], v[140:143], a[100:103]
    buffer_load_dwordx4 v254, s[28:31], 0 offen offset:2048 lds
    v_mfma_f32_16x16x32_bf16 a[96:99], v[176:179], v[140:143], a[96:99]
    s_waitcnt lgkmcnt(2)
    ds_read_b128 v[156:159], v234 offset:2048
    v_perm_b32 v191, v93, v89, s66
    v_mfma_f32_16x16x32_bf16 a[128:131], v[176:179], v[144:147], a[128:131]
    s_add_u32 m0, s68, 0
    ds_read_b128 v[160:163], v234 offset:4096
    ds_read_b128 v[164:167], v234 offset:6144
    v_mfma_f32_16x16x32_bf16 a[132:135], v[180:183], v[144:147], a[132:135]
    s_waitcnt lgkmcnt(4)
    buffer_load_dwordx4 v254, s[28:31], 0 offen offset:3072 lds
    v_mfma_f32_16x16x32_bf16 a[164:167], v[180:183], v[148:151], a[164:167]
    s_add_u32 s3, s50, 3
    ds_read_b128 v[168:171], v234 offset:8192
    ds_read_b128 v[172:175], v234 offset:10240
    v_mfma_f32_16x16x32_bf16 a[160:163], v[176:179], v[148:151], a[160:163]
    s_and_b32 s3, s3, 7
    s_lshl_b32 s70, s3, 7
    v_perm_b32 v176, v70, v66, s65
    v_mfma_f32_16x16x32_bf16 a[168:171], v[184:187], v[148:151], a[168:171]
    s_mul_i32 s9, s3, 12288
    s_add_u32 s9, s9, s67
    v_perm_b32 v177, v78, v74, s65
    v_mfma_f32_16x16x32_bf16 a[172:175], v[188:191], v[148:151], a[172:175]
    s_add_u32 m0, s9, 0
    v_perm_b32 v178, v86, v82, s65
    v_mfma_f32_16x16x32_bf16 a[140:143], v[188:191], v[144:147], a[140:143]
    buffer_load_dwordx4 v232, s[20:23], s70 offen lds
    v_mfma_f32_16x16x32_bf16 a[136:139], v[184:187], v[144:147], a[136:139]
    s_add_u32 m0, s9, 1024
    v_perm_b32 v179, v94, v90, s65
    v_perm_b32 v180, v70, v66, s66
    v_mfma_f32_16x16x32_bf16 a[104:107], v[184:187], v[140:143], a[104:107]
    buffer_load_dwordx4 v228, s[20:23], s70 offen lds
    v_mfma_f32_16x16x32_bf16 a[108:111], v[188:191], v[140:143], a[108:111]
    s_add_u32 m0, s9, 2048
    v_perm_b32 v181, v78, v74, s66
    v_perm_b32 v182, v86, v82, s66
    v_mfma_f32_16x16x32_bf16 a[76:79], v[188:191], v[136:139], a[76:79]
    buffer_load_dwordx4 v229, s[20:23], s70 offen lds
    v_mfma_f32_16x16x32_bf16 a[72:75], v[184:187], v[136:139], a[72:75]
    v_perm_b32 v183, v94, v90, s66
    v_mfma_f32_16x16x32_bf16 a[40:43], v[184:187], v[132:135], a[40:43]
    v_mfma_f32_16x16x32_bf16 a[44:47], v[188:191], v[132:135], a[44:47]
    v_mfma_f32_16x16x32_bf16 a[12:15], v[188:191], v[128:131], a[12:15]
    v_mfma_f32_16x16x32_bf16 a[8:11], v[184:187], v[128:131], a[8:11]
    v_perm_b32 v184, v71, v67, s65
    v_perm_b32 v185, v79, v75, s65
    v_mfma_f32_16x16x32_bf16 a[16:19], v[176:179], v[128:131], a[16:19]
    v_perm_b32 v186, v87, v83, s65
    v_perm_b32 v187, v95, v91, s65
    v_mfma_f32_16x16x32_bf16 a[20:23], v[180:183], v[128:131], a[20:23]
    s_lshl_b32 s71, s98, 18
    s_add_u32 s24, s96, s71
    v_perm_b32 v188, v71, v67, s66
    v_mfma_f32_16x16x32_bf16 a[52:55], v[180:183], v[132:135], a[52:55]
    s_addc_u32 s25, s97, 0
    s_add_u32 s98, s98, 1
    v_perm_b32 v189, v79, v75, s66
    v_mfma_f32_16x16x32_bf16 a[48:51], v[176:179], v[132:135], a[48:51]
    s_and_b32 s98, s98, 15
    v_perm_b32 v190, v87, v83, s66
    v_mfma_f32_16x16x32_bf16 a[80:83], v[176:179], v[136:139], a[80:83]
    v_perm_b32 v191, v95, v91, s66
    v_mfma_f32_16x16x32_bf16 a[84:87], v[180:183], v[136:139], a[84:87]
    v_mfma_f32_16x16x32_bf16 a[116:119], v[180:183], v[140:143], a[116:119]
    v_mfma_f32_16x16x32_bf16 a[112:115], v[176:179], v[140:143], a[112:115]
    v_mfma_f32_16x16x32_bf16 a[144:147], v[176:179], v[144:147], a[144:147]
    v_mfma_f32_16x16x32_bf16 a[148:151], v[180:183], v[144:147], a[148:151]
    v_mfma_f32_16x16x32_bf16 a[180:183], v[180:183], v[148:151], a[180:183]
    v_mfma_f32_16x16x32_bf16 a[176:179], v[176:179], v[148:151], a[176:179]
    buffer_load_dwordx4 v[64:67], v224, s[24:27], 0 offen
    v_mfma_f32_16x16x32_bf16 a[184:187], v[184:187], v[148:151], a[184:187]
    s_waitcnt vmcnt(31)
    v_perm_b32 v176, v100, v96, s65
    v_perm_b32 v177, v108, v104, s65
    v_mfma_f32_16x16x32_bf16 a[188:191], v[188:191], v[148:151], a[188:191]
    buffer_load_dwordx4 v[68:71], v224, s[24:27], s51 offen
    v_mfma_f32_16x16x32_bf16 a[156:159], v[188:191], v[144:147], a[156:159]
    s_waitcnt vmcnt(28)
    v_perm_b32 v178, v116, v112, s65
    v_perm_b32 v179, v124, v120, s65
    v_mfma_f32_16x16x32_bf16 a[152:155], v[184:187], v[144:147], a[152:155]
    v_perm_b32 v180, v100, v96, s66
    v_mfma_f32_16x16x32_bf16 a[120:123], v[184:187], v[140:143], a[120:123]
    buffer_load_dwordx4 v[72:75], v224, s[24:27], s52 offen
    v_mfma_f32_16x16x32_bf16 a[124:127], v[188:191], v[140:143], a[124:127]
    v_perm_b32 v181, v108, v104, s66
    v_perm_b32 v182, v116, v112, s66
    v_mfma_f32_16x16x32_bf16 a[92:95], v[188:191], v[136:139], a[92:95]
    buffer_load_dwordx4 v[76:79], v224, s[24:27], s53 offen
    v_mfma_f32_16x16x32_bf16 a[88:91], v[184:187], v[136:139], a[88:91]
    v_perm_b32 v183, v124, v120, s66
    v_mfma_f32_16x16x32_bf16 a[56:59], v[184:187], v[132:135], a[56:59]
    s_add_u32 s71, s50, 2
    s_and_b32 s71, s71, 7
    s_mul_i32 s71, s71, 12288
    v_mfma_f32_16x16x32_bf16 a[60:63], v[188:191], v[132:135], a[60:63]
    buffer_load_dwordx4 v[80:83], v224, s[24:27], s54 offen
    v_mfma_f32_16x16x32_bf16 a[28:31], v[188:191], v[128:131], a[28:31]
    s_add_u32 m0, s68, 4096
    v_mfma_f32_16x16x32_bf16 a[24:27], v[184:187], v[128:131], a[24:27]
    s_waitcnt lgkmcnt(5)
    buffer_load_dwordx4 v[84:87], v224, s[24:27], s55 offen
    v_mfma_f32_16x16x32_bf16 a[0:3], v[176:179], v[152:155], a[0:3]
    v_perm_b32 v184, v101, v97, s65
    v_perm_b32 v185, v109, v105, s65
    v_perm_b32 v186, v117, v113, s65
    v_mfma_f32_16x16x32_bf16 a[4:7], v[180:183], v[152:155], a[4:7]
    s_waitcnt lgkmcnt(4)
    buffer_load_dwordx4 v[88:91], v224, s[24:27], s56 offen
    v_mfma_f32_16x16x32_bf16 a[36:39], v[180:183], v[156:159], a[36:39]
    v_perm_b32 v187, v125, v121, s65
    v_perm_b32 v188, v101, v97, s66
    v_mfma_f32_16x16x32_bf16 a[32:35], v[176:179], v[156:159], a[32:35]
    s_waitcnt lgkmcnt(3)
    v_perm_b32 v189, v109, v105, s66
    v_perm_b32 v190, v117, v113, s66
    v_mfma_f32_16x16x32_bf16 a[64:67], v[176:179], v[160:163], a[64:67]
    buffer_load_dwordx4 v[92:95], v224, s[24:27], s57 offen
    v_mfma_f32_16x16x32_bf16 a[68:71], v[180:183], v[160:163], a[68:71]
    s_waitcnt lgkmcnt(2)
    v_perm_b32 v191, v125, v121, s66
    v_add_u32 v233, s71, v230
    v_mfma_f32_16x16x32_bf16 a[100:103], v[180:183], v[164:167], a[100:103]
    s_waitcnt vmcnt(21)
    s_barrier
    v_add_u32 v234, s71, v231
    v_mfma_f32_16x16x32_bf16 a[96:99], v[176:179], v[164:167], a[96:99]
    s_waitcnt lgkmcnt(1)
    buffer_load_dwordx4 v254, s[28:31], s59 offen offset:0 lds
    v_mfma_f32_16x16x32_bf16 a[128:131], v[176:179], v[168:171], a[128:131]
    s_add_u32 m0, s68, 4096
    ds_read_b128 v[128:131], v233 offset:0
    ds_read_b128 v[132:135], v233 offset:2048
    v_mfma_f32_16x16x32_bf16 a[132:135], v[180:183], v[168:171], a[132:135]
    s_waitcnt lgkmcnt(2)
    ds_read_b128 v[136:139], v233 offset:4096
    v_mfma_f32_16x16x32_bf16 a[164:167], v[180:183], v[172:175], a[164:167]
    buffer_load_dwordx4 v254, s[28:31], s59 offen offset:1024 lds
    v_mfma_f32_16x16x32_bf16 a[160:163], v[176:179], v[172:175], a[160:163]
    ds_read_b128 v[140:143], v233 offset:6144
    v_perm_b32 v176, v102, v98, s65
    v_mfma_f32_16x16x32_bf16 a[168:171], v[184:187], v[172:175], a[168:171]
    ds_read_b128 v[144:147], v233 offset:8192
    v_perm_b32 v177, v110, v106, s65
    v_mfma_f32_16x16x32_bf16 a[172:175], v[188:191], v[172:175], a[172:175]
    ds_read_b128 v[148:151], v233 offset:10240
    v_perm_b32 v178, v118, v114, s65
    v_mfma_f32_16x16x32_bf16 a[140:143], v[188:191], v[168:171], a[140:143]
    v_perm_b32 v179, v126, v122, s65
    v_perm_b32 v180, v102, v98, s66
    v_mfma_f32_16x16x32_bf16 a[136:139], v[184:187], v[168:171], a[136:139]
    v_perm_b32 v181, v110, v106, s66
    v_mfma_f32_16x16x32_bf16 a[104:107], v[184:187], v[164:167], a[104:107]
    v_perm_b32 v182, v118, v114, s66
    v_mfma_f32_16x16x32_bf16 a[108:111], v[188:191], v[164:167], a[108:111]
    v_perm_b32 v183, v126, v122, s66
    v_mfma_f32_16x16x32_bf16 a[76:79], v[188:191], v[160:163], a[76:79]
    v_mfma_f32_16x16x32_bf16 a[72:75], v[184:187], v[160:163], a[72:75]
    v_mfma_f32_16x16x32_bf16 a[40:43], v[184:187], v[156:159], a[40:43]
    v_mfma_f32_16x16x32_bf16 a[44:47], v[188:191], v[156:159], a[44:47]
    v_mfma_f32_16x16x32_bf16 a[12:15], v[188:191], v[152:155], a[12:15]
    v_mfma_f32_16x16x32_bf16 a[8:11], v[184:187], v[152:155], a[8:11]
    v_perm_b32 v184, v103, v99, s65
    v_perm_b32 v185, v111, v107, s65
    v_mfma_f32_16x16x32_bf16 a[16:19], v[176:179], v[152:155], a[16:19]
    v_perm_b32 v186, v119, v115, s65
    v_perm_b32 v187, v127, v123, s65
    v_mfma_f32_16x16x32_bf16 a[20:23], v[180:183], v[152:155], a[20:23]
    s_lshl_b32 s71, s98, 18
    s_add_u32 s24, s96, s71
    v_perm_b32 v188, v103, v99, s66
    v_mfma_f32_16x16x32_bf16 a[52:55], v[180:183], v[156:159], a[52:55]
    s_addc_u32 s25, s97, 0
    s_add_u32 s98, s98, 1
    v_perm_b32 v189, v111, v107, s66
    v_mfma_f32_16x16x32_bf16 a[48:51], v[176:179], v[156:159], a[48:51]
    s_and_b32 s98, s98, 15
    v_perm_b32 v190, v119, v115, s66
    v_mfma_f32_16x16x32_bf16 a[80:83], v[176:179], v[160:163], a[80:83]
    v_perm_b32 v191, v127, v123, s66
    v_mfma_f32_16x16x32_bf16 a[84:87], v[180:183], v[160:163], a[84:87]
    v_mfma_f32_16x16x32_bf16 a[116:119], v[180:183], v[164:167], a[116:119]
    v_mfma_f32_16x16x32_bf16 a[112:115], v[176:179], v[164:167], a[112:115]
    v_mfma_f32_16x16x32_bf16 a[144:147], v[176:179], v[168:171], a[144:147]
    v_mfma_f32_16x16x32_bf16 a[148:151], v[180:183], v[168:171], a[148:151]
    v_mfma_f32_16x16x32_bf16 a[180:183], v[180:183], v[172:175], a[180:183]
    v_mfma_f32_16x16x32_bf16 a[176:179], v[176:179], v[172:175], a[176:179]
    buffer_load_dwordx4 v[96:99], v224, s[24:27], 0 offen
    v_mfma_f32_16x16x32_bf16 a[184:187], v[184:187], v[172:175], a[184:187]
    v_perm_b32 v176, v4, v0, s65
    v_perm_b32 v177, v12, v8, s65
    v_mfma_f32_16x16x32_bf16 a[188:191], v[188:191], v[172:175], a[188:191]
    buffer_load_dwordx4 v[100:103], v224, s[24:27], s51 offen
    v_mfma_f32_16x16x32_bf16 a[156:159], v[188:191], v[168:171], a[156:159]
    v_perm_b32 v178, v20, v16, s65
    v_perm_b32 v179, v28, v24, s65
    v_mfma_f32_16x16x32_bf16 a[152:155], v[184:187], v[168:171], a[152:155]
    v_perm_b32 v180, v4, v0, s66
    v_mfma_f32_16x16x32_bf16 a[120:123], v[184:187], v[164:167], a[120:123]
    buffer_load_dwordx4 v[104:107], v224, s[24:27], s52 offen
    v_mfma_f32_16x16x32_bf16 a[124:127], v[188:191], v[164:167], a[124:127]
    v_perm_b32 v181, v12, v8, s66
    v_perm_b32 v182, v20, v16, s66
    v_mfma_f32_16x16x32_bf16 a[92:95], v[188:191], v[160:163], a[92:95]
    buffer_load_dwordx4 v[108:111], v224, s[24:27], s53 offen
    v_mfma_f32_16x16x32_bf16 a[88:91], v[184:187], v[160:163], a[88:91]
    v_perm_b32 v183, v28, v24, s66
    v_mfma_f32_16x16x32_bf16 a[56:59], v[184:187], v[156:159], a[56:59]
    s_add_u32 m0, s68, 4096
    v_mfma_f32_16x16x32_bf16 a[60:63], v[188:191], v[156:159], a[60:63]
    buffer_load_dwordx4 v[112:115], v224, s[24:27], s54 offen
    v_mfma_f32_16x16x32_bf16 a[28:31], v[188:191], v[152:155], a[28:31]
    v_mfma_f32_16x16x32_bf16 a[24:27], v[184:187], v[152:155], a[24:27]
    s_waitcnt lgkmcnt(5)
    buffer_load_dwordx4 v[116:119], v224, s[24:27], s55 offen
    v_mfma_f32_16x16x32_bf16 a[0:3], v[176:179], v[128:131], a[0:3]
    v_perm_b32 v184, v5, v1, s65
    v_perm_b32 v185, v13, v9, s65
    v_mfma_f32_16x16x32_bf16 a[4:7], v[180:183], v[128:131], a[4:7]
    s_waitcnt lgkmcnt(4)
    buffer_load_dwordx4 v[120:123], v224, s[24:27], s56 offen
    v_mfma_f32_16x16x32_bf16 a[36:39], v[180:183], v[132:135], a[36:39]
    v_perm_b32 v186, v21, v17, s65
    v_perm_b32 v187, v29, v25, s65
    v_mfma_f32_16x16x32_bf16 a[32:35], v[176:179], v[132:135], a[32:35]
    s_waitcnt lgkmcnt(3)
    v_perm_b32 v188, v5, v1, s66
    v_perm_b32 v189, v13, v9, s66
    v_mfma_f32_16x16x32_bf16 a[64:67], v[176:179], v[136:139], a[64:67]
    buffer_load_dwordx4 v[124:127], v224, s[24:27], s57 offen
    v_mfma_f32_16x16x32_bf16 a[68:71], v[180:183], v[136:139], a[68:71]
    s_waitcnt lgkmcnt(2)
    ds_read_b128 v[152:155], v234 offset:0
    v_perm_b32 v190, v21, v17, s66
    v_mfma_f32_16x16x32_bf16 a[100:103], v[180:183], v[140:143], a[100:103]
    buffer_load_dwordx4 v254, s[28:31], s59 offen offset:2048 lds
    v_mfma_f32_16x16x32_bf16 a[96:99], v[176:179], v[140:143], a[96:99]
    s_waitcnt lgkmcnt(2)
    ds_read_b128 v[156:159], v234 offset:2048
    v_perm_b32 v191, v29, v25, s66
    v_mfma_f32_16x16x32_bf16 a[128:131], v[176:179], v[144:147], a[128:131]
    s_add_u32 m0, s68, 4096
    ds_read_b128 v[160:163], v234 offset:4096
    ds_read_b128 v[164:167], v234 offset:6144
    v_mfma_f32_16x16x32_bf16 a[132:135], v[180:183], v[144:147], a[132:135]
    s_waitcnt lgkmcnt(4)
    buffer_load_dwordx4 v254, s[28:31], s59 offen offset:3072 lds
    v_mfma_f32_16x16x32_bf16 a[164:167], v[180:183], v[148:151], a[164:167]
    s_add_u32 s3, s50, 4
    ds_read_b128 v[168:171], v234 offset:8192
    ds_read_b128 v[172:175], v234 offset:10240
    v_mfma_f32_16x16x32_bf16 a[160:163], v[176:179], v[148:151], a[160:163]
    s_and_b32 s3, s3, 7
    s_lshl_b32 s70, s3, 7
    v_perm_b32 v176, v6, v2, s65
    v_mfma_f32_16x16x32_bf16 a[168:171], v[184:187], v[148:151], a[168:171]
    s_mul_i32 s9, s3, 12288
    s_add_u32 s9, s9, s67
    v_perm_b32 v177, v14, v10, s65
    v_mfma_f32_16x16x32_bf16 a[172:175], v[188:191], v[148:151], a[172:175]
    s_add_u32 m0, s9, 0
    v_perm_b32 v178, v22, v18, s65
    v_mfma_f32_16x16x32_bf16 a[140:143], v[188:191], v[144:147], a[140:143]
    buffer_load_dwordx4 v232, s[20:23], s70 offen lds
    v_mfma_f32_16x16x32_bf16 a[136:139], v[184:187], v[144:147], a[136:139]
    s_add_u32 m0, s9, 1024
    v_perm_b32 v179, v30, v26, s65
    v_perm_b32 v180, v6, v2, s66
    v_mfma_f32_16x16x32_bf16 a[104:107], v[184:187], v[140:143], a[104:107]
    buffer_load_dwordx4 v228, s[20:23], s70 offen lds
    v_mfma_f32_16x16x32_bf16 a[108:111], v[188:191], v[140:143], a[108:111]
    s_add_u32 m0, s9, 2048
    v_perm_b32 v181, v14, v10, s66
    v_perm_b32 v182, v22, v18, s66
    v_mfma_f32_16x16x32_bf16 a[76:79], v[188:191], v[136:139], a[76:79]
    buffer_load_dwordx4 v229, s[20:23], s70 offen lds
    v_mfma_f32_16x16x32_bf16 a[72:75], v[184:187], v[136:139], a[72:75]
    v_perm_b32 v183, v30, v26, s66
    v_mfma_f32_16x16x32_bf16 a[40:43], v[184:187], v[132:135], a[40:43]
    v_mfma_f32_16x16x32_bf16 a[44:47], v[188:191], v[132:135], a[44:47]
    v_mfma_f32_16x16x32_bf16 a[12:15], v[188:191], v[128:131], a[12:15]
    v_mfma_f32_16x16x32_bf16 a[8:11], v[184:187], v[128:131], a[8:11]
    v_perm_b32 v184, v7, v3, s65
    v_perm_b32 v185, v15, v11, s65
    v_mfma_f32_16x16x32_bf16 a[16:19], v[176:179], v[128:131], a[16:19]
    v_perm_b32 v186, v23, v19, s65
    v_perm_b32 v187, v31, v27, s65
    v_mfma_f32_16x16x32_bf16 a[20:23], v[180:183], v[128:131], a[20:23]
    s_lshl_b32 s71, s98, 18
    s_add_u32 s24, s96, s71
    v_perm_b32 v188, v7, v3, s66
    v_mfma_f32_16x16x32_bf16 a[52:55], v[180:183], v[132:135], a[52:55]
    s_addc_u32 s25, s97, 0
    s_add_u32 s98, s98, 1
    v_perm_b32 v189, v15, v11, s66
    v_mfma_f32_16x16x32_bf16 a[48:51], v[176:179], v[132:135], a[48:51]
    s_and_b32 s98, s98, 15
    v_perm_b32 v190, v23, v19, s66
    v_mfma_f32_16x16x32_bf16 a[80:83], v[176:179], v[136:139], a[80:83]
    v_perm_b32 v191, v31, v27, s66
    v_mfma_f32_16x16x32_bf16 a[84:87], v[180:183], v[136:139], a[84:87]
    v_mfma_f32_16x16x32_bf16 a[116:119], v[180:183], v[140:143], a[116:119]
    v_mfma_f32_16x16x32_bf16 a[112:115], v[176:179], v[140:143], a[112:115]
    v_mfma_f32_16x16x32_bf16 a[144:147], v[176:179], v[144:147], a[144:147]
    v_mfma_f32_16x16x32_bf16 a[148:151], v[180:183], v[144:147], a[148:151]
    v_mfma_f32_16x16x32_bf16 a[180:183], v[180:183], v[148:151], a[180:183]
    v_mfma_f32_16x16x32_bf16 a[176:179], v[176:179], v[148:151], a[176:179]
    buffer_load_dwordx4 v[0:3], v224, s[24:27], 0 offen
    v_mfma_f32_16x16x32_bf16 a[184:187], v[184:187], v[148:151], a[184:187]
    s_waitcnt vmcnt(33)
    v_perm_b32 v176, v36, v32, s65
    v_perm_b32 v177, v44, v40, s65
    v_mfma_f32_16x16x32_bf16 a[188:191], v[188:191], v[148:151], a[188:191]
    buffer_load_dwordx4 v[4:7], v224, s[24:27], s51 offen
    v_mfma_f32_16x16x32_bf16 a[156:159], v[188:191], v[144:147], a[156:159]
    s_waitcnt vmcnt(30)
    v_perm_b32 v178, v52, v48, s65
    v_perm_b32 v179, v60, v56, s65
    v_mfma_f32_16x16x32_bf16 a[152:155], v[184:187], v[144:147], a[152:155]
    v_perm_b32 v180, v36, v32, s66
    v_mfma_f32_16x16x32_bf16 a[120:123], v[184:187], v[140:143], a[120:123]
    buffer_load_dwordx4 v[8:11], v224, s[24:27], s52 offen
    v_mfma_f32_16x16x32_bf16 a[124:127], v[188:191], v[140:143], a[124:127]
    v_perm_b32 v181, v44, v40, s66
    v_perm_b32 v182, v52, v48, s66
    v_mfma_f32_16x16x32_bf16 a[92:95], v[188:191], v[136:139], a[92:95]
    buffer_load_dwordx4 v[12:15], v224, s[24:27], s53 offen
    v_mfma_f32_16x16x32_bf16 a[88:91], v[184:187], v[136:139], a[88:91]
    v_perm_b32 v183, v60, v56, s66
    v_mfma_f32_16x16x32_bf16 a[56:59], v[184:187], v[132:135], a[56:59]
    s_add_u32 s71, s50, 3
    s_and_b32 s71, s71, 7
    s_mul_i32 s71, s71, 12288
    v_mfma_f32_16x16x32_bf16 a[60:63], v[188:191], v[132:135], a[60:63]
    buffer_load_dwordx4 v[16:19], v224, s[24:27], s54 offen
    v_mfma_f32_16x16x32_bf16 a[28:31], v[188:191], v[128:131], a[28:31]
    s_add_u32 m0, s68, 8192
    v_mfma_f32_16x16x32_bf16 a[24:27], v[184:187], v[128:131], a[24:27]
    s_waitcnt lgkmcnt(5)
    buffer_load_dwordx4 v[20:23], v224, s[24:27], s55 offen
    v_mfma_f32_16x16x32_bf16 a[0:3], v[176:179], v[152:155], a[0:3]
    v_perm_b32 v184, v37, v33, s65
    v_perm_b32 v185, v45, v41, s65
    v_perm_b32 v186, v53, v49, s65
    v_mfma_f32_16x16x32_bf16 a[4:7], v[180:183], v[152:155], a[4:7]
    s_waitcnt lgkmcnt(4)
    buffer_load_dwordx4 v[24:27], v224, s[24:27], s56 offen
    v_mfma_f32_16x16x32_bf16 a[36:39], v[180:183], v[156:159], a[36:39]
    v_perm_b32 v187, v61, v57, s65
    v_perm_b32 v188, v37, v33, s66
    v_mfma_f32_16x16x32_bf16 a[32:35], v[176:179], v[156:159], a[32:35]
    s_waitcnt lgkmcnt(3)
    v_perm_b32 v189, v45, v41, s66
    v_perm_b32 v190, v53, v49, s66
    v_mfma_f32_16x16x32_bf16 a[64:67], v[176:179], v[160:163], a[64:67]
    buffer_load_dwordx4 v[28:31], v224, s[24:27], s57 offen
    v_mfma_f32_16x16x32_bf16 a[68:71], v[180:183], v[160:163], a[68:71]
    s_waitcnt lgkmcnt(2)
    v_perm_b32 v191, v61, v57, s66
    v_add_u32 v233, s71, v230
    v_mfma_f32_16x16x32_bf16 a[100:103], v[180:183], v[164:167], a[100:103]
    s_waitcnt vmcnt(31)
    s_barrier
    v_add_u32 v234, s71, v231
    v_mfma_f32_16x16x32_bf16 a[96:99], v[176:179], v[164:167], a[96:99]
    s_waitcnt lgkmcnt(1)
    buffer_load_dwordx4 v254, s[28:31], s60 offen offset:0 lds
    v_mfma_f32_16x16x32_bf16 a[128:131], v[176:179], v[168:171], a[128:131]
    s_add_u32 m0, s68, 8192
    ds_read_b128 v[128:131], v233 offset:0
    ds_read_b128 v[132:135], v233 offset:2048
    v_mfma_f32_16x16x32_bf16 a[132:135], v[180:183], v[168:171], a[132:135]
    s_waitcnt lgkmcnt(2)
    ds_read_b128 v[136:139], v233 offset:4096
    v_mfma_f32_16x16x32_bf16 a[164:167], v[180:183], v[172:175], a[164:167]
    buffer_load_dwordx4 v254, s[28:31], s60 offen offset:1024 lds
    v_mfma_f32_16x16x32_bf16 a[160:163], v[176:179], v[172:175], a[160:163]
    s_add_u32 s3, s50, 5
    ds_read_b128 v[140:143], v233 offset:6144
    v_perm_b32 v176, v38, v34, s65
    v_mfma_f32_16x16x32_bf16 a[168:171], v[184:187], v[172:175], a[168:171]
    s_and_b32 s3, s3, 7
    ds_read_b128 v[144:147], v233 offset:8192
    v_perm_b32 v177, v46, v42, s65
    v_mfma_f32_16x16x32_bf16 a[172:175], v[188:191], v[172:175], a[172:175]
    s_lshl_b32 s70, s3, 7
    ds_read_b128 v[148:151], v233 offset:10240
    v_perm_b32 v178, v54, v50, s65
    v_mfma_f32_16x16x32_bf16 a[140:143], v[188:191], v[168:171], a[140:143]
    s_mul_i32 s9, s3, 12288
    s_add_u32 s9, s9, s67
    v_perm_b32 v179, v62, v58, s65
    v_mfma_f32_16x16x32_bf16 a[136:139], v[184:187], v[168:171], a[136:139]
    s_add_u32 m0, s9, 0
    v_perm_b32 v180, v38, v34, s66
    v_mfma_f32_16x16x32_bf16 a[104:107], v[184:187], v[164:167], a[104:107]
    buffer_load_dwordx4 v232, s[20:23], s70 offen lds
    v_mfma_f32_16x16x32_bf16 a[108:111], v[188:191], v[164:167], a[108:111]
    s_add_u32 m0, s9, 1024
    v_perm_b32 v181, v46, v42, s66
    v_mfma_f32_16x16x32_bf16 a[76:79], v[188:191], v[160:163], a[76:79]
    buffer_load_dwordx4 v228, s[20:23], s70 offen lds
    v_mfma_f32_16x16x32_bf16 a[72:75], v[184:187], v[160:163], a[72:75]
    s_add_u32 m0, s9, 2048
    v_perm_b32 v182, v54, v50, s66
    v_perm_b32 v183, v62, v58, s66
    v_mfma_f32_16x16x32_bf16 a[40:43], v[184:187], v[156:159], a[40:43]
    buffer_load_dwordx4 v229, s[20:23], s70 offen lds
    v_mfma_f32_16x16x32_bf16 a[44:47], v[188:191], v[156:159], a[44:47]
    ds_read_b128 a[192:195], v225 offset:0
    ds_read_b128 a[196:199], v225 offset:16
    v_mfma_f32_16x16x32_bf16 a[12:15], v[188:191], v[152:155], a[12:15]
    ds_read_b128 a[200:203], v225 offset:32
    ds_read_b128 a[204:207], v225 offset:48
    v_mfma_f32_16x16x32_bf16 a[8:11], v[184:187], v[152:155], a[8:11]
    v_perm_b32 v184, v39, v35, s65
    v_perm_b32 v185, v47, v43, s65
    v_mfma_f32_16x16x32_bf16 a[16:19], v[176:179], v[152:155], a[16:19]
    v_perm_b32 v186, v55, v51, s65
    v_perm_b32 v187, v63, v59, s65
    v_mfma_f32_16x16x32_bf16 a[20:23], v[180:183], v[152:155], a[20:23]
    s_lshl_b32 s71, s98, 18
    s_add_u32 s24, s96, s71
    v_perm_b32 v188, v39, v35, s66
    v_mfma_f32_16x16x32_bf16 a[52:55], v[180:183], v[156:159], a[52:55]
    s_addc_u32 s25, s97, 0
    s_add_u32 s98, s98, 1
    v_perm_b32 v189, v47, v43, s66
    v_mfma_f32_16x16x32_bf16 a[48:51], v[176:179], v[156:159], a[48:51]
    s_and_b32 s98, s98, 15
    v_perm_b32 v190, v55, v51, s66
    v_mfma_f32_16x16x32_bf16 a[80:83], v[176:179], v[160:163], a[80:83]
    v_perm_b32 v191, v63, v59, s66
    v_mfma_f32_16x16x32_bf16 a[84:87], v[180:183], v[160:163], a[84:87]
    v_mfma_f32_16x16x32_bf16 a[116:119], v[180:183], v[164:167], a[116:119]
    v_mfma_f32_16x16x32_bf16 a[112:115], v[176:179], v[164:167], a[112:115]
    v_mfma_f32_16x16x32_bf16 a[144:147], v[176:179], v[168:171], a[144:147]
    v_mfma_f32_16x16x32_bf16 a[148:151], v[180:183], v[168:171], a[148:151]
    v_mfma_f32_16x16x32_bf16 a[180:183], v[180:183], v[172:175], a[180:183]
    v_mfma_f32_16x16x32_bf16 a[176:179], v[176:179], v[172:175], a[176:179]
    buffer_load_dwordx4 v[32:35], v224, s[24:27], 0 offen
    v_mfma_f32_16x16x32_bf16 a[184:187], v[184:187], v[172:175], a[184:187]
    s_waitcnt vmcnt(33)
    v_perm_b32 v176, v68, v64, s65
    v_perm_b32 v177, v76, v72, s65
    v_mfma_f32_16x16x32_bf16 a[188:191], v[188:191], v[172:175], a[188:191]
    buffer_load_dwordx4 v[36:39], v224, s[24:27], s51 offen
    v_mfma_f32_16x16x32_bf16 a[156:159], v[188:191], v[168:171], a[156:159]
    s_waitcnt vmcnt(30)
    v_perm_b32 v178, v84, v80, s65
    v_perm_b32 v179, v92, v88, s65
    v_mfma_f32_16x16x32_bf16 a[152:155], v[184:187], v[168:171], a[152:155]
    v_perm_b32 v180, v68, v64, s66
    v_mfma_f32_16x16x32_bf16 a[120:123], v[184:187], v[164:167], a[120:123]
    buffer_load_dwordx4 v[40:43], v224, s[24:27], s52 offen
    v_mfma_f32_16x16x32_bf16 a[124:127], v[188:191], v[164:167], a[124:127]
    v_perm_b32 v181, v76, v72, s66
    v_perm_b32 v182, v84, v80, s66
    v_mfma_f32_16x16x32_bf16 a[92:95], v[188:191], v[160:163], a[92:95]
    buffer_load_dwordx4 v[44:47], v224, s[24:27], s53 offen
    v_mfma_f32_16x16x32_bf16 a[88:91], v[184:187], v[160:163], a[88:91]
    v_perm_b32 v183, v92, v88, s66
    v_mfma_f32_16x16x32_bf16 a[56:59], v[184:187], v[156:159], a[56:59]
    s_add_u32 m0, s68, 8192
    v_mfma_f32_16x16x32_bf16 a[60:63], v[188:191], v[156:159], a[60:63]
    buffer_load_dwordx4 v[48:51], v224, s[24:27], s54 offen
    v_mfma_f32_16x16x32_bf16 a[28:31], v[188:191], v[152:155], a[28:31]
    v_mfma_f32_16x16x32_bf16 a[24:27], v[184:187], v[152:155], a[24:27]
    s_waitcnt lgkmcnt(9)
    buffer_load_dwordx4 v[52:55], v224, s[24:27], s55 offen
    v_mfma_f32_16x16x32_bf16 a[0:3], v[176:179], v[128:131], a[0:3]
    v_perm_b32 v184, v69, v65, s65
    v_perm_b32 v185, v77, v73, s65
    v_mfma_f32_16x16x32_bf16 a[4:7], v[180:183], v[128:131], a[4:7]
    s_waitcnt lgkmcnt(8)
    buffer_load_dwordx4 v[56:59], v224, s[24:27], s56 offen
    v_mfma_f32_16x16x32_bf16 a[36:39], v[180:183], v[132:135], a[36:39]
    v_perm_b32 v186, v85, v81, s65
    v_perm_b32 v187, v93, v89, s65
    v_mfma_f32_16x16x32_bf16 a[32:35], v[176:179], v[132:135], a[32:35]
    s_waitcnt lgkmcnt(7)
    v_perm_b32 v188, v69, v65, s66
    v_perm_b32 v189, v77, v73, s66
    v_mfma_f32_16x16x32_bf16 a[64:67], v[176:179], v[136:139], a[64:67]
    buffer_load_dwordx4 v[60:63], v224, s[24:27], s57 offen
    v_mfma_f32_16x16x32_bf16 a[68:71], v[180:183], v[136:139], a[68:71]
    s_waitcnt lgkmcnt(6)
    ds_read_b128 v[152:155], v234 offset:0
    v_perm_b32 v190, v85, v81, s66
    v_mfma_f32_16x16x32_bf16 a[100:103], v[180:183], v[140:143], a[100:103]
    buffer_load_dwordx4 v254, s[28:31], s60 offen offset:2048 lds
    v_mfma_f32_16x16x32_bf16 a[96:99], v[176:179], v[140:143], a[96:99]
    s_waitcnt lgkmcnt(6)
    ds_read_b128 v[156:159], v234 offset:2048
    v_perm_b32 v191, v93, v89, s66
    v_mfma_f32_16x16x32_bf16 a[128:131], v[176:179], v[144:147], a[128:131]
    s_add_u32 m0, s68, 8192
    ds_read_b128 v[160:163], v234 offset:4096
    ds_read_b128 v[164:167], v234 offset:6144
    v_mfma_f32_16x16x32_bf16 a[132:135], v[180:183], v[144:147], a[132:135]
    s_waitcnt lgkmcnt(8)
    buffer_load_dwordx4 v254, s[28:31], s60 offen offset:3072 lds
    v_mfma_f32_16x16x32_bf16 a[164:167], v[180:183], v[148:151], a[164:167]
    ds_read_b128 v[168:171], v234 offset:8192
    ds_read_b128 v[172:175], v234 offset:10240
    v_mfma_f32_16x16x32_bf16 a[160:163], v[176:179], v[148:151], a[160:163]
    v_perm_b32 v176, v70, v66, s65
    v_perm_b32 v177, v78, v74, s65
    v_mfma_f32_16x16x32_bf16 a[168:171], v[184:187], v[148:151], a[168:171]
    v_perm_b32 v178, v86, v82, s65
    v_perm_b32 v179, v94, v90, s65
    v_mfma_f32_16x16x32_bf16 a[172:175], v[188:191], v[148:151], a[172:175]
    v_perm_b32 v180, v70, v66, s66
    v_mfma_f32_16x16x32_bf16 a[140:143], v[188:191], v[144:147], a[140:143]
    v_perm_b32 v181, v78, v74, s66
    v_mfma_f32_16x16x32_bf16 a[136:139], v[184:187], v[144:147], a[136:139]
    v_perm_b32 v182, v86, v82, s66
    v_mfma_f32_16x16x32_bf16 a[104:107], v[184:187], v[140:143], a[104:107]
    v_perm_b32 v183, v94, v90, s66
    v_mfma_f32_16x16x32_bf16 a[108:111], v[188:191], v[140:143], a[108:111]
    v_mfma_f32_16x16x32_bf16 a[76:79], v[188:191], v[136:139], a[76:79]
    v_mfma_f32_16x16x32_bf16 a[72:75], v[184:187], v[136:139], a[72:75]
    v_mfma_f32_16x16x32_bf16 a[40:43], v[184:187], v[132:135], a[40:43]
    v_mfma_f32_16x16x32_bf16 a[44:47], v[188:191], v[132:135], a[44:47]
    v_mfma_f32_16x16x32_bf16 a[12:15], v[188:191], v[128:131], a[12:15]
    v_mfma_f32_16x16x32_bf16 a[8:11], v[184:187], v[128:131], a[8:11]
    v_perm_b32 v184, v71, v67, s65
    v_perm_b32 v185, v79, v75, s65
    v_mfma_f32_16x16x32_bf16 a[16:19], v[176:179], v[128:131], a[16:19]
    v_perm_b32 v186, v87, v83, s65
    v_perm_b32 v187, v95, v91, s65
    v_mfma_f32_16x16x32_bf16 a[20:23], v[180:183], v[128:131], a[20:23]
    s_lshl_b32 s71, s98, 18
    s_add_u32 s24, s96, s71
    v_perm_b32 v188, v71, v67, s66
    v_mfma_f32_16x16x32_bf16 a[52:55], v[180:183], v[132:135], a[52:55]
    s_addc_u32 s25, s97, 0
    s_add_u32 s98, s98, 1
    v_perm_b32 v189, v79, v75, s66
    v_mfma_f32_16x16x32_bf16 a[48:51], v[176:179], v[132:135], a[48:51]
    s_and_b32 s98, s98, 15
    v_perm_b32 v190, v87, v83, s66
    v_mfma_f32_16x16x32_bf16 a[80:83], v[176:179], v[136:139], a[80:83]
    v_perm_b32 v191, v95, v91, s66
    v_mfma_f32_16x16x32_bf16 a[84:87], v[180:183], v[136:139], a[84:87]
    v_mfma_f32_16x16x32_bf16 a[116:119], v[180:183], v[140:143], a[116:119]
    v_mfma_f32_16x16x32_bf16 a[112:115], v[176:179], v[140:143], a[112:115]
    v_mfma_f32_16x16x32_bf16 a[144:147], v[176:179], v[144:147], a[144:147]
    v_mfma_f32_16x16x32_bf16 a[148:151], v[180:183], v[144:147], a[148:151]
    v_mfma_f32_16x16x32_bf16 a[180:183], v[180:183], v[148:151], a[180:183]
    v_mfma_f32_16x16x32_bf16 a[176:179], v[176:179], v[148:151], a[176:179]
    buffer_load_dwordx4 v[64:67], v224, s[24:27], 0 offen
    v_mfma_f32_16x16x32_bf16 a[184:187], v[184:187], v[148:151], a[184:187]
    s_waitcnt vmcnt(33)
    v_perm_b32 v176, v100, v96, s65
    v_perm_b32 v177, v108, v104, s65
    v_mfma_f32_16x16x32_bf16 a[188:191], v[188:191], v[148:151], a[188:191]
    buffer_load_dwordx4 v[68:71], v224, s[24:27], s51 offen
    v_mfma_f32_16x16x32_bf16 a[156:159], v[188:191], v[144:147], a[156:159]
    s_waitcnt vmcnt(30)
    v_perm_b32 v178, v116, v112, s65
    v_perm_b32 v179, v124, v120, s65
    v_mfma_f32_16x16x32_bf16 a[152:155], v[184:187], v[144:147], a[152:155]
    v_perm_b32 v180, v100, v96, s66
    v_mfma_f32_16x16x32_bf16 a[120:123], v[184:187], v[140:143], a[120:123]
    buffer_load_dwordx4 v[72:75], v224, s[24:27], s52 offen
    v_mfma_f32_16x16x32_bf16 a[124:127], v[188:191], v[140:143], a[124:127]
    v_perm_b32 v181, v108, v104, s66
    v_perm_b32 v182, v116, v112, s66
    v_mfma_f32_16x16x32_bf16 a[92:95], v[188:191], v[136:139], a[92:95]
    buffer_load_dwordx4 v[76:79], v224, s[24:27], s53 offen
    v_mfma_f32_16x16x32_bf16 a[88:91], v[184:187], v[136:139], a[88:91]
    v_perm_b32 v183, v124, v120, s66
    v_mfma_f32_16x16x32_bf16 a[56:59], v[184:187], v[132:135], a[56:59]
    s_add_u32 s71, s50, 4
    s_and_b32 s71, s71, 7
    s_mul_i32 s71, s71, 12288
    v_mfma_f32_16x16x32_bf16 a[60:63], v[188:191], v[132:135], a[60:63]
    buffer_load_dwordx4 v[80:83], v224, s[24:27], s54 offen
    v_mfma_f32_16x16x32_bf16 a[28:31], v[188:191], v[128:131], a[28:31]
    s_add_u32 m0, s68, 12288
    v_mfma_f32_16x16x32_bf16 a[24:27], v[184:187], v[128:131], a[24:27]
    s_waitcnt lgkmcnt(5)
    buffer_load_dwordx4 v[84:87], v224, s[24:27], s55 offen
    v_mfma_f32_16x16x32_bf16 a[0:3], v[176:179], v[152:155], a[0:3]
    v_perm_b32 v184, v101, v97, s65
    v_perm_b32 v185, v109, v105, s65
    v_perm_b32 v186, v117, v113, s65
    v_mfma_f32_16x16x32_bf16 a[4:7], v[180:183], v[152:155], a[4:7]
    s_waitcnt lgkmcnt(4)
    buffer_load_dwordx4 v[88:91], v224, s[24:27], s56 offen
    v_mfma_f32_16x16x32_bf16 a[36:39], v[180:183], v[156:159], a[36:39]
    v_perm_b32 v187, v125, v121, s65
    v_perm_b32 v188, v101, v97, s66
    v_mfma_f32_16x16x32_bf16 a[32:35], v[176:179], v[156:159], a[32:35]
    s_waitcnt lgkmcnt(3)
    v_perm_b32 v189, v109, v105, s66
    v_perm_b32 v190, v117, v113, s66
    v_mfma_f32_16x16x32_bf16 a[64:67], v[176:179], v[160:163], a[64:67]
    buffer_load_dwordx4 v[92:95], v224, s[24:27], s57 offen
    v_mfma_f32_16x16x32_bf16 a[68:71], v[180:183], v[160:163], a[68:71]
    s_waitcnt lgkmcnt(2)
    v_perm_b32 v191, v125, v121, s66
    v_add_u32 v233, s71, v230
    v_mfma_f32_16x16x32_bf16 a[100:103], v[180:183], v[164:167], a[100:103]
    s_waitcnt vmcnt(18)
    s_barrier
    v_add_u32 v234, s71, v231
    v_mfma_f32_16x16x32_bf16 a[96:99], v[176:179], v[164:167], a[96:99]
    s_waitcnt lgkmcnt(1)
    buffer_load_dwordx4 v254, s[28:31], s61 offen offset:0 lds
    v_mfma_f32_16x16x32_bf16 a[128:131], v[176:179], v[168:171], a[128:131]
    s_add_u32 m0, s68, 12288
    ds_read_b128 v[128:131], v233 offset:0
    ds_read_b128 v[132:135], v233 offset:2048
    v_mfma_f32_16x16x32_bf16 a[132:135], v[180:183], v[168:171], a[132:135]
    s_waitcnt lgkmcnt(2)
    ds_read_b128 v[136:139], v233 offset:4096
    v_mfma_f32_16x16x32_bf16 a[164:167], v[180:183], v[172:175], a[164:167]
    buffer_load_dwordx4 v254, s[28:31], s61 offen offset:1024 lds
    v_mfma_f32_16x16x32_bf16 a[160:163], v[176:179], v[172:175], a[160:163]
    ds_read_b128 v[140:143], v233 offset:6144
    v_perm_b32 v176, v102, v98, s65
    v_mfma_f32_16x16x32_bf16 a[168:171], v[184:187], v[172:175], a[168:171]
    ds_read_b128 v[144:147], v233 offset:8192
    v_perm_b32 v177, v110, v106, s65
    v_mfma_f32_16x16x32_bf16 a[172:175], v[188:191], v[172:175], a[172:175]
    ds_read_b128 v[148:151], v233 offset:10240
    v_perm_b32 v178, v118, v114, s65
    v_mfma_f32_16x16x32_bf16 a[140:143], v[188:191], v[168:171], a[140:143]
    ds_read_b128 a[208:211], v225 offset:4096
    v_perm_b32 v179, v126, v122, s65
    v_mfma_f32_16x16x32_bf16 a[136:139], v[184:187], v[168:171], a[136:139]
    ds_read_b128 a[212:215], v225 offset:4112
    v_perm_b32 v180, v102, v98, s66
    v_mfma_f32_16x16x32_bf16 a[104:107], v[184:187], v[164:167], a[104:107]
    ds_read_b128 a[216:219], v225 offset:4128
    v_perm_b32 v181, v110, v106, s66
    v_mfma_f32_16x16x32_bf16 a[108:111], v[188:191], v[164:167], a[108:111]
    ds_read_b128 a[220:223], v225 offset:4144
    v_perm_b32 v182, v118, v114, s66
    v_mfma_f32_16x16x32_bf16 a[76:79], v[188:191], v[160:163], a[76:79]
    v_perm_b32 v183, v126, v122, s66
    v_mfma_f32_16x16x32_bf16 a[72:75], v[184:187], v[160:163], a[72:75]
    v_mfma_f32_16x16x32_bf16 a[40:43], v[184:187], v[156:159], a[40:43]
    v_mfma_f32_16x16x32_bf16 a[44:47], v[188:191], v[156:159], a[44:47]
    v_mfma_f32_16x16x32_bf16 a[12:15], v[188:191], v[152:155], a[12:15]
    v_mfma_f32_16x16x32_bf16 a[8:11], v[184:187], v[152:155], a[8:11]
    v_perm_b32 v184, v103, v99, s65
    v_perm_b32 v185, v111, v107, s65
    v_mfma_f32_16x16x32_bf16 a[16:19], v[176:179], v[152:155], a[16:19]
    v_perm_b32 v186, v119, v115, s65
    v_perm_b32 v187, v127, v123, s65
    v_mfma_f32_16x16x32_bf16 a[20:23], v[180:183], v[152:155], a[20:23]
    s_lshl_b32 s71, s98, 18
    s_add_u32 s24, s96, s71
    v_perm_b32 v188, v103, v99, s66
    v_mfma_f32_16x16x32_bf16 a[52:55], v[180:183], v[156:159], a[52:55]
    s_addc_u32 s25, s97, 0
    s_add_u32 s98, s98, 1
    v_perm_b32 v189, v111, v107, s66
    v_mfma_f32_16x16x32_bf16 a[48:51], v[176:179], v[156:159], a[48:51]
    s_and_b32 s98, s98, 15
    v_perm_b32 v190, v119, v115, s66
    v_mfma_f32_16x16x32_bf16 a[80:83], v[176:179], v[160:163], a[80:83]
    v_perm_b32 v191, v127, v123, s66
    v_mfma_f32_16x16x32_bf16 a[84:87], v[180:183], v[160:163], a[84:87]
    v_mfma_f32_16x16x32_bf16 a[116:119], v[180:183], v[164:167], a[116:119]
    v_mfma_f32_16x16x32_bf16 a[112:115], v[176:179], v[164:167], a[112:115]
    v_mfma_f32_16x16x32_bf16 a[144:147], v[176:179], v[168:171], a[144:147]
    v_mfma_f32_16x16x32_bf16 a[148:151], v[180:183], v[168:171], a[148:151]
    v_mfma_f32_16x16x32_bf16 a[180:183], v[180:183], v[172:175], a[180:183]
    v_mfma_f32_16x16x32_bf16 a[176:179], v[176:179], v[172:175], a[176:179]
    buffer_load_dwordx4 v[96:99], v224, s[24:27], 0 offen
    v_mfma_f32_16x16x32_bf16 a[184:187], v[184:187], v[172:175], a[184:187]
    v_perm_b32 v176, v4, v0, s65
    v_perm_b32 v177, v12, v8, s65
    v_mfma_f32_16x16x32_bf16 a[188:191], v[188:191], v[172:175], a[188:191]
    buffer_load_dwordx4 v[100:103], v224, s[24:27], s51 offen
    v_mfma_f32_16x16x32_bf16 a[156:159], v[188:191], v[168:171], a[156:159]
    v_perm_b32 v178, v20, v16, s65
    v_perm_b32 v179, v28, v24, s65
    v_mfma_f32_16x16x32_bf16 a[152:155], v[184:187], v[168:171], a[152:155]
    v_perm_b32 v180, v4, v0, s66
    v_mfma_f32_16x16x32_bf16 a[120:123], v[184:187], v[164:167], a[120:123]
    buffer_load_dwordx4 v[104:107], v224, s[24:27], s52 offen
    v_mfma_f32_16x16x32_bf16 a[124:127], v[188:191], v[164:167], a[124:127]
    v_perm_b32 v181, v12, v8, s66
    v_perm_b32 v182, v20, v16, s66
    v_mfma_f32_16x16x32_bf16 a[92:95], v[188:191], v[160:163], a[92:95]
    buffer_load_dwordx4 v[108:111], v224, s[24:27], s53 offen
    v_mfma_f32_16x16x32_bf16 a[88:91], v[184:187], v[160:163], a[88:91]
    v_perm_b32 v183, v28, v24, s66
    v_mfma_f32_16x16x32_bf16 a[56:59], v[184:187], v[156:159], a[56:59]
    s_add_u32 m0, s68, 12288
    v_mfma_f32_16x16x32_bf16 a[60:63], v[188:191], v[156:159], a[60:63]
    buffer_load_dwordx4 v[112:115], v224, s[24:27], s54 offen
    v_mfma_f32_16x16x32_bf16 a[28:31], v[188:191], v[152:155], a[28:31]
    v_mfma_f32_16x16x32_bf16 a[24:27], v[184:187], v[152:155], a[24:27]
    s_waitcnt lgkmcnt(9)
    buffer_load_dwordx4 v[116:119], v224, s[24:27], s55 offen
    v_mfma_f32_16x16x32_bf16 a[0:3], v[176:179], v[128:131], a[0:3]
    v_perm_b32 v184, v5, v1, s65
    v_perm_b32 v185, v13, v9, s65
    v_mfma_f32_16x16x32_bf16 a[4:7], v[180:183], v[128:131], a[4:7]
    s_waitcnt lgkmcnt(8)
    buffer_load_dwordx4 v[120:123], v224, s[24:27], s56 offen
    v_mfma_f32_16x16x32_bf16 a[36:39], v[180:183], v[132:135], a[36:39]
    v_perm_b32 v186, v21, v17, s65
    v_perm_b32 v187, v29, v25, s65
    v_mfma_f32_16x16x32_bf16 a[32:35], v[176:179], v[132:135], a[32:35]
    s_waitcnt lgkmcnt(7)
    v_perm_b32 v188, v5, v1, s66
    v_perm_b32 v189, v13, v9, s66
    v_mfma_f32_16x16x32_bf16 a[64:67], v[176:179], v[136:139], a[64:67]
    buffer_load_dwordx4 v[124:127], v224, s[24:27], s57 offen
    v_mfma_f32_16x16x32_bf16 a[68:71], v[180:183], v[136:139], a[68:71]
    s_waitcnt lgkmcnt(6)
    ds_read_b128 v[152:155], v234 offset:0
    v_perm_b32 v190, v21, v17, s66
    v_mfma_f32_16x16x32_bf16 a[100:103], v[180:183], v[140:143], a[100:103]
    buffer_load_dwordx4 v254, s[28:31], s61 offen offset:2048 lds
    v_mfma_f32_16x16x32_bf16 a[96:99], v[176:179], v[140:143], a[96:99]
    s_waitcnt lgkmcnt(6)
    ds_read_b128 v[156:159], v234 offset:2048
    v_perm_b32 v191, v29, v25, s66
    v_mfma_f32_16x16x32_bf16 a[128:131], v[176:179], v[144:147], a[128:131]
    s_add_u32 m0, s68, 12288
    ds_read_b128 v[160:163], v234 offset:4096
    ds_read_b128 v[164:167], v234 offset:6144
    v_mfma_f32_16x16x32_bf16 a[132:135], v[180:183], v[144:147], a[132:135]
    s_waitcnt lgkmcnt(8)
    buffer_load_dwordx4 v254, s[28:31], s61 offen offset:3072 lds
    v_mfma_f32_16x16x32_bf16 a[164:167], v[180:183], v[148:151], a[164:167]
    s_add_u32 s3, s50, 6
    ds_read_b128 v[168:171], v234 offset:8192
    ds_read_b128 v[172:175], v234 offset:10240
    v_mfma_f32_16x16x32_bf16 a[160:163], v[176:179], v[148:151], a[160:163]
    s_and_b32 s3, s3, 7
    s_lshl_b32 s70, s3, 7
    v_perm_b32 v176, v6, v2, s65
    v_mfma_f32_16x16x32_bf16 a[168:171], v[184:187], v[148:151], a[168:171]
    s_mul_i32 s9, s3, 12288
    s_add_u32 s9, s9, s67
    v_perm_b32 v177, v14, v10, s65
    v_mfma_f32_16x16x32_bf16 a[172:175], v[188:191], v[148:151], a[172:175]
    s_add_u32 m0, s9, 0
    v_perm_b32 v178, v22, v18, s65
    v_mfma_f32_16x16x32_bf16 a[140:143], v[188:191], v[144:147], a[140:143]
    buffer_load_dwordx4 v232, s[20:23], s70 offen lds
    v_mfma_f32_16x16x32_bf16 a[136:139], v[184:187], v[144:147], a[136:139]
    s_add_u32 m0, s9, 1024
    v_perm_b32 v179, v30, v26, s65
    v_perm_b32 v180, v6, v2, s66
    v_mfma_f32_16x16x32_bf16 a[104:107], v[184:187], v[140:143], a[104:107]
    buffer_load_dwordx4 v228, s[20:23], s70 offen lds
    v_mfma_f32_16x16x32_bf16 a[108:111], v[188:191], v[140:143], a[108:111]
    s_add_u32 m0, s9, 2048
    v_perm_b32 v181, v14, v10, s66
    v_perm_b32 v182, v22, v18, s66
    v_mfma_f32_16x16x32_bf16 a[76:79], v[188:191], v[136:139], a[76:79]
    buffer_load_dwordx4 v229, s[20:23], s70 offen lds
    v_mfma_f32_16x16x32_bf16 a[72:75], v[184:187], v[136:139], a[72:75]
    v_perm_b32 v183, v30, v26, s66
    v_mfma_f32_16x16x32_bf16 a[40:43], v[184:187], v[132:135], a[40:43]
    v_mfma_f32_16x16x32_bf16 a[44:47], v[188:191], v[132:135], a[44:47]
    v_mfma_f32_16x16x32_bf16 a[12:15], v[188:191], v[128:131], a[12:15]
    v_mfma_f32_16x16x32_bf16 a[8:11], v[184:187], v[128:131], a[8:11]
    v_perm_b32 v184, v7, v3, s65
    v_perm_b32 v185, v15, v11, s65
    v_mfma_f32_16x16x32_bf16 a[16:19], v[176:179], v[128:131], a[16:19]
    v_perm_b32 v186, v23, v19, s65
    v_perm_b32 v187, v31, v27, s65
    v_mfma_f32_16x16x32_bf16 a[20:23], v[180:183], v[128:131], a[20:23]
    s_lshl_b32 s71, s98, 18
    s_add_u32 s24, s96, s71
    v_perm_b32 v188, v7, v3, s66
    v_mfma_f32_16x16x32_bf16 a[52:55], v[180:183], v[132:135], a[52:55]
    s_addc_u32 s25, s97, 0
    s_add_u32 s98, s98, 1
    v_perm_b32 v189, v15, v11, s66
    v_mfma_f32_16x16x32_bf16 a[48:51], v[176:179], v[132:135], a[48:51]
    s_and_b32 s98, s98, 15
    v_perm_b32 v190, v23, v19, s66
    v_mfma_f32_16x16x32_bf16 a[80:83], v[176:179], v[136:139], a[80:83]
    v_perm_b32 v191, v31, v27, s66
    v_mfma_f32_16x16x32_bf16 a[84:87], v[180:183], v[136:139], a[84:87]
    v_mfma_f32_16x16x32_bf16 a[116:119], v[180:183], v[140:143], a[116:119]
    v_mfma_f32_16x16x32_bf16 a[112:115], v[176:179], v[140:143], a[112:115]
    v_mfma_f32_16x16x32_bf16 a[144:147], v[176:179], v[144:147], a[144:147]
    v_mfma_f32_16x16x32_bf16 a[148:151], v[180:183], v[144:147], a[148:151]
    v_mfma_f32_16x16x32_bf16 a[180:183], v[180:183], v[148:151], a[180:183]
    v_mfma_f32_16x16x32_bf16 a[176:179], v[176:179], v[148:151], a[176:179]
    buffer_load_dwordx4 v[0:3], v224, s[24:27], 0 offen
    v_mfma_f32_16x16x32_bf16 a[184:187], v[184:187], v[148:151], a[184:187]
    s_waitcnt vmcnt(30)
    v_perm_b32 v176, v36, v32, s65
    v_perm_b32 v177, v44, v40, s65
    v_mfma_f32_16x16x32_bf16 a[188:191], v[188:191], v[148:151], a[188:191]
    buffer_load_dwordx4 v[4:7], v224, s[24:27], s51 offen
    v_mfma_f32_16x16x32_bf16 a[156:159], v[188:191], v[144:147], a[156:159]
    s_waitcnt vmcnt(27)
    v_perm_b32 v178, v52, v48, s65
    v_perm_b32 v179, v60, v56, s65
    v_mfma_f32_16x16x32_bf16 a[152:155], v[184:187], v[144:147], a[152:155]
    v_perm_b32 v180, v36, v32, s66
    v_mfma_f32_16x16x32_bf16 a[120:123], v[184:187], v[140:143], a[120:123]
    buffer_load_dwordx4 v[8:11], v224, s[24:27], s52 offen
    v_mfma_f32_16x16x32_bf16 a[124:127], v[188:191], v[140:143], a[124:127]
    v_perm_b32 v181, v44, v40, s66
    v_perm_b32 v182, v52, v48, s66
    v_mfma_f32_16x16x32_bf16 a[92:95], v[188:191], v[136:139], a[92:95]
    buffer_load_dwordx4 v[12:15], v224, s[24:27], s53 offen
    v_mfma_f32_16x16x32_bf16 a[88:91], v[184:187], v[136:139], a[88:91]
    v_perm_b32 v183, v60, v56, s66
    v_mfma_f32_16x16x32_bf16 a[56:59], v[184:187], v[132:135], a[56:59]
    s_add_u32 s71, s50, 5
    s_and_b32 s71, s71, 7
    s_mul_i32 s71, s71, 12288
    v_mfma_f32_16x16x32_bf16 a[60:63], v[188:191], v[132:135], a[60:63]
    buffer_load_dwordx4 v[16:19], v224, s[24:27], s54 offen
    v_mfma_f32_16x16x32_bf16 a[28:31], v[188:191], v[128:131], a[28:31]
    s_add_u32 m0, s68, 0
    v_mfma_f32_16x16x32_bf16 a[24:27], v[184:187], v[128:131], a[24:27]
    s_waitcnt lgkmcnt(5)
    buffer_load_dwordx4 v[20:23], v224, s[24:27], s55 offen
    v_mfma_f32_16x16x32_bf16 a[0:3], v[176:179], v[152:155], a[0:3]
    v_perm_b32 v184, v37, v33, s65
    v_perm_b32 v185, v45, v41, s65
    v_perm_b32 v186, v53, v49, s65
    v_mfma_f32_16x16x32_bf16 a[4:7], v[180:183], v[152:155], a[4:7]
    s_waitcnt lgkmcnt(4)
    buffer_load_dwordx4 v[24:27], v224, s[24:27], s56 offen
    v_mfma_f32_16x16x32_bf16 a[36:39], v[180:183], v[156:159], a[36:39]
    v_perm_b32 v187, v61, v57, s65
    v_perm_b32 v188, v37, v33, s66
    v_perm_b32 v189, v45, v41, s66
    v_mfma_f32_16x16x32_bf16 a[32:35], v[176:179], v[156:159], a[32:35]
    s_waitcnt lgkmcnt(3)
    buffer_load_dwordx4 v[28:31], v224, s[24:27], s57 offen
    v_mfma_f32_16x16x32_bf16 a[64:67], v[176:179], v[160:163], a[64:67]
    v_perm_b32 v190, v53, v49, s66
    v_perm_b32 v191, v61, v57, s66
    v_mfma_f32_16x16x32_bf16 a[68:71], v[180:183], v[160:163], a[68:71]
    s_waitcnt lgkmcnt(2)
    v_add_u32 v233, s71, v230
    v_add_u32 v234, s71, v231
    v_mfma_f32_16x16x32_bf16 a[100:103], v[180:183], v[164:167], a[100:103]
    buffer_load_dwordx4 v254, s[28:31], s62 offen offset:0 lds
    v_mfma_f32_16x16x32_bf16 a[96:99], v[176:179], v[164:167], a[96:99]
    s_waitcnt lgkmcnt(1)
    ds_read_b128 v[128:131], v233 offset:0
    ds_read_b128 v[132:135], v233 offset:2048
    v_mfma_f32_16x16x32_bf16 a[128:131], v[176:179], v[168:171], a[128:131]
    s_add_u32 m0, s68, 0
    ds_read_b128 v[136:139], v233 offset:4096
    v_mfma_f32_16x16x32_bf16 a[132:135], v[180:183], v[168:171], a[132:135]
    s_waitcnt lgkmcnt(3)
    buffer_load_dwordx4 v254, s[28:31], s62 offen offset:1024 lds
    v_mfma_f32_16x16x32_bf16 a[164:167], v[180:183], v[172:175], a[164:167]
    s_add_u32 s3, s50, 7
    ds_read_b128 v[140:143], v233 offset:6144
    ds_read_b128 v[144:147], v233 offset:8192
    v_mfma_f32_16x16x32_bf16 a[160:163], v[176:179], v[172:175], a[160:163]
    s_and_b32 s3, s3, 7
    ds_read_b128 v[148:151], v233 offset:10240
    v_perm_b32 v176, v38, v34, s65
    v_mfma_f32_16x16x32_bf16 a[168:171], v[184:187], v[172:175], a[168:171]
    s_lshl_b32 s70, s3, 7
    s_mul_i32 s9, s3, 12288
    v_perm_b32 v177, v46, v42, s65
    v_mfma_f32_16x16x32_bf16 a[172:175], v[188:191], v[172:175], a[172:175]
    s_add_u32 s9, s9, s67
    s_add_u32 m0, s9, 0
    v_perm_b32 v178, v54, v50, s65
    v_mfma_f32_16x16x32_bf16 a[140:143], v[188:191], v[168:171], a[140:143]
    buffer_load_dwordx4 v232, s[20:23], s70 offen lds
    v_mfma_f32_16x16x32_bf16 a[136:139], v[184:187], v[168:171], a[136:139]
    s_add_u32 m0, s9, 1024
    v_perm_b32 v179, v62, v58, s65
    v_mfma_f32_16x16x32_bf16 a[104:107], v[184:187], v[164:167], a[104:107]
    buffer_load_dwordx4 v228, s[20:23], s70 offen lds
    v_mfma_f32_16x16x32_bf16 a[108:111], v[188:191], v[164:167], a[108:111]
    s_add_u32 m0, s9, 2048
    v_perm_b32 v180, v38, v34, s66
    v_perm_b32 v181, v46, v42, s66
    v_mfma_f32_16x16x32_bf16 a[76:79], v[188:191], v[160:163], a[76:79]
    buffer_load_dwordx4 v229, s[20:23], s70 offen lds
    v_mfma_f32_16x16x32_bf16 a[72:75], v[184:187], v[160:163], a[72:75]
    s_waitcnt vmcnt(36)
    ds_read_b128 a[224:227], v225 offset:8192
    v_perm_b32 v182, v54, v50, s66
    v_mfma_f32_16x16x32_bf16 a[40:43], v[184:187], v[156:159], a[40:43]
    s_add_u32 s70, s69, L_pB-L_k1_start
    ds_read_b128 a[228:231], v225 offset:8208
    v_perm_b32 v183, v62, v58, s66
    v_mfma_f32_16x16x32_bf16 a[44:47], v[188:191], v[156:159], a[44:47]
    ds_read_b128 a[232:235], v225 offset:8224
    ds_read_b128 a[236:239], v225 offset:8240
    v_mfma_f32_16x16x32_bf16 a[12:15], v[188:191], v[152:155], a[12:15]
    v_mfma_f32_16x16x32_bf16 a[8:11], v[184:187], v[152:155], a[8:11]
    buffer_load_dword v235, v254, s[72:75], s70 offen
    v_mfma_f32_16x16x32_bf16 a[16:19], v[176:179], v[152:155], a[16:19]
    v_perm_b32 v184, v39, v35, s65
    v_perm_b32 v185, v47, v43, s65
    v_mfma_f32_16x16x32_bf16 a[20:23], v[180:183], v[152:155], a[20:23]
    s_lshl_b32 s71, s98, 18
    v_perm_b32 v186, v55, v51, s65
    v_perm_b32 v187, v63, v59, s65
    v_mfma_f32_16x16x32_bf16 a[52:55], v[180:183], v[156:159], a[52:55]
    s_add_u32 s24, s96, s71
    s_addc_u32 s25, s97, 0
    v_perm_b32 v188, v39, v35, s66
    v_mfma_f32_16x16x32_bf16 a[48:51], v[176:179], v[156:159], a[48:51]
    s_add_u32 s98, s98, 1
    s_and_b32 s98, s98, 15
    v_perm_b32 v189, v47, v43, s66
    v_mfma_f32_16x16x32_bf16 a[80:83], v[176:179], v[160:163], a[80:83]
    v_perm_b32 v190, v55, v51, s66
    v_mfma_f32_16x16x32_bf16 a[84:87], v[180:183], v[160:163], a[84:87]
    v_perm_b32 v191, v63, v59, s66
    v_mfma_f32_16x16x32_bf16 a[116:119], v[180:183], v[164:167], a[116:119]
    v_mfma_f32_16x16x32_bf16 a[112:115], v[176:179], v[164:167], a[112:115]
    v_mfma_f32_16x16x32_bf16 a[144:147], v[176:179], v[168:171], a[144:147]
    v_mfma_f32_16x16x32_bf16 a[148:151], v[180:183], v[168:171], a[148:151]
    v_mfma_f32_16x16x32_bf16 a[180:183], v[180:183], v[172:175], a[180:183]
    v_mfma_f32_16x16x32_bf16 a[176:179], v[176:179], v[172:175], a[176:179]
    buffer_load_dwordx4 v[32:35], v224, s[24:27], 0 offen
    v_mfma_f32_16x16x32_bf16 a[184:187], v[184:187], v[172:175], a[184:187]
    s_waitcnt vmcnt(34)
    v_perm_b32 v176, v68, v64, s65
    v_perm_b32 v177, v76, v72, s65
    v_mfma_f32_16x16x32_bf16 a[188:191], v[188:191], v[172:175], a[188:191]
    buffer_load_dwordx4 v[36:39], v224, s[24:27], s51 offen
    v_mfma_f32_16x16x32_bf16 a[156:159], v[188:191], v[168:171], a[156:159]
    s_waitcnt vmcnt(31)
    v_perm_b32 v178, v84, v80, s65
    v_perm_b32 v179, v92, v88, s65
    v_mfma_f32_16x16x32_bf16 a[152:155], v[184:187], v[168:171], a[152:155]
    v_perm_b32 v180, v68, v64, s66
    v_mfma_f32_16x16x32_bf16 a[120:123], v[184:187], v[164:167], a[120:123]
    buffer_load_dwordx4 v[40:43], v224, s[24:27], s52 offen
    v_mfma_f32_16x16x32_bf16 a[124:127], v[188:191], v[164:167], a[124:127]
    v_perm_b32 v181, v76, v72, s66
    v_perm_b32 v182, v84, v80, s66
    v_mfma_f32_16x16x32_bf16 a[92:95], v[188:191], v[160:163], a[92:95]
    buffer_load_dwordx4 v[44:47], v224, s[24:27], s53 offen
    v_mfma_f32_16x16x32_bf16 a[88:91], v[184:187], v[160:163], a[88:91]
    v_perm_b32 v183, v92, v88, s66
    v_mfma_f32_16x16x32_bf16 a[56:59], v[184:187], v[156:159], a[56:59]
    s_add_u32 m0, s68, 0
    v_mfma_f32_16x16x32_bf16 a[60:63], v[188:191], v[156:159], a[60:63]
    buffer_load_dwordx4 v[48:51], v224, s[24:27], s54 offen
    v_mfma_f32_16x16x32_bf16 a[28:31], v[188:191], v[152:155], a[28:31]
    v_mfma_f32_16x16x32_bf16 a[24:27], v[184:187], v[152:155], a[24:27]
    s_waitcnt lgkmcnt(9)
    buffer_load_dwordx4 v[52:55], v224, s[24:27], s55 offen
    v_mfma_f32_16x16x32_bf16 a[0:3], v[176:179], v[128:131], a[0:3]
    v_perm_b32 v184, v69, v65, s65
    v_perm_b32 v185, v77, v73, s65
    v_mfma_f32_16x16x32_bf16 a[4:7], v[180:183], v[128:131], a[4:7]
    s_waitcnt lgkmcnt(8)
    buffer_load_dwordx4 v[56:59], v224, s[24:27], s56 offen
    v_mfma_f32_16x16x32_bf16 a[36:39], v[180:183], v[132:135], a[36:39]
    v_perm_b32 v186, v85, v81, s65
    v_perm_b32 v187, v93, v89, s65
    v_mfma_f32_16x16x32_bf16 a[32:35], v[176:179], v[132:135], a[32:35]
    s_waitcnt lgkmcnt(7)
    v_perm_b32 v188, v69, v65, s66
    v_perm_b32 v189, v77, v73, s66
    v_mfma_f32_16x16x32_bf16 a[64:67], v[176:179], v[136:139], a[64:67]
    buffer_load_dwordx4 v[60:63], v224, s[24:27], s57 offen
    v_mfma_f32_16x16x32_bf16 a[68:71], v[180:183], v[136:139], a[68:71]
    s_waitcnt lgkmcnt(6)
    ds_read_b128 v[152:155], v234 offset:0
    v_perm_b32 v190, v85, v81, s66
    v_mfma_f32_16x16x32_bf16 a[100:103], v[180:183], v[140:143], a[100:103]
    buffer_load_dwordx4 v254, s[28:31], s62 offen offset:2048 lds
    v_mfma_f32_16x16x32_bf16 a[96:99], v[176:179], v[140:143], a[96:99]
    s_waitcnt lgkmcnt(6)
    ds_read_b128 v[156:159], v234 offset:2048
    v_perm_b32 v191, v93, v89, s66
    v_mfma_f32_16x16x32_bf16 a[128:131], v[176:179], v[144:147], a[128:131]
    s_add_u32 m0, s68, 0
    ds_read_b128 v[160:163], v234 offset:4096
    ds_read_b128 v[164:167], v234 offset:6144
    v_mfma_f32_16x16x32_bf16 a[132:135], v[180:183], v[144:147], a[132:135]
    s_waitcnt lgkmcnt(8)
    buffer_load_dwordx4 v254, s[28:31], s62 offen offset:3072 lds
    v_mfma_f32_16x16x32_bf16 a[164:167], v[180:183], v[148:151], a[164:167]
    ds_read_b128 v[168:171], v234 offset:8192
    ds_read_b128 v[172:175], v234 offset:10240
    v_mfma_f32_16x16x32_bf16 a[160:163], v[176:179], v[148:151], a[160:163]
    v_perm_b32 v176, v70, v66, s65
    v_perm_b32 v177, v78, v74, s65
    v_mfma_f32_16x16x32_bf16 a[168:171], v[184:187], v[148:151], a[168:171]
    v_perm_b32 v178, v86, v82, s65
    v_perm_b32 v179, v94, v90, s65
    v_mfma_f32_16x16x32_bf16 a[172:175], v[188:191], v[148:151], a[172:175]
    v_perm_b32 v180, v70, v66, s66
    v_mfma_f32_16x16x32_bf16 a[140:143], v[188:191], v[144:147], a[140:143]
    v_perm_b32 v181, v78, v74, s66
    v_mfma_f32_16x16x32_bf16 a[136:139], v[184:187], v[144:147], a[136:139]
    v_perm_b32 v182, v86, v82, s66
    v_mfma_f32_16x16x32_bf16 a[104:107], v[184:187], v[140:143], a[104:107]
    v_perm_b32 v183, v94, v90, s66
    v_mfma_f32_16x16x32_bf16 a[108:111], v[188:191], v[140:143], a[108:111]
    v_mfma_f32_16x16x32_bf16 a[76:79], v[188:191], v[136:139], a[76:79]
    v_mfma_f32_16x16x32_bf16 a[72:75], v[184:187], v[136:139], a[72:75]
    v_mfma_f32_16x16x32_bf16 a[40:43], v[184:187], v[132:135], a[40:43]
    v_mfma_f32_16x16x32_bf16 a[44:47], v[188:191], v[132:135], a[44:47]
    v_mfma_f32_16x16x32_bf16 a[12:15], v[188:191], v[128:131], a[12:15]
    v_mfma_f32_16x16x32_bf16 a[8:11], v[184:187], v[128:131], a[8:11]
    v_perm_b32 v184, v71, v67, s65
    v_perm_b32 v185, v79, v75, s65
    v_mfma_f32_16x16x32_bf16 a[16:19], v[176:179], v[128:131], a[16:19]
    v_perm_b32 v186, v87, v83, s65
    v_perm_b32 v187, v95, v91, s65
    v_mfma_f32_16x16x32_bf16 a[20:23], v[180:183], v[128:131], a[20:23]
    s_lshl_b32 s71, s98, 18
    s_add_u32 s24, s96, s71
    v_perm_b32 v188, v71, v67, s66
    v_mfma_f32_16x16x32_bf16 a[52:55], v[180:183], v[132:135], a[52:55]
    s_addc_u32 s25, s97, 0
    s_add_u32 s98, s98, 1
    v_perm_b32 v189, v79, v75, s66
    v_mfma_f32_16x16x32_bf16 a[48:51], v[176:179], v[132:135], a[48:51]
    s_and_b32 s98, s98, 15
    v_perm_b32 v190, v87, v83, s66
    v_mfma_f32_16x16x32_bf16 a[80:83], v[176:179], v[136:139], a[80:83]
    v_perm_b32 v191, v95, v91, s66
    v_mfma_f32_16x16x32_bf16 a[84:87], v[180:183], v[136:139], a[84:87]
    v_mfma_f32_16x16x32_bf16 a[116:119], v[180:183], v[140:143], a[116:119]
    v_mfma_f32_16x16x32_bf16 a[112:115], v[176:179], v[140:143], a[112:115]
    v_mfma_f32_16x16x32_bf16 a[144:147], v[176:179], v[144:147], a[144:147]
    v_mfma_f32_16x16x32_bf16 a[148:151], v[180:183], v[144:147], a[148:151]
    v_mfma_f32_16x16x32_bf16 a[180:183], v[180:183], v[148:151], a[180:183]
    v_mfma_f32_16x16x32_bf16 a[176:179], v[176:179], v[148:151], a[176:179]
    buffer_load_dwordx4 v[64:67], v224, s[24:27], 0 offen
    v_mfma_f32_16x16x32_bf16 a[184:187], v[184:187], v[148:151], a[184:187]
    s_waitcnt vmcnt(34)
    v_perm_b32 v176, v100, v96, s65
    v_perm_b32 v177, v108, v104, s65
    v_mfma_f32_16x16x32_bf16 a[188:191], v[188:191], v[148:151], a[188:191]
    s_waitcnt vmcnt(30)
    v_perm_b32 v178, v116, v112, s65
    v_perm_b32 v179, v124, v120, s65
    v_mfma_f32_16x16x32_bf16 a[156:159], v[188:191], v[144:147], a[156:159]
    buffer_load_dwordx4 v[68:71], v224, s[24:27], s51 offen
    v_mfma_f32_16x16x32_bf16 a[152:155], v[184:187], v[144:147], a[152:155]
    v_perm_b32 v180, v100, v96, s66
    v_mfma_f32_16x16x32_bf16 a[120:123], v[184:187], v[140:143], a[120:123]
    v_perm_b32 v181, v108, v104, s66
    v_mfma_f32_16x16x32_bf16 a[124:127], v[188:191], v[140:143], a[124:127]
    buffer_load_dwordx4 v[72:75], v224, s[24:27], s52 offen
    v_mfma_f32_16x16x32_bf16 a[92:95], v[188:191], v[136:139], a[92:95]
    v_perm_b32 v182, v116, v112, s66
    v_perm_b32 v183, v124, v120, s66
    v_mfma_f32_16x16x32_bf16 a[88:91], v[184:187], v[136:139], a[88:91]
    v_mfma_f32_16x16x32_bf16 a[56:59], v[184:187], v[132:135], a[56:59]
    buffer_load_dwordx4 v[76:79], v224, s[24:27], s53 offen
    v_mfma_f32_16x16x32_bf16 a[60:63], v[188:191], v[132:135], a[60:63]
    s_add_u32 s71, s50, 6
    s_and_b32 s71, s71, 7
    s_mul_i32 s71, s71, 12288
    v_mfma_f32_16x16x32_bf16 a[28:31], v[188:191], v[128:131], a[28:31]
    v_mfma_f32_16x16x32_bf16 a[24:27], v[184:187], v[128:131], a[24:27]
    s_waitcnt lgkmcnt(5)
    buffer_load_dwordx4 v[80:83], v224, s[24:27], s54 offen
    v_mfma_f32_16x16x32_bf16 a[0:3], v[176:179], v[152:155], a[0:3]
    v_perm_b32 v184, v101, v97, s65
    v_perm_b32 v185, v109, v105, s65
    v_mfma_f32_16x16x32_bf16 a[4:7], v[180:183], v[152:155], a[4:7]
    s_waitcnt lgkmcnt(4)
    v_perm_b32 v186, v117, v113, s65
    v_perm_b32 v187, v125, v121, s65
    v_mfma_f32_16x16x32_bf16 a[36:39], v[180:183], v[156:159], a[36:39]
    buffer_load_dwordx4 v[84:87], v224, s[24:27], s55 offen
    v_mfma_f32_16x16x32_bf16 a[32:35], v[176:179], v[156:159], a[32:35]
    s_waitcnt lgkmcnt(3)
    v_perm_b32 v188, v101, v97, s66
    v_perm_b32 v189, v109, v105, s66
    v_mfma_f32_16x16x32_bf16 a[64:67], v[176:179], v[160:163], a[64:67]
    v_perm_b32 v190, v117, v113, s66
    v_perm_b32 v191, v125, v121, s66
    v_mfma_f32_16x16x32_bf16 a[68:71], v[180:183], v[160:163], a[68:71]
    s_waitcnt lgkmcnt(2)
    buffer_load_dwordx4 v[88:91], v224, s[24:27], s56 offen
    v_mfma_f32_16x16x32_bf16 a[100:103], v[180:183], v[164:167], a[100:103]
    s_waitcnt vmcnt(18)
    s_barrier
    v_add_u32 v233, s71, v230
    v_mfma_f32_16x16x32_bf16 a[96:99], v[176:179], v[164:167], a[96:99]
    s_waitcnt lgkmcnt(1)
    ds_read_b128 v[128:131], v233 offset:0
    v_add_u32 v234, s71, v231
    v_mfma_f32_16x16x32_bf16 a[128:131], v[176:179], v[168:171], a[128:131]
    ds_read_b128 v[132:135], v233 offset:2048
    v_mfma_f32_16x16x32_bf16 a[132:135], v[180:183], v[168:171], a[132:135]
    s_waitcnt lgkmcnt(2)
    buffer_load_dwordx4 v[92:95], v224, s[24:27], s57 offen
    v_mfma_f32_16x16x32_bf16 a[164:167], v[180:183], v[172:175], a[164:167]
    ds_read_b128 v[136:139], v233 offset:4096
    ds_read_b128 v[140:143], v233 offset:6144
    v_mfma_f32_16x16x32_bf16 a[160:163], v[176:179], v[172:175], a[160:163]
    ds_read_b128 v[144:147], v233 offset:8192
    v_perm_b32 v176, v102, v98, s65
    v_mfma_f32_16x16x32_bf16 a[168:171], v[184:187], v[172:175], a[168:171]
    ds_read_b128 v[148:151], v233 offset:10240
    v_perm_b32 v177, v110, v106, s65
    v_mfma_f32_16x16x32_bf16 a[172:175], v[188:191], v[172:175], a[172:175]
    ds_read_b128 a[240:243], v225 offset:12288
    v_perm_b32 v178, v118, v114, s65
    v_mfma_f32_16x16x32_bf16 a[140:143], v[188:191], v[168:171], a[140:143]
    ds_read_b128 a[244:247], v225 offset:12304
    v_perm_b32 v179, v126, v122, s65
    v_mfma_f32_16x16x32_bf16 a[136:139], v[184:187], v[168:171], a[136:139]
    ds_read_b128 a[248:251], v225 offset:12320
    v_perm_b32 v180, v102, v98, s66
    v_mfma_f32_16x16x32_bf16 a[104:107], v[184:187], v[164:167], a[104:107]
    ds_read_b128 a[252:255], v225 offset:12336
    v_perm_b32 v181, v110, v106, s66
    v_mfma_f32_16x16x32_bf16 a[108:111], v[188:191], v[164:167], a[108:111]
    v_perm_b32 v182, v118, v114, s66
    v_mfma_f32_16x16x32_bf16 a[76:79], v[188:191], v[160:163], a[76:79]
    v_perm_b32 v183, v126, v122, s66
    v_mfma_f32_16x16x32_bf16 a[72:75], v[184:187], v[160:163], a[72:75]
    v_mfma_f32_16x16x32_bf16 a[40:43], v[184:187], v[156:159], a[40:43]
    v_mfma_f32_16x16x32_bf16 a[44:47], v[188:191], v[156:159], a[44:47]
    v_mfma_f32_16x16x32_bf16 a[12:15], v[188:191], v[152:155], a[12:15]
    v_mfma_f32_16x16x32_bf16 a[8:11], v[184:187], v[152:155], a[8:11]
    v_perm_b32 v184, v103, v99, s65
    v_perm_b32 v185, v111, v107, s65
    v_mfma_f32_16x16x32_bf16 a[16:19], v[176:179], v[152:155], a[16:19]
    v_perm_b32 v186, v119, v115, s65
    v_perm_b32 v187, v127, v123, s65
    v_mfma_f32_16x16x32_bf16 a[20:23], v[180:183], v[152:155], a[20:23]
    s_lshl_b32 s71, s98, 18
    s_add_u32 s24, s96, s71
    v_perm_b32 v188, v103, v99, s66
    v_mfma_f32_16x16x32_bf16 a[52:55], v[180:183], v[156:159], a[52:55]
    s_addc_u32 s25, s97, 0
    s_add_u32 s98, s98, 1
    v_perm_b32 v189, v111, v107, s66
    v_mfma_f32_16x16x32_bf16 a[48:51], v[176:179], v[156:159], a[48:51]
    s_and_b32 s98, s98, 15
    v_perm_b32 v190, v119, v115, s66
    v_mfma_f32_16x16x32_bf16 a[80:83], v[176:179], v[160:163], a[80:83]
    v_perm_b32 v191, v127, v123, s66
    v_mfma_f32_16x16x32_bf16 a[84:87], v[180:183], v[160:163], a[84:87]
    v_mfma_f32_16x16x32_bf16 a[116:119], v[180:183], v[164:167], a[116:119]
    v_mfma_f32_16x16x32_bf16 a[112:115], v[176:179], v[164:167], a[112:115]
    v_mfma_f32_16x16x32_bf16 a[144:147], v[176:179], v[168:171], a[144:147]
    v_mfma_f32_16x16x32_bf16 a[148:151], v[180:183], v[168:171], a[148:151]
    v_mfma_f32_16x16x32_bf16 a[180:183], v[180:183], v[172:175], a[180:183]
    v_mfma_f32_16x16x32_bf16 a[176:179], v[176:179], v[172:175], a[176:179]
    buffer_load_dwordx4 v[96:99], v224, s[24:27], 0 offen
    v_mfma_f32_16x16x32_bf16 a[184:187], v[184:187], v[172:175], a[184:187]
    v_perm_b32 v176, v4, v0, s65
    v_perm_b32 v177, v12, v8, s65
    v_mfma_f32_16x16x32_bf16 a[188:191], v[188:191], v[172:175], a[188:191]
    s_add_u32 m0, s68, 8192
    v_perm_b32 v178, v20, v16, s65
    v_perm_b32 v179, v28, v24, s65
    v_mfma_f32_16x16x32_bf16 a[156:159], v[188:191], v[168:171], a[156:159]
    buffer_load_dwordx4 v[100:103], v224, s[24:27], s51 offen
    v_mfma_f32_16x16x32_bf16 a[152:155], v[184:187], v[168:171], a[152:155]
    v_perm_b32 v180, v4, v0, s66
    v_mfma_f32_16x16x32_bf16 a[120:123], v[184:187], v[164:167], a[120:123]
    v_perm_b32 v181, v12, v8, s66
    v_mfma_f32_16x16x32_bf16 a[124:127], v[188:191], v[164:167], a[124:127]
    buffer_load_dwordx4 v[104:107], v224, s[24:27], s52 offen
    v_mfma_f32_16x16x32_bf16 a[92:95], v[188:191], v[160:163], a[92:95]
    v_perm_b32 v182, v20, v16, s66
    v_perm_b32 v183, v28, v24, s66
    v_mfma_f32_16x16x32_bf16 a[88:91], v[184:187], v[160:163], a[88:91]
    v_mfma_f32_16x16x32_bf16 a[56:59], v[184:187], v[156:159], a[56:59]
    buffer_load_dwordx4 v[108:111], v224, s[24:27], s53 offen
    v_mfma_f32_16x16x32_bf16 a[60:63], v[188:191], v[156:159], a[60:63]
    v_mfma_f32_16x16x32_bf16 a[28:31], v[188:191], v[152:155], a[28:31]
    v_mfma_f32_16x16x32_bf16 a[24:27], v[184:187], v[152:155], a[24:27]
    s_waitcnt lgkmcnt(9)
    buffer_load_dwordx4 v226, s[32:35], 0 offen offset:0 lds
    v_mfma_f32_16x16x32_bf16 a[0:3], v[176:179], v[128:131], a[0:3]
    buffer_load_dwordx4 v[112:115], v224, s[24:27], s54 offen
    v_mfma_f32_16x16x32_bf16 a[4:7], v[180:183], v[128:131], a[4:7]
    s_waitcnt lgkmcnt(8)
    v_perm_b32 v184, v5, v1, s65
    v_perm_b32 v185, v13, v9, s65
    v_mfma_f32_16x16x32_bf16 a[36:39], v[180:183], v[132:135], a[36:39]
    buffer_load_dwordx4 v[116:119], v224, s[24:27], s55 offen
    v_mfma_f32_16x16x32_bf16 a[32:35], v[176:179], v[132:135], a[32:35]
    s_waitcnt lgkmcnt(7)
    v_perm_b32 v186, v21, v17, s65
    v_perm_b32 v187, v29, v25, s65
    v_mfma_f32_16x16x32_bf16 a[64:67], v[176:179], v[136:139], a[64:67]
    v_perm_b32 v188, v5, v1, s66
    v_perm_b32 v189, v13, v9, s66
    v_mfma_f32_16x16x32_bf16 a[68:71], v[180:183], v[136:139], a[68:71]
    s_waitcnt lgkmcnt(6)
    buffer_load_dwordx4 v[120:123], v224, s[24:27], s56 offen
    v_mfma_f32_16x16x32_bf16 a[100:103], v[180:183], v[140:143], a[100:103]
    ds_read_b128 v[152:155], v234 offset:0
    v_perm_b32 v190, v21, v17, s66
    v_mfma_f32_16x16x32_bf16 a[96:99], v[176:179], v[140:143], a[96:99]
    s_waitcnt lgkmcnt(6)
    ds_read_b128 v[156:159], v234 offset:2048
    v_perm_b32 v191, v29, v25, s66
    v_mfma_f32_16x16x32_bf16 a[128:131], v[176:179], v[144:147], a[128:131]
    ds_read_b128 v[160:163], v234 offset:4096
    v_mfma_f32_16x16x32_bf16 a[132:135], v[180:183], v[144:147], a[132:135]
    s_waitcnt lgkmcnt(7)
    buffer_load_dwordx4 v[124:127], v224, s[24:27], s57 offen
    v_mfma_f32_16x16x32_bf16 a[164:167], v[180:183], v[148:151], a[164:167]
    ds_read_b128 v[164:167], v234 offset:6144
    ds_read_b128 v[168:171], v234 offset:8192
    v_mfma_f32_16x16x32_bf16 a[160:163], v[176:179], v[148:151], a[160:163]
    ds_read_b128 v[172:175], v234 offset:10240
    v_perm_b32 v176, v6, v2, s65
    v_mfma_f32_16x16x32_bf16 a[168:171], v[184:187], v[148:151], a[168:171]
    v_perm_b32 v177, v14, v10, s65
    v_perm_b32 v178, v22, v18, s65
    v_mfma_f32_16x16x32_bf16 a[172:175], v[188:191], v[148:151], a[172:175]
    s_add_u32 m0, s68, 9088
    v_perm_b32 v179, v30, v26, s65
    v_mfma_f32_16x16x32_bf16 a[140:143], v[188:191], v[144:147], a[140:143]
    v_perm_b32 v180, v6, v2, s66
    v_mfma_f32_16x16x32_bf16 a[136:139], v[184:187], v[144:147], a[136:139]
    v_perm_b32 v181, v14, v10, s66
    v_mfma_f32_16x16x32_bf16 a[104:107], v[184:187], v[140:143], a[104:107]
    v_perm_b32 v182, v22, v18, s66
    v_mfma_f32_16x16x32_bf16 a[108:111], v[188:191], v[140:143], a[108:111]
    v_perm_b32 v183, v30, v26, s66
    v_mfma_f32_16x16x32_bf16 a[76:79], v[188:191], v[136:139], a[76:79]
    v_mfma_f32_16x16x32_bf16 a[72:75], v[184:187], v[136:139], a[72:75]
    v_mfma_f32_16x16x32_bf16 a[40:43], v[184:187], v[132:135], a[40:43]
    v_mfma_f32_16x16x32_bf16 a[44:47], v[188:191], v[132:135], a[44:47]
    v_mfma_f32_16x16x32_bf16 a[12:15], v[188:191], v[128:131], a[12:15]
    v_mfma_f32_16x16x32_bf16 a[8:11], v[184:187], v[128:131], a[8:11]
    buffer_load_dwordx4 v226, s[32:35], 0 offen offset:128 lds
    v_mfma_f32_16x16x32_bf16 a[16:19], v[176:179], v[128:131], a[16:19]
    v_perm_b32 v184, v7, v3, s65
    v_perm_b32 v185, v15, v11, s65
    v_mfma_f32_16x16x32_bf16 a[20:23], v[180:183], v[128:131], a[20:23]
    s_add_u32 m0, s68, 4096
    v_perm_b32 v186, v23, v19, s65
    v_perm_b32 v187, v31, v27, s65
    v_mfma_f32_16x16x32_bf16 a[52:55], v[180:183], v[132:135], a[52:55]
    v_perm_b32 v188, v7, v3, s66
    v_mfma_f32_16x16x32_bf16 a[48:51], v[176:179], v[132:135], a[48:51]
    v_perm_b32 v189, v15, v11, s66
    v_mfma_f32_16x16x32_bf16 a[80:83], v[176:179], v[136:139], a[80:83]
    v_perm_b32 v190, v23, v19, s66
    v_mfma_f32_16x16x32_bf16 a[84:87], v[180:183], v[136:139], a[84:87]
    v_perm_b32 v191, v31, v27, s66
    v_mfma_f32_16x16x32_bf16 a[116:119], v[180:183], v[140:143], a[116:119]
    v_mfma_f32_16x16x32_bf16 a[112:115], v[176:179], v[140:143], a[112:115]
    v_mfma_f32_16x16x32_bf16 a[144:147], v[176:179], v[144:147], a[144:147]
    v_mfma_f32_16x16x32_bf16 a[148:151], v[180:183], v[144:147], a[148:151]
    v_mfma_f32_16x16x32_bf16 a[180:183], v[180:183], v[148:151], a[180:183]
    v_mfma_f32_16x16x32_bf16 a[176:179], v[176:179], v[148:151], a[176:179]
    buffer_load_dwordx4 v254, s[28:31], s63 offen offset:0 lds
    v_mfma_f32_16x16x32_bf16 a[184:187], v[184:187], v[148:151], a[184:187]
    s_waitcnt vmcnt(25)
    v_perm_b32 v176, v36, v32, s65
    v_perm_b32 v177, v44, v40, s65
    v_mfma_f32_16x16x32_bf16 a[188:191], v[188:191], v[148:151], a[188:191]
    s_waitcnt vmcnt(21)
    v_perm_b32 v178, v52, v48, s65
    v_perm_b32 v179, v60, v56, s65
    v_mfma_f32_16x16x32_bf16 a[156:159], v[188:191], v[144:147], a[156:159]
    s_add_u32 m0, s68, 4096
    v_perm_b32 v180, v36, v32, s66
    v_mfma_f32_16x16x32_bf16 a[152:155], v[184:187], v[144:147], a[152:155]
    v_perm_b32 v181, v44, v40, s66
    v_mfma_f32_16x16x32_bf16 a[120:123], v[184:187], v[140:143], a[120:123]
    v_perm_b32 v182, v52, v48, s66
    v_mfma_f32_16x16x32_bf16 a[124:127], v[188:191], v[140:143], a[124:127]
    buffer_load_dwordx4 v254, s[28:31], s63 offen offset:1024 lds
    v_mfma_f32_16x16x32_bf16 a[92:95], v[188:191], v[136:139], a[92:95]
    s_add_u32 m0, s68, 8192
    v_perm_b32 v183, v60, v56, s66
    v_mfma_f32_16x16x32_bf16 a[88:91], v[184:187], v[136:139], a[88:91]
    v_mfma_f32_16x16x32_bf16 a[56:59], v[184:187], v[132:135], a[56:59]
    v_mfma_f32_16x16x32_bf16 a[60:63], v[188:191], v[132:135], a[60:63]
    v_mfma_f32_16x16x32_bf16 a[28:31], v[188:191], v[128:131], a[28:31]
    buffer_load_dwordx4 v226, s[32:35], 0 offen offset:2048 lds
    v_mfma_f32_16x16x32_bf16 a[24:27], v[184:187], v[128:131], a[24:27]
    s_waitcnt lgkmcnt(5)
    v_perm_b32 v184, v37, v33, s65
    v_perm_b32 v185, v45, v41, s65
    v_mfma_f32_16x16x32_bf16 a[0:3], v[176:179], v[152:155], a[0:3]
    s_add_u32 m0, s68, 4096
    v_perm_b32 v186, v53, v49, s65
    v_perm_b32 v187, v61, v57, s65
    v_mfma_f32_16x16x32_bf16 a[4:7], v[180:183], v[152:155], a[4:7]
    s_waitcnt lgkmcnt(4)
    buffer_load_dwordx4 v254, s[28:31], s63 offen offset:2048 lds
    v_mfma_f32_16x16x32_bf16 a[36:39], v[180:183], v[156:159], a[36:39]
    s_add_u32 m0, s68, 4096
    v_perm_b32 v188, v37, v33, s66
    v_perm_b32 v189, v45, v41, s66
    v_mfma_f32_16x16x32_bf16 a[32:35], v[176:179], v[156:159], a[32:35]
    s_waitcnt lgkmcnt(3)
    v_perm_b32 v190, v53, v49, s66
    v_perm_b32 v191, v61, v57, s66
    v_mfma_f32_16x16x32_bf16 a[64:67], v[176:179], v[160:163], a[64:67]
    s_add_u32 s71, s50, 7
    s_and_b32 s71, s71, 7
    s_mul_i32 s71, s71, 12288
    v_mfma_f32_16x16x32_bf16 a[68:71], v[180:183], v[160:163], a[68:71]
    s_waitcnt lgkmcnt(2)
    buffer_load_dwordx4 v254, s[28:31], s63 offen offset:3072 lds
    v_mfma_f32_16x16x32_bf16 a[100:103], v[180:183], v[164:167], a[100:103]
    v_add_u32 v233, s71, v230
    v_add_u32 v234, s71, v231
    v_mfma_f32_16x16x32_bf16 a[96:99], v[176:179], v[164:167], a[96:99]
    s_waitcnt lgkmcnt(1)
    ds_read_b128 v[128:131], v233 offset:0
    ds_read_b128 v[132:135], v233 offset:2048
    v_mfma_f32_16x16x32_bf16 a[128:131], v[176:179], v[168:171], a[128:131]
    ds_read_b128 v[136:139], v233 offset:4096
    ds_read_b128 v[140:143], v233 offset:6144
    v_mfma_f32_16x16x32_bf16 a[132:135], v[180:183], v[168:171], a[132:135]
    s_waitcnt lgkmcnt(4)
    ds_read_b128 v[144:147], v233 offset:8192
    ds_read_b128 v[148:151], v233 offset:10240
    v_mfma_f32_16x16x32_bf16 a[164:167], v[180:183], v[172:175], a[164:167]
    v_mfma_f32_16x16x32_bf16 a[160:163], v[176:179], v[172:175], a[160:163]
    s_waitcnt vmcnt(23)
    ds_read_b128 v[192:195], v225 offset:0
    v_perm_b32 v176, v38, v34, s65
    v_mfma_f32_16x16x32_bf16 a[168:171], v[184:187], v[172:175], a[168:171]
    ds_read_b128 v[196:199], v225 offset:16
    v_perm_b32 v177, v46, v42, s65
    v_mfma_f32_16x16x32_bf16 a[172:175], v[188:191], v[172:175], a[172:175]
    s_add_u32 m0, s68, 9088
    ds_read_b128 v[200:203], v225 offset:32
    v_perm_b32 v178, v54, v50, s65
    v_mfma_f32_16x16x32_bf16 a[140:143], v[188:191], v[168:171], a[140:143]
    ds_read_b128 v[204:207], v225 offset:48
    v_perm_b32 v179, v62, v58, s65
    v_mfma_f32_16x16x32_bf16 a[136:139], v[184:187], v[168:171], a[136:139]
    v_perm_b32 v180, v38, v34, s66
    v_mfma_f32_16x16x32_bf16 a[104:107], v[184:187], v[164:167], a[104:107]
    v_perm_b32 v181, v46, v42, s66
    v_mfma_f32_16x16x32_bf16 a[108:111], v[188:191], v[164:167], a[108:111]
    v_perm_b32 v182, v54, v50, s66
    v_mfma_f32_16x16x32_bf16 a[76:79], v[188:191], v[160:163], a[76:79]
    v_perm_b32 v183, v62, v58, s66
    v_mfma_f32_16x16x32_bf16 a[72:75], v[184:187], v[160:163], a[72:75]
    v_mfma_f32_16x16x32_bf16 a[40:43], v[184:187], v[156:159], a[40:43]
    v_mfma_f32_16x16x32_bf16 a[44:47], v[188:191], v[156:159], a[44:47]
    v_mfma_f32_16x16x32_bf16 a[12:15], v[188:191], v[152:155], a[12:15]
    v_mfma_f32_16x16x32_bf16 a[8:11], v[184:187], v[152:155], a[8:11]
    buffer_load_dwordx4 v226, s[32:35], 0 offen offset:2176 lds
    v_mfma_f32_16x16x32_bf16 a[16:19], v[176:179], v[152:155], a[16:19]
    v_perm_b32 v184, v39, v35, s65
    v_perm_b32 v185, v47, v43, s65
    v_mfma_f32_16x16x32_bf16 a[20:23], v[180:183], v[152:155], a[20:23]
    v_perm_b32 v186, v55, v51, s65
    v_perm_b32 v187, v63, v59, s65
    v_mfma_f32_16x16x32_bf16 a[52:55], v[180:183], v[156:159], a[52:55]
    v_perm_b32 v188, v39, v35, s66
    v_mfma_f32_16x16x32_bf16 a[48:51], v[176:179], v[156:159], a[48:51]
    v_perm_b32 v189, v47, v43, s66
    v_mfma_f32_16x16x32_bf16 a[80:83], v[176:179], v[160:163], a[80:83]
    v_perm_b32 v190, v55, v51, s66
    v_mfma_f32_16x16x32_bf16 a[84:87], v[180:183], v[160:163], a[84:87]
    v_perm_b32 v191, v63, v59, s66
    v_mfma_f32_16x16x32_bf16 a[116:119], v[180:183], v[164:167], a[116:119]
    v_mfma_f32_16x16x32_bf16 a[112:115], v[176:179], v[164:167], a[112:115]
    v_mfma_f32_16x16x32_bf16 a[144:147], v[176:179], v[168:171], a[144:147]
    v_mfma_f32_16x16x32_bf16 a[148:151], v[180:183], v[168:171], a[148:151]
    v_mfma_f32_16x16x32_bf16 a[180:183], v[180:183], v[172:175], a[180:183]
    v_mfma_f32_16x16x32_bf16 a[176:179], v[176:179], v[172:175], a[176:179]
    s_waitcnt vmcnt(20)
    v_perm_b32 v176, v68, v64, s65
    v_perm_b32 v177, v76, v72, s65
    v_mfma_f32_16x16x32_bf16 a[184:187], v[184:187], v[172:175], a[184:187]
    s_waitcnt vmcnt(16)
    v_perm_b32 v178, v84, v80, s65
    v_perm_b32 v179, v92, v88, s65
    v_mfma_f32_16x16x32_bf16 a[188:191], v[188:191], v[172:175], a[188:191]
    s_add_u32 m0, s68, 12288
    v_perm_b32 v180, v68, v64, s66
    v_mfma_f32_16x16x32_bf16 a[156:159], v[188:191], v[168:171], a[156:159]
    v_perm_b32 v181, v76, v72, s66
    v_mfma_f32_16x16x32_bf16 a[152:155], v[184:187], v[168:171], a[152:155]
    v_perm_b32 v182, v84, v80, s66
    v_mfma_f32_16x16x32_bf16 a[120:123], v[184:187], v[164:167], a[120:123]
    v_perm_b32 v183, v92, v88, s66
    v_mfma_f32_16x16x32_bf16 a[124:127], v[188:191], v[164:167], a[124:127]
    v_mfma_f32_16x16x32_bf16 a[92:95], v[188:191], v[160:163], a[92:95]
    v_mfma_f32_16x16x32_bf16 a[88:91], v[184:187], v[160:163], a[88:91]
    v_mfma_f32_16x16x32_bf16 a[56:59], v[184:187], v[156:159], a[56:59]
    v_mfma_f32_16x16x32_bf16 a[60:63], v[188:191], v[156:159], a[60:63]
    v_mfma_f32_16x16x32_bf16 a[28:31], v[188:191], v[152:155], a[28:31]
    v_mfma_f32_16x16x32_bf16 a[24:27], v[184:187], v[152:155], a[24:27]
    s_waitcnt lgkmcnt(9)
    buffer_load_dwordx4 v226, s[32:35], s59 offen offset:0 lds
    v_mfma_f32_16x16x32_bf16 a[0:3], v[176:179], v[128:131], a[0:3]
    v_perm_b32 v184, v69, v65, s65
    v_perm_b32 v185, v77, v73, s65
    v_mfma_f32_16x16x32_bf16 a[4:7], v[180:183], v[128:131], a[4:7]
    s_waitcnt lgkmcnt(8)
    v_perm_b32 v186, v85, v81, s65
    v_perm_b32 v187, v93, v89, s65
    v_mfma_f32_16x16x32_bf16 a[36:39], v[180:183], v[132:135], a[36:39]
    v_perm_b32 v188, v69, v65, s66
    v_perm_b32 v189, v77, v73, s66
    v_mfma_f32_16x16x32_bf16 a[32:35], v[176:179], v[132:135], a[32:35]
    s_waitcnt lgkmcnt(7)
    v_perm_b32 v190, v85, v81, s66
    v_perm_b32 v191, v93, v89, s66
    v_mfma_f32_16x16x32_bf16 a[64:67], v[176:179], v[136:139], a[64:67]
    v_mfma_f32_16x16x32_bf16 a[68:71], v[180:183], v[136:139], a[68:71]
    s_waitcnt lgkmcnt(6)
    v_mfma_f32_16x16x32_bf16 a[100:103], v[180:183], v[140:143], a[100:103]
    ds_read_b128 v[152:155], v234 offset:0
    ds_read_b128 v[156:159], v234 offset:2048
    v_mfma_f32_16x16x32_bf16 a[96:99], v[176:179], v[140:143], a[96:99]
    s_waitcnt lgkmcnt(7)
    ds_read_b128 v[160:163], v234 offset:4096
    ds_read_b128 v[164:167], v234 offset:6144
    v_mfma_f32_16x16x32_bf16 a[128:131], v[176:179], v[144:147], a[128:131]
    v_mfma_f32_16x16x32_bf16 a[132:135], v[180:183], v[144:147], a[132:135]
    s_waitcnt lgkmcnt(8)
    ds_read_b128 v[168:171], v234 offset:8192
    ds_read_b128 v[172:175], v234 offset:10240
    v_mfma_f32_16x16x32_bf16 a[164:167], v[180:183], v[148:151], a[164:167]
    v_mfma_f32_16x16x32_bf16 a[160:163], v[176:179], v[148:151], a[160:163]
    v_perm_b32 v176, v70, v66, s65
    v_perm_b32 v177, v78, v74, s65
    v_mfma_f32_16x16x32_bf16 a[168:171], v[184:187], v[148:151], a[168:171]
    v_perm_b32 v178, v86, v82, s65
    v_perm_b32 v179, v94, v90, s65
    v_mfma_f32_16x16x32_bf16 a[172:175], v[188:191], v[148:151], a[172:175]
    s_add_u32 m0, s68, 13184
    v_perm_b32 v180, v70, v66, s66
    v_mfma_f32_16x16x32_bf16 a[140:143], v[188:191], v[144:147], a[140:143]
    v_perm_b32 v181, v78, v74, s66
    v_mfma_f32_16x16x32_bf16 a[136:139], v[184:187], v[144:147], a[136:139]
    v_perm_b32 v182, v86, v82, s66
    v_mfma_f32_16x16x32_bf16 a[104:107], v[184:187], v[140:143], a[104:107]
    v_perm_b32 v183, v94, v90, s66
    v_mfma_f32_16x16x32_bf16 a[108:111], v[188:191], v[140:143], a[108:111]
    v_mfma_f32_16x16x32_bf16 a[76:79], v[188:191], v[136:139], a[76:79]
    v_mfma_f32_16x16x32_bf16 a[72:75], v[184:187], v[136:139], a[72:75]
    v_mfma_f32_16x16x32_bf16 a[40:43], v[184:187], v[132:135], a[40:43]
    v_mfma_f32_16x16x32_bf16 a[44:47], v[188:191], v[132:135], a[44:47]
    v_mfma_f32_16x16x32_bf16 a[12:15], v[188:191], v[128:131], a[12:15]
    v_mfma_f32_16x16x32_bf16 a[8:11], v[184:187], v[128:131], a[8:11]
    buffer_load_dwordx4 v226, s[32:35], s59 offen offset:128 lds
    v_mfma_f32_16x16x32_bf16 a[16:19], v[176:179], v[128:131], a[16:19]
    v_perm_b32 v184, v71, v67, s65
    v_perm_b32 v185, v79, v75, s65
    v_mfma_f32_16x16x32_bf16 a[20:23], v[180:183], v[128:131], a[20:23]
    v_perm_b32 v186, v87, v83, s65
    v_perm_b32 v187, v95, v91, s65
    v_mfma_f32_16x16x32_bf16 a[52:55], v[180:183], v[132:135], a[52:55]
    v_perm_b32 v188, v71, v67, s66
    v_mfma_f32_16x16x32_bf16 a[48:51], v[176:179], v[132:135], a[48:51]
    v_perm_b32 v189, v79, v75, s66
    v_mfma_f32_16x16x32_bf16 a[80:83], v[176:179], v[136:139], a[80:83]
    v_perm_b32 v190, v87, v83, s66
    v_mfma_f32_16x16x32_bf16 a[84:87], v[180:183], v[136:139], a[84:87]
    v_perm_b32 v191, v95, v91, s66
    v_mfma_f32_16x16x32_bf16 a[116:119], v[180:183], v[140:143], a[116:119]
    v_mfma_f32_16x16x32_bf16 a[112:115], v[176:179], v[140:143], a[112:115]
    v_mfma_f32_16x16x32_bf16 a[144:147], v[176:179], v[144:147], a[144:147]
    v_mfma_f32_16x16x32_bf16 a[148:151], v[180:183], v[144:147], a[148:151]
    v_mfma_f32_16x16x32_bf16 a[180:183], v[180:183], v[148:151], a[180:183]
    v_mfma_f32_16x16x32_bf16 a[176:179], v[176:179], v[148:151], a[176:179]
    s_waitcnt vmcnt(14)
    v_perm_b32 v176, v100, v96, s65
    v_perm_b32 v177, v108, v104, s65
    v_mfma_f32_16x16x32_bf16 a[184:187], v[184:187], v[148:151], a[184:187]
    s_waitcnt vmcnt(9)
    v_perm_b32 v178, v116, v112, s65
    v_perm_b32 v179, v124, v120, s65
    v_mfma_f32_16x16x32_bf16 a[188:191], v[188:191], v[148:151], a[188:191]
    s_add_u32 m0, s68, 12288
    v_perm_b32 v180, v100, v96, s66
    v_mfma_f32_16x16x32_bf16 a[156:159], v[188:191], v[144:147], a[156:159]
    v_perm_b32 v181, v108, v104, s66
    v_mfma_f32_16x16x32_bf16 a[152:155], v[184:187], v[144:147], a[152:155]
    v_perm_b32 v182, v116, v112, s66
    v_mfma_f32_16x16x32_bf16 a[120:123], v[184:187], v[140:143], a[120:123]
    v_perm_b32 v183, v124, v120, s66
    v_mfma_f32_16x16x32_bf16 a[124:127], v[188:191], v[140:143], a[124:127]
    v_mfma_f32_16x16x32_bf16 a[92:95], v[188:191], v[136:139], a[92:95]
    v_mfma_f32_16x16x32_bf16 a[88:91], v[184:187], v[136:139], a[88:91]
    v_mfma_f32_16x16x32_bf16 a[56:59], v[184:187], v[132:135], a[56:59]
    v_mfma_f32_16x16x32_bf16 a[60:63], v[188:191], v[132:135], a[60:63]
    v_mfma_f32_16x16x32_bf16 a[28:31], v[188:191], v[128:131], a[28:31]
    v_mfma_f32_16x16x32_bf16 a[24:27], v[184:187], v[128:131], a[24:27]
    s_waitcnt lgkmcnt(5)
    buffer_load_dwordx4 v226, s[32:35], s59 offen offset:2048 lds
    v_mfma_f32_16x16x32_bf16 a[0:3], v[176:179], v[152:155], a[0:3]
    v_perm_b32 v184, v101, v97, s65
    v_perm_b32 v185, v109, v105, s65
    v_mfma_f32_16x16x32_bf16 a[4:7], v[180:183], v[152:155], a[4:7]
    s_waitcnt lgkmcnt(4)
    v_perm_b32 v186, v117, v113, s65
    v_perm_b32 v187, v125, v121, s65
    v_mfma_f32_16x16x32_bf16 a[36:39], v[180:183], v[156:159], a[36:39]
    v_perm_b32 v188, v101, v97, s66
    v_mfma_f32_16x16x32_bf16 a[32:35], v[176:179], v[156:159], a[32:35]
    s_waitcnt lgkmcnt(3)
    v_perm_b32 v189, v109, v105, s66
    v_mfma_f32_16x16x32_bf16 a[64:67], v[176:179], v[160:163], a[64:67]
    v_perm_b32 v190, v117, v113, s66
    v_mfma_f32_16x16x32_bf16 a[68:71], v[180:183], v[160:163], a[68:71]
    s_waitcnt lgkmcnt(2)
    v_perm_b32 v191, v125, v121, s66
    v_mfma_f32_16x16x32_bf16 a[100:103], v[180:183], v[164:167], a[100:103]
    v_mfma_f32_16x16x32_bf16 a[96:99], v[176:179], v[164:167], a[96:99]
    s_waitcnt lgkmcnt(1)
    v_mfma_f32_16x16x32_bf16 a[128:131], v[176:179], v[168:171], a[128:131]
    v_mfma_f32_16x16x32_bf16 a[132:135], v[180:183], v[168:171], a[132:135]
    s_waitcnt lgkmcnt(0)
    v_mfma_f32_16x16x32_bf16 a[164:167], v[180:183], v[172:175], a[164:167]
    v_mfma_f32_16x16x32_bf16 a[160:163], v[176:179], v[172:175], a[160:163]
    s_waitcnt vmcnt(4)
    ds_read_b128 v[208:211], v225 offset:4096
    v_perm_b32 v176, v102, v98, s65
    v_mfma_f32_16x16x32_bf16 a[168:171], v[184:187], v[172:175], a[168:171]
    ds_read_b128 v[212:215], v225 offset:4112
    v_perm_b32 v177, v110, v106, s65
    v_mfma_f32_16x16x32_bf16 a[172:175], v[188:191], v[172:175], a[172:175]
    s_add_u32 m0, s68, 13184
    ds_read_b128 v[216:219], v225 offset:4128
    v_perm_b32 v178, v118, v114, s65
    v_mfma_f32_16x16x32_bf16 a[140:143], v[188:191], v[168:171], a[140:143]
    ds_read_b128 v[220:223], v225 offset:4144
    v_perm_b32 v179, v126, v122, s65
    v_mfma_f32_16x16x32_bf16 a[136:139], v[184:187], v[168:171], a[136:139]
    v_perm_b32 v180, v102, v98, s66
    v_mfma_f32_16x16x32_bf16 a[104:107], v[184:187], v[164:167], a[104:107]
    v_perm_b32 v181, v110, v106, s66
    v_mfma_f32_16x16x32_bf16 a[108:111], v[188:191], v[164:167], a[108:111]
    v_perm_b32 v182, v118, v114, s66
    v_mfma_f32_16x16x32_bf16 a[76:79], v[188:191], v[160:163], a[76:79]
    v_perm_b32 v183, v126, v122, s66
    v_mfma_f32_16x16x32_bf16 a[72:75], v[184:187], v[160:163], a[72:75]
    v_mfma_f32_16x16x32_bf16 a[40:43], v[184:187], v[156:159], a[40:43]
    v_mfma_f32_16x16x32_bf16 a[44:47], v[188:191], v[156:159], a[44:47]
    v_mfma_f32_16x16x32_bf16 a[12:15], v[188:191], v[152:155], a[12:15]
    v_mfma_f32_16x16x32_bf16 a[8:11], v[184:187], v[152:155], a[8:11]
    buffer_load_dwordx4 v226, s[32:35], s59 offen offset:2176 lds
    v_mfma_f32_16x16x32_bf16 a[16:19], v[176:179], v[152:155], a[16:19]
    v_perm_b32 v184, v103, v99, s65
    v_perm_b32 v185, v111, v107, s65
    v_mfma_f32_16x16x32_bf16 a[20:23], v[180:183], v[152:155], a[20:23]
    v_perm_b32 v186, v119, v115, s65
    v_perm_b32 v187, v127, v123, s65
    v_mfma_f32_16x16x32_bf16 a[52:55], v[180:183], v[156:159], a[52:55]
    v_perm_b32 v188, v103, v99, s66
    v_mfma_f32_16x16x32_bf16 a[48:51], v[176:179], v[156:159], a[48:51]
    v_perm_b32 v189, v111, v107, s66
    v_mfma_f32_16x16x32_bf16 a[80:83], v[176:179], v[160:163], a[80:83]
    v_perm_b32 v190, v119, v115, s66
    v_mfma_f32_16x16x32_bf16 a[84:87], v[180:183], v[160:163], a[84:87]
    v_perm_b32 v191, v127, v123, s66
    v_mfma_f32_16x16x32_bf16 a[116:119], v[180:183], v[164:167], a[116:119]
    v_mfma_f32_16x16x32_bf16 a[112:115], v[176:179], v[164:167], a[112:115]
    v_mfma_f32_16x16x32_bf16 a[144:147], v[176:179], v[168:171], a[144:147]
    v_mfma_f32_16x16x32_bf16 a[148:151], v[180:183], v[168:171], a[148:151]
    v_mfma_f32_16x16x32_bf16 a[180:183], v[180:183], v[172:175], a[180:183]
    v_mfma_f32_16x16x32_bf16 a[176:179], v[176:179], v[172:175], a[176:179]
    v_mfma_f32_16x16x32_bf16 a[184:187], v[184:187], v[172:175], a[184:187]
    v_mfma_f32_16x16x32_bf16 a[188:191], v[188:191], v[172:175], a[188:191]
    v_mfma_f32_16x16x32_bf16 a[156:159], v[188:191], v[168:171], a[156:159]
    v_mfma_f32_16x16x32_bf16 a[152:155], v[184:187], v[168:171], a[152:155]
    v_mfma_f32_16x16x32_bf16 a[120:123], v[184:187], v[164:167], a[120:123]
    v_mfma_f32_16x16x32_bf16 a[124:127], v[188:191], v[164:167], a[124:127]
    v_mfma_f32_16x16x32_bf16 a[92:95], v[188:191], v[160:163], a[92:95]
    v_mfma_f32_16x16x32_bf16 a[88:91], v[184:187], v[160:163], a[88:91]
    v_mfma_f32_16x16x32_bf16 a[56:59], v[184:187], v[156:159], a[56:59]
    v_mfma_f32_16x16x32_bf16 a[60:63], v[188:191], v[156:159], a[60:63]
    v_mfma_f32_16x16x32_bf16 a[28:31], v[188:191], v[152:155], a[28:31]
    v_mfma_f32_16x16x32_bf16 a[24:27], v[184:187], v[152:155], a[24:27]
    s_barrier
L_pB:
    s_load_dwordx2 s[12:13], s[78:79], 0
    v_accvgpr_read_b32 v244, a0
    v_accvgpr_read_b32 v245, a4
    v_cvt_pk_bf16_f32 v176, v244, v245
    v_accvgpr_read_b32 v246, a8
    v_accvgpr_read_b32 v247, a12
    v_cvt_pk_bf16_f32 v177, v246, v247
    v_accvgpr_read_b32 v244, a16
    v_accvgpr_read_b32 v245, a20
    v_cvt_pk_bf16_f32 v178, v244, v245
    v_accvgpr_read_b32 v246, a24
    v_accvgpr_read_b32 v247, a28
    v_cvt_pk_bf16_f32 v179, v246, v247
    s_nop 1
    v_mfma_f32_16x16x32_bf16 v[128:131], a[192:195], v[176:179], 0
    s_add_u32 m0, s68, 0
    v_accvgpr_read_b32 v244, a1
    v_accvgpr_read_b32 v245, a5
    v_cvt_pk_bf16_f32 v180, v244, v245
    v_mfma_f32_16x16x32_bf16 v[132:135], a[208:211], v[176:179], 0
    buffer_load_dwordx4 v226, s[32:35], s60 offen offset:0 lds
    v_accvgpr_read_b32 v246, a9
    v_mfma_f32_16x16x32_bf16 v[136:139], a[224:227], v[176:179], 0
    v_accvgpr_read_b32 v247, a13
    v_cvt_pk_bf16_f32 v181, v246, v247
    v_accvgpr_read_b32 v244, a17
    v_mfma_f32_16x16x32_bf16 v[140:143], a[240:243], v[176:179], 0
    v_accvgpr_read_b32 v245, a21
    v_cvt_pk_bf16_f32 v182, v244, v245
    v_accvgpr_read_b32 v246, a25
    v_mfma_f32_16x16x32_bf16 v[144:147], v[192:195], v[176:179], 0
    s_waitcnt lgkmcnt(3)
    v_accvgpr_read_b32 v247, a29
    v_cvt_pk_bf16_f32 v183, v246, v247
    v_accvgpr_read_b32 v244, a2
    v_mfma_f32_16x16x32_bf16 v[148:151], v[208:211], v[176:179], 0
    v_accvgpr_read_b32 v245, a6
    v_cvt_pk_bf16_f32 v184, v244, v245
    v_accvgpr_read_b32 v246, a10
    v_mfma_f32_16x16x32_bf16 v[128:131], a[196:199], v[180:183], v[128:131]
    v_accvgpr_read_b32 v247, a14
    v_cvt_pk_bf16_f32 v185, v246, v247
    v_accvgpr_read_b32 v244, a18
    v_mfma_f32_16x16x32_bf16 v[132:135], a[212:215], v[180:183], v[132:135]
    s_add_u32 m0, s68, 896
    v_accvgpr_read_b32 v245, a22
    v_cvt_pk_bf16_f32 v186, v244, v245
    v_accvgpr_read_b32 v246, a26
    v_mfma_f32_16x16x32_bf16 v[136:139], a[228:231], v[180:183], v[136:139]
    buffer_load_dwordx4 v226, s[32:35], s60 offen offset:128 lds
    v_accvgpr_read_b32 v247, a30
    v_mfma_f32_16x16x32_bf16 v[140:143], a[244:247], v[180:183], v[140:143]
    v_cvt_pk_bf16_f32 v187, v246, v247
    v_accvgpr_read_b32 v244, a3
    v_accvgpr_read_b32 v245, a7
    v_mfma_f32_16x16x32_bf16 v[144:147], v[196:199], v[180:183], v[144:147]
    s_waitcnt lgkmcnt(2)
    v_cvt_pk_bf16_f32 v188, v244, v245
    v_accvgpr_read_b32 v246, a11
    v_accvgpr_read_b32 v247, a15
    v_mfma_f32_16x16x32_bf16 v[148:151], v[212:215], v[180:183], v[148:151]
    v_cvt_pk_bf16_f32 v189, v246, v247
    v_accvgpr_read_b32 v244, a19
    v_accvgpr_read_b32 v245, a23
    v_mfma_f32_16x16x32_bf16 v[128:131], a[200:203], v[184:187], v[128:131]
    v_cvt_pk_bf16_f32 v190, v244, v245
    v_accvgpr_read_b32 v246, a27
    v_accvgpr_read_b32 v247, a31
    v_mfma_f32_16x16x32_bf16 v[132:135], a[216:219], v[184:187], v[132:135]
    v_cvt_pk_bf16_f32 v191, v246, v247
    v_accvgpr_read_b32 v244, a32
    v_accvgpr_read_b32 v245, a36
    v_mfma_f32_16x16x32_bf16 v[136:139], a[232:235], v[184:187], v[136:139]
    v_cvt_pk_bf16_f32 v176, v244, v245
    v_accvgpr_read_b32 v246, a40
    v_accvgpr_read_b32 v247, a44
    v_mfma_f32_16x16x32_bf16 v[140:143], a[248:251], v[184:187], v[140:143]
    s_add_u32 m0, s68, 0
    v_cvt_pk_bf16_f32 v177, v246, v247
    v_accvgpr_read_b32 v244, a48
    v_accvgpr_read_b32 v245, a52
    v_mfma_f32_16x16x32_bf16 v[144:147], v[200:203], v[184:187], v[144:147]
    s_waitcnt lgkmcnt(1)
    buffer_load_dwordx4 v226, s[32:35], s60 offen offset:2048 lds
    v_cvt_pk_bf16_f32 v178, v244, v245
    v_mfma_f32_16x16x32_bf16 v[148:151], v[216:219], v[184:187], v[148:151]
    v_accvgpr_read_b32 v246, a56
    v_accvgpr_read_b32 v247, a60
    v_cvt_pk_bf16_f32 v179, v246, v247
    v_mfma_f32_16x16x32_bf16 v[128:131], a[204:207], v[188:191], v[128:131]
    v_accvgpr_read_b32 v244, a33
    v_accvgpr_read_b32 v245, a37
    v_cvt_pk_bf16_f32 v180, v244, v245
    v_mfma_f32_16x16x32_bf16 v[132:135], a[220:223], v[188:191], v[132:135]
    v_accvgpr_read_b32 v246, a41
    v_accvgpr_read_b32 v247, a45
    v_cvt_pk_bf16_f32 v181, v246, v247
    v_mfma_f32_16x16x32_bf16 v[136:139], a[236:239], v[188:191], v[136:139]
    v_accvgpr_read_b32 v244, a49
    v_accvgpr_read_b32 v245, a53
    v_cvt_pk_bf16_f32 v182, v244, v245
    v_mfma_f32_16x16x32_bf16 v[140:143], a[252:255], v[188:191], v[140:143]
    v_accvgpr_read_b32 v246, a57
    v_accvgpr_read_b32 v247, a61
    v_cvt_pk_bf16_f32 v183, v246, v247
    v_mfma_f32_16x16x32_bf16 v[144:147], v[204:207], v[188:191], v[144:147]
    s_waitcnt lgkmcnt(0)
    v_accvgpr_read_b32 v244, a34
    v_accvgpr_read_b32 v245, a38
    v_cvt_pk_bf16_f32 v184, v244, v245
    v_mfma_f32_16x16x32_bf16 v[148:151], v[220:223], v[188:191], v[148:151]
    s_add_u32 m0, s68, 896
    v_accvgpr_read_b32 v246, a42
    v_accvgpr_read_b32 v247, a46
    v_cvt_pk_bf16_f32 v185, v246, v247
    v_mfma_f32_16x16x32_bf16 v[152:155], a[192:195], v[176:179], 0
    buffer_load_dwordx4 v226, s[32:35], s60 offen offset:2176 lds
    v_accvgpr_read_b32 v244, a50
    v_mfma_f32_16x16x32_bf16 v[156:159], a[208:211], v[176:179], 0
    v_accvgpr_read_b32 v245, a54
    v_cvt_pk_bf16_f32 v186, v244, v245
    v_accvgpr_read_b32 v246, a58
    v_mfma_f32_16x16x32_bf16 v[160:163], a[224:227], v[176:179], 0
    v_accvgpr_read_b32 v247, a62
    v_cvt_pk_bf16_f32 v187, v246, v247
    v_accvgpr_read_b32 v244, a35
    v_mfma_f32_16x16x32_bf16 v[164:167], a[240:243], v[176:179], 0
    v_accvgpr_read_b32 v245, a39
    v_cvt_pk_bf16_f32 v188, v244, v245
    v_accvgpr_read_b32 v246, a43
    v_mfma_f32_16x16x32_bf16 v[168:171], v[192:195], v[176:179], 0
    v_accvgpr_read_b32 v247, a47
    v_cvt_pk_bf16_f32 v189, v246, v247
    v_accvgpr_read_b32 v244, a51
    v_mfma_f32_16x16x32_bf16 v[172:175], v[208:211], v[176:179], 0
    v_accvgpr_read_b32 v245, a55
    v_cvt_pk_bf16_f32 v190, v244, v245
    v_accvgpr_read_b32 v246, a59
    v_mfma_f32_16x16x32_bf16 v[152:155], a[196:199], v[180:183], v[152:155]
    v_accvgpr_read_b32 v247, a63
    v_cvt_pk_bf16_f32 v191, v246, v247
    v_max3_f32 v248, v128, v129, v130
    v_mfma_f32_16x16x32_bf16 v[156:159], a[212:215], v[180:183], v[156:159]
    s_add_u32 m0, s68, 4096
    v_max3_f32 v248, v248, v131, v132
    v_max3_f32 v248, v248, v133, v134
    v_max3_f32 v248, v248, v135, v136
    v_mfma_f32_16x16x32_bf16 v[160:163], a[228:231], v[180:183], v[160:163]
    buffer_load_dwordx4 v226, s[32:35], s61 offen offset:0 lds
    v_max3_f32 v248, v248, v137, v138
    v_mfma_f32_16x16x32_bf16 v[164:167], a[244:247], v[180:183], v[164:167]
    v_max3_f32 v248, v248, v139, v140
    v_max3_f32 v248, v248, v141, v142
    v_max3_f32 v248, v248, v143, v144
    v_mfma_f32_16x16x32_bf16 v[168:171], v[196:199], v[180:183], v[168:171]
    v_max3_f32 v248, v248, v145, v146
    v_max3_f32 v248, v248, v147, v148
    v_max3_f32 v248, v248, v149, v150
    v_mfma_f32_16x16x32_bf16 v[172:175], v[212:215], v[180:183], v[172:175]
    v_max3_f32 v248, v248, v151, v151
    v_mov_b32 v249, v248
    s_nop 1
    v_permlane32_swap_b32 v248, v249
    v_mfma_f32_16x16x32_bf16 v[152:155], a[200:203], v[184:187], v[152:155]
    v_max_f32 v248, v248, v249
    v_mov_b32 v249, v248
    s_nop 1
    v_permlane16_swap_b32 v248, v249
    v_max_f32 v248, v248, v249
    v_mul_f32 v248, s64, v248
    v_pk_fma_f32 v[128:129], v[128:129], s[64:65], v[248:249] op_sel_hi:[1,0,0] neg_lo:[0,0,1] neg_hi:[0,0,1]
    v_pk_fma_f32 v[130:131], v[130:131], s[64:65], v[248:249] op_sel_hi:[1,0,0] neg_lo:[0,0,1] neg_hi:[0,0,1]
    v_pk_fma_f32 v[132:133], v[132:133], s[64:65], v[248:249] op_sel_hi:[1,0,0] neg_lo:[0,0,1] neg_hi:[0,0,1]
    v_pk_fma_f32 v[134:135], v[134:135], s[64:65], v[248:249] op_sel_hi:[1,0,0] neg_lo:[0,0,1] neg_hi:[0,0,1]
    v_pk_fma_f32 v[136:137], v[136:137], s[64:65], v[248:249] op_sel_hi:[1,0,0] neg_lo:[0,0,1] neg_hi:[0,0,1]
    v_pk_fma_f32 v[138:139], v[138:139], s[64:65], v[248:249] op_sel_hi:[1,0,0] neg_lo:[0,0,1] neg_hi:[0,0,1]
    v_pk_fma_f32 v[140:141], v[140:141], s[64:65], v[248:249] op_sel_hi:[1,0,0] neg_lo:[0,0,1] neg_hi:[0,0,1]
    v_pk_fma_f32 v[142:143], v[142:143], s[64:65], v[248:249] op_sel_hi:[1,0,0] neg_lo:[0,0,1] neg_hi:[0,0,1]
    v_pk_fma_f32 v[144:145], v[144:145], s[64:65], v[248:249] op_sel_hi:[1,0,0] neg_lo:[0,0,1] neg_hi:[0,0,1]
    v_pk_fma_f32 v[146:147], v[146:147], s[64:65], v[248:249] op_sel_hi:[1,0,0] neg_lo:[0,0,1] neg_hi:[0,0,1]
    v_pk_fma_f32 v[148:149], v[148:149], s[64:65], v[248:249] op_sel_hi:[1,0,0] neg_lo:[0,0,1] neg_hi:[0,0,1]
    v_pk_fma_f32 v[150:151], v[150:151], s[64:65], v[248:249] op_sel_hi:[1,0,0] neg_lo:[0,0,1] neg_hi:[0,0,1]
    v_exp_f32 v128, v128
    v_exp_f32 v129, v129
    v_mfma_f32_16x16x32_bf16 v[156:159], a[216:219], v[184:187], v[156:159]
    v_exp_f32 v130, v130
    v_exp_f32 v131, v131
    v_mfma_f32_16x16x32_bf16 v[160:163], a[232:235], v[184:187], v[160:163]
    v_cvt_pk_bf16_f32 v0, v128, v129
    v_exp_f32 v132, v132
    v_mfma_f32_16x16x32_bf16 v[164:167], a[248:251], v[184:187], v[164:167]
    s_add_u32 m0, s68, 4992
    v_exp_f32 v133, v133
    v_cvt_pk_bf16_f32 v1, v130, v131
    v_mfma_f32_16x16x32_bf16 v[168:171], v[200:203], v[184:187], v[168:171]
    buffer_load_dwordx4 v226, s[32:35], s61 offen offset:128 lds
    v_exp_f32 v134, v134
    v_mfma_f32_16x16x32_bf16 v[172:175], v[216:219], v[184:187], v[172:175]
    v_exp_f32 v135, v135
    v_cvt_pk_bf16_f32 v2, v132, v133
    v_mfma_f32_16x16x32_bf16 v[152:155], a[204:207], v[188:191], v[152:155]
    v_exp_f32 v136, v136
    v_exp_f32 v137, v137
    v_mfma_f32_16x16x32_bf16 v[156:159], a[220:223], v[188:191], v[156:159]
    v_cvt_pk_bf16_f32 v3, v134, v135
    v_exp_f32 v138, v138
    v_mfma_f32_16x16x32_bf16 v[160:163], a[236:239], v[188:191], v[160:163]
    v_exp_f32 v139, v139
    v_cvt_pk_bf16_f32 v4, v136, v137
    v_mfma_f32_16x16x32_bf16 v[164:167], a[252:255], v[188:191], v[164:167]
    v_exp_f32 v140, v140
    v_exp_f32 v141, v141
    v_mfma_f32_16x16x32_bf16 v[168:171], v[204:207], v[188:191], v[168:171]
    v_cvt_pk_bf16_f32 v5, v138, v139
    v_exp_f32 v142, v142
    v_mfma_f32_16x16x32_bf16 v[172:175], v[220:223], v[188:191], v[172:175]
    s_add_u32 m0, s68, 4096
    v_exp_f32 v143, v143
    v_cvt_pk_bf16_f32 v6, v140, v141
    v_exp_f32 v144, v144
    v_exp_f32 v145, v145
    v_cvt_pk_bf16_f32 v7, v142, v143
    v_exp_f32 v146, v146
    v_exp_f32 v147, v147
    v_cvt_pk_bf16_f32 v8, v144, v145
    v_exp_f32 v148, v148
    v_exp_f32 v149, v149
    v_cvt_pk_bf16_f32 v9, v146, v147
    v_exp_f32 v150, v150
    v_exp_f32 v151, v151
    v_cvt_pk_bf16_f32 v10, v148, v149
    v_cvt_pk_bf16_f32 v11, v150, v151
    v_add_u32 v236, s68, v227
    v_xor_b32 v237, 32, v236
    v_xor_b32 v238, 64, v236
    v_xor_b32 v239, 96, v236
    s_waitcnt vmcnt(6)
    ds_read_b64_tr_b16 a[0:1], v236 offset:8192
    ds_read_b64_tr_b16 a[2:3], v236 offset:12288
    ds_read_b64_tr_b16 a[4:5], v237 offset:8192
    ds_read_b64_tr_b16 a[6:7], v237 offset:12288
    ds_read_b64_tr_b16 a[8:9], v238 offset:8192
    ds_read_b64_tr_b16 a[10:11], v238 offset:12288
    ds_read_b64_tr_b16 a[12:13], v239 offset:8192
    ds_read_b64_tr_b16 a[14:15], v239 offset:12288
    ds_read_b64_tr_b16 a[16:17], v236 offset:9216
    ds_read_b64_tr_b16 a[18:19], v236 offset:13312
    ds_read_b64_tr_b16 a[20:21], v237 offset:9216
    ds_read_b64_tr_b16 a[22:23], v237 offset:13312
    ds_read_b64_tr_b16 a[24:25], v238 offset:9216
    ds_read_b64_tr_b16 a[26:27], v238 offset:13312
    ds_read_b64_tr_b16 a[28:29], v239 offset:9216
    s_waitcnt lgkmcnt(14)
    ds_read_b64_tr_b16 a[30:31], v239 offset:13312
    v_accvgpr_read_b32 v244, a64
    v_accvgpr_read_b32 v245, a68
    v_cvt_pk_bf16_f32 v176, v244, v245
    v_accvgpr_read_b32 v246, a72
    v_accvgpr_read_b32 v247, a76
    v_cvt_pk_bf16_f32 v177, v246, v247
    v_accvgpr_read_b32 v244, a80
    v_accvgpr_read_b32 v245, a84
    v_cvt_pk_bf16_f32 v178, v244, v245
    v_accvgpr_read_b32 v246, a88
    v_accvgpr_read_b32 v247, a92
    v_cvt_pk_bf16_f32 v179, v246, v247
    s_nop 1
    v_mfma_f32_16x16x32_bf16 v[128:131], a[192:195], v[176:179], 0
    buffer_load_dwordx4 v226, s[32:35], s61 offen offset:2048 lds
    v_accvgpr_read_b32 v244, a65
    v_mfma_f32_16x16x32_bf16 v[132:135], a[208:211], v[176:179], 0
    v_accvgpr_read_b32 v245, a69
    v_cvt_pk_bf16_f32 v180, v244, v245
    v_accvgpr_read_b32 v246, a73
    v_mfma_f32_16x16x32_bf16 v[136:139], a[224:227], v[176:179], 0
    v_accvgpr_read_b32 v247, a77
    v_cvt_pk_bf16_f32 v181, v246, v247
    v_accvgpr_read_b32 v244, a81
    v_mfma_f32_16x16x32_bf16 v[140:143], a[240:243], v[176:179], 0
    v_accvgpr_read_b32 v245, a85
    v_cvt_pk_bf16_f32 v182, v244, v245
    v_accvgpr_read_b32 v246, a89
    v_mfma_f32_16x16x32_bf16 v[144:147], v[192:195], v[176:179], 0
    v_accvgpr_read_b32 v247, a93
    v_cvt_pk_bf16_f32 v183, v246, v247
    v_accvgpr_read_b32 v244, a66
    v_mfma_f32_16x16x32_bf16 v[148:151], v[208:211], v[176:179], 0
    v_accvgpr_read_b32 v245, a70
    v_cvt_pk_bf16_f32 v184, v244, v245
    v_accvgpr_read_b32 v246, a74
    v_mfma_f32_16x16x32_bf16 v[128:131], a[196:199], v[180:183], v[128:131]
    v_accvgpr_read_b32 v247, a78
    v_cvt_pk_bf16_f32 v185, v246, v247
    v_accvgpr_read_b32 v244, a82
    v_mfma_f32_16x16x32_bf16 v[132:135], a[212:215], v[180:183], v[132:135]
    s_add_u32 m0, s68, 4992
    v_accvgpr_read_b32 v245, a86
    v_cvt_pk_bf16_f32 v186, v244, v245
    v_accvgpr_read_b32 v246, a90
    v_mfma_f32_16x16x32_bf16 v[136:139], a[228:231], v[180:183], v[136:139]
    buffer_load_dwordx4 v226, s[32:35], s61 offen offset:2176 lds
    v_accvgpr_read_b32 v247, a94
    v_mfma_f32_16x16x32_bf16 v[140:143], a[244:247], v[180:183], v[140:143]
    v_cvt_pk_bf16_f32 v187, v246, v247
    v_accvgpr_read_b32 v244, a67
    v_accvgpr_read_b32 v245, a71
    v_mfma_f32_16x16x32_bf16 v[144:147], v[196:199], v[180:183], v[144:147]
    v_cvt_pk_bf16_f32 v188, v244, v245
    v_accvgpr_read_b32 v246, a75
    v_accvgpr_read_b32 v247, a79
    v_mfma_f32_16x16x32_bf16 v[148:151], v[212:215], v[180:183], v[148:151]
    v_cvt_pk_bf16_f32 v189, v246, v247
    v_accvgpr_read_b32 v244, a83
    v_accvgpr_read_b32 v245, a87
    v_mfma_f32_16x16x32_bf16 v[128:131], a[200:203], v[184:187], v[128:131]
    v_cvt_pk_bf16_f32 v190, v244, v245
    v_accvgpr_read_b32 v246, a91
    v_accvgpr_read_b32 v247, a95
    v_mfma_f32_16x16x32_bf16 v[132:135], a[216:219], v[184:187], v[132:135]
    v_cvt_pk_bf16_f32 v191, v246, v247
    v_max3_f32 v248, v152, v153, v154
    v_max3_f32 v248, v248, v155, v156
    v_mfma_f32_16x16x32_bf16 v[136:139], a[232:235], v[184:187], v[136:139]
    v_max3_f32 v248, v248, v157, v158
    v_max3_f32 v248, v248, v159, v160
    v_max3_f32 v248, v248, v161, v162
    v_mfma_f32_16x16x32_bf16 v[140:143], a[248:251], v[184:187], v[140:143]
    s_add_u32 m0, s8, 0
    v_max3_f32 v248, v248, v163, v164
    v_max3_f32 v248, v248, v165, v166
    v_max3_f32 v248, v248, v167, v168
    v_mfma_f32_16x16x32_bf16 v[144:147], v[200:203], v[184:187], v[144:147]
    buffer_load_dwordx4 v226, s[32:35], s62 offen offset:0 lds
    v_max3_f32 v248, v248, v169, v170
    v_mfma_f32_16x16x32_bf16 v[148:151], v[216:219], v[184:187], v[148:151]
    v_max3_f32 v248, v248, v171, v172
    v_max3_f32 v248, v248, v173, v174
    v_max3_f32 v248, v248, v175, v175
    v_mfma_f32_16x16x32_bf16 v[128:131], a[204:207], v[188:191], v[128:131]
    v_mov_b32 v249, v248
    s_nop 1
    v_permlane32_swap_b32 v248, v249
    v_max_f32 v248, v248, v249
    v_mfma_f32_16x16x32_bf16 v[132:135], a[220:223], v[188:191], v[132:135]
    v_mov_b32 v249, v248
    s_nop 1
    v_permlane16_swap_b32 v248, v249
    v_max_f32 v248, v248, v249
    v_mul_f32 v248, s64, v248
    v_pk_fma_f32 v[152:153], v[152:153], s[64:65], v[248:249] op_sel_hi:[1,0,0] neg_lo:[0,0,1] neg_hi:[0,0,1]
    v_pk_fma_f32 v[154:155], v[154:155], s[64:65], v[248:249] op_sel_hi:[1,0,0] neg_lo:[0,0,1] neg_hi:[0,0,1]
    v_pk_fma_f32 v[156:157], v[156:157], s[64:65], v[248:249] op_sel_hi:[1,0,0] neg_lo:[0,0,1] neg_hi:[0,0,1]
    v_pk_fma_f32 v[158:159], v[158:159], s[64:65], v[248:249] op_sel_hi:[1,0,0] neg_lo:[0,0,1] neg_hi:[0,0,1]
    v_pk_fma_f32 v[160:161], v[160:161], s[64:65], v[248:249] op_sel_hi:[1,0,0] neg_lo:[0,0,1] neg_hi:[0,0,1]
    v_pk_fma_f32 v[162:163], v[162:163], s[64:65], v[248:249] op_sel_hi:[1,0,0] neg_lo:[0,0,1] neg_hi:[0,0,1]
    v_pk_fma_f32 v[164:165], v[164:165], s[64:65], v[248:249] op_sel_hi:[1,0,0] neg_lo:[0,0,1] neg_hi:[0,0,1]
    v_pk_fma_f32 v[166:167], v[166:167], s[64:65], v[248:249] op_sel_hi:[1,0,0] neg_lo:[0,0,1] neg_hi:[0,0,1]
    v_pk_fma_f32 v[168:169], v[168:169], s[64:65], v[248:249] op_sel_hi:[1,0,0] neg_lo:[0,0,1] neg_hi:[0,0,1]
    v_pk_fma_f32 v[170:171], v[170:171], s[64:65], v[248:249] op_sel_hi:[1,0,0] neg_lo:[0,0,1] neg_hi:[0,0,1]
    v_pk_fma_f32 v[172:173], v[172:173], s[64:65], v[248:249] op_sel_hi:[1,0,0] neg_lo:[0,0,1] neg_hi:[0,0,1]
    v_pk_fma_f32 v[174:175], v[174:175], s[64:65], v[248:249] op_sel_hi:[1,0,0] neg_lo:[0,0,1] neg_hi:[0,0,1]
    v_exp_f32 v152, v152
    v_exp_f32 v153, v153
    v_mfma_f32_16x16x32_bf16 v[136:139], a[236:239], v[188:191], v[136:139]
    v_exp_f32 v154, v154
    v_exp_f32 v155, v155
    v_mfma_f32_16x16x32_bf16 v[140:143], a[252:255], v[188:191], v[140:143]
    v_cvt_pk_bf16_f32 v12, v152, v153
    v_exp_f32 v156, v156
    v_mfma_f32_16x16x32_bf16 v[144:147], v[204:207], v[188:191], v[144:147]
    v_exp_f32 v157, v157
    v_cvt_pk_bf16_f32 v13, v154, v155
    v_mfma_f32_16x16x32_bf16 v[148:151], v[220:223], v[188:191], v[148:151]
    s_waitcnt lgkmcnt(14)
    s_add_u32 m0, s8, 896
    v_exp_f32 v158, v158
    v_exp_f32 v159, v159
    v_mfma_f32_16x16x32_bf16 v[72:75], a[0:3], v[0:3], 0
    s_waitcnt lgkmcnt(12)
    buffer_load_dwordx4 v226, s[32:35], s62 offen offset:128 lds
    v_cvt_pk_bf16_f32 v14, v156, v157
    v_mfma_f32_16x16x32_bf16 v[76:79], a[4:7], v[0:3], 0
    s_waitcnt lgkmcnt(10)
    v_exp_f32 v160, v160
    v_exp_f32 v161, v161
    v_mfma_f32_16x16x32_bf16 v[80:83], a[8:11], v[0:3], 0
    s_waitcnt lgkmcnt(8)
    v_cvt_pk_bf16_f32 v15, v158, v159
    v_exp_f32 v162, v162
    v_mfma_f32_16x16x32_bf16 v[84:87], a[12:15], v[0:3], 0
    s_waitcnt lgkmcnt(6)
    v_exp_f32 v163, v163
    v_cvt_pk_bf16_f32 v16, v160, v161
    v_mfma_f32_16x16x32_bf16 v[88:91], a[16:19], v[0:3], 0
    s_waitcnt lgkmcnt(4)
    v_exp_f32 v164, v164
    v_exp_f32 v165, v165
    v_mfma_f32_16x16x32_bf16 v[92:95], a[20:23], v[0:3], 0
    s_waitcnt lgkmcnt(2)
    v_cvt_pk_bf16_f32 v17, v162, v163
    v_exp_f32 v166, v166
    v_mfma_f32_16x16x32_bf16 v[96:99], a[24:27], v[0:3], 0
    s_waitcnt lgkmcnt(0)
    v_exp_f32 v167, v167
    v_cvt_pk_bf16_f32 v18, v164, v165
    v_mfma_f32_16x16x32_bf16 v[100:103], a[28:31], v[0:3], 0
    s_add_u32 m0, s8, 0
    v_exp_f32 v168, v168
    v_exp_f32 v169, v169
    v_cvt_pk_bf16_f32 v19, v166, v167
    v_exp_f32 v170, v170
    v_exp_f32 v171, v171
    v_cvt_pk_bf16_f32 v20, v168, v169
    v_exp_f32 v172, v172
    v_exp_f32 v173, v173
    v_cvt_pk_bf16_f32 v21, v170, v171
    v_exp_f32 v174, v174
    v_exp_f32 v175, v175
    v_cvt_pk_bf16_f32 v22, v172, v173
    v_cvt_pk_bf16_f32 v23, v174, v175
    v_accvgpr_read_b32 v244, a96
    v_accvgpr_read_b32 v245, a100
    v_cvt_pk_bf16_f32 v176, v244, v245
    v_accvgpr_read_b32 v246, a104
    v_accvgpr_read_b32 v247, a108
    v_cvt_pk_bf16_f32 v177, v246, v247
    v_accvgpr_read_b32 v244, a112
    v_accvgpr_read_b32 v245, a116
    v_cvt_pk_bf16_f32 v178, v244, v245
    v_accvgpr_read_b32 v246, a120
    v_accvgpr_read_b32 v247, a124
    v_cvt_pk_bf16_f32 v179, v246, v247
    s_nop 1
    v_mfma_f32_16x16x32_bf16 v[152:155], a[192:195], v[176:179], 0
    buffer_load_dwordx4 v226, s[32:35], s62 offen offset:2048 lds
    v_accvgpr_read_b32 v244, a97
    v_mfma_f32_16x16x32_bf16 v[156:159], a[208:211], v[176:179], 0
    v_accvgpr_read_b32 v245, a101
    v_cvt_pk_bf16_f32 v180, v244, v245
    v_accvgpr_read_b32 v246, a105
    v_mfma_f32_16x16x32_bf16 v[160:163], a[224:227], v[176:179], 0
    v_accvgpr_read_b32 v247, a109
    v_cvt_pk_bf16_f32 v181, v246, v247
    v_accvgpr_read_b32 v244, a113
    v_mfma_f32_16x16x32_bf16 v[164:167], a[240:243], v[176:179], 0
    v_accvgpr_read_b32 v245, a117
    v_cvt_pk_bf16_f32 v182, v244, v245
    v_accvgpr_read_b32 v246, a121
    v_mfma_f32_16x16x32_bf16 v[168:171], v[192:195], v[176:179], 0
    v_accvgpr_read_b32 v247, a125
    v_cvt_pk_bf16_f32 v183, v246, v247
    v_accvgpr_read_b32 v244, a98
    v_mfma_f32_16x16x32_bf16 v[172:175], v[208:211], v[176:179], 0
    v_accvgpr_read_b32 v245, a102
    v_cvt_pk_bf16_f32 v184, v244, v245
    v_accvgpr_read_b32 v246, a106
    v_mfma_f32_16x16x32_bf16 v[152:155], a[196:199], v[180:183], v[152:155]
    v_accvgpr_read_b32 v247, a110
    v_cvt_pk_bf16_f32 v185, v246, v247
    v_accvgpr_read_b32 v244, a114
    v_mfma_f32_16x16x32_bf16 v[156:159], a[212:215], v[180:183], v[156:159]
    s_add_u32 m0, s8, 896
    v_accvgpr_read_b32 v245, a118
    v_cvt_pk_bf16_f32 v186, v244, v245
    v_accvgpr_read_b32 v246, a122
    v_mfma_f32_16x16x32_bf16 v[160:163], a[228:231], v[180:183], v[160:163]
    buffer_load_dwordx4 v226, s[32:35], s62 offen offset:2176 lds
    v_accvgpr_read_b32 v247, a126
    v_mfma_f32_16x16x32_bf16 v[164:167], a[244:247], v[180:183], v[164:167]
    v_cvt_pk_bf16_f32 v187, v246, v247
    v_accvgpr_read_b32 v244, a99
    v_accvgpr_read_b32 v245, a103
    v_mfma_f32_16x16x32_bf16 v[168:171], v[196:199], v[180:183], v[168:171]
    v_cvt_pk_bf16_f32 v188, v244, v245
    v_accvgpr_read_b32 v246, a107
    v_accvgpr_read_b32 v247, a111
    v_mfma_f32_16x16x32_bf16 v[172:175], v[212:215], v[180:183], v[172:175]
    v_cvt_pk_bf16_f32 v189, v246, v247
    v_accvgpr_read_b32 v244, a115
    v_accvgpr_read_b32 v245, a119
    v_mfma_f32_16x16x32_bf16 v[152:155], a[200:203], v[184:187], v[152:155]
    v_cvt_pk_bf16_f32 v190, v244, v245
    v_accvgpr_read_b32 v246, a123
    v_accvgpr_read_b32 v247, a127
    v_mfma_f32_16x16x32_bf16 v[156:159], a[216:219], v[184:187], v[156:159]
    v_cvt_pk_bf16_f32 v191, v246, v247
    v_mov_b32 v250, 0x3f803f80
    v_accvgpr_write_b32 a96, v250
    v_mfma_f32_16x16x32_bf16 v[160:163], a[232:235], v[184:187], v[160:163]
    v_accvgpr_write_b32 a97, v250
    v_accvgpr_write_b32 a98, v250
    v_accvgpr_write_b32 a99, v250
    v_mfma_f32_16x16x32_bf16 v[164:167], a[248:251], v[184:187], v[164:167]
    s_add_u32 m0, s8, 4096
    v_max3_f32 v248, v128, v129, v130
    v_max3_f32 v248, v248, v131, v132
    v_max3_f32 v248, v248, v133, v134
    v_mfma_f32_16x16x32_bf16 v[168:171], v[200:203], v[184:187], v[168:171]
    buffer_load_dwordx4 v226, s[32:35], s63 offen offset:0 lds
    v_max3_f32 v248, v248, v135, v136
    v_mfma_f32_16x16x32_bf16 v[172:175], v[216:219], v[184:187], v[172:175]
    v_max3_f32 v248, v248, v137, v138
    v_max3_f32 v248, v248, v139, v140
    v_max3_f32 v248, v248, v141, v142
    v_mfma_f32_16x16x32_bf16 v[152:155], a[204:207], v[188:191], v[152:155]
    v_max3_f32 v248, v248, v143, v144
    v_max3_f32 v248, v248, v145, v146
    v_max3_f32 v248, v248, v147, v148
    v_mfma_f32_16x16x32_bf16 v[156:159], a[220:223], v[188:191], v[156:159]
    v_max3_f32 v248, v248, v149, v150
    v_max3_f32 v248, v248, v151, v151
    v_mov_b32 v249, v248
    v_mfma_f32_16x16x32_bf16 v[160:163], a[236:239], v[188:191], v[160:163]
    s_nop 0
    v_permlane32_swap_b32 v248, v249
    v_max_f32 v248, v248, v249
    v_mov_b32 v249, v248
    s_nop 1
    v_permlane16_swap_b32 v248, v249
    v_max_f32 v248, v248, v249
    v_mul_f32 v248, s64, v248
    v_pk_fma_f32 v[128:129], v[128:129], s[64:65], v[248:249] op_sel_hi:[1,0,0] neg_lo:[0,0,1] neg_hi:[0,0,1]
    v_pk_fma_f32 v[130:131], v[130:131], s[64:65], v[248:249] op_sel_hi:[1,0,0] neg_lo:[0,0,1] neg_hi:[0,0,1]
    v_pk_fma_f32 v[132:133], v[132:133], s[64:65], v[248:249] op_sel_hi:[1,0,0] neg_lo:[0,0,1] neg_hi:[0,0,1]
    v_pk_fma_f32 v[134:135], v[134:135], s[64:65], v[248:249] op_sel_hi:[1,0,0] neg_lo:[0,0,1] neg_hi:[0,0,1]
    v_pk_fma_f32 v[136:137], v[136:137], s[64:65], v[248:249] op_sel_hi:[1,0,0] neg_lo:[0,0,1] neg_hi:[0,0,1]
    v_pk_fma_f32 v[138:139], v[138:139], s[64:65], v[248:249] op_sel_hi:[1,0,0] neg_lo:[0,0,1] neg_hi:[0,0,1]
    v_pk_fma_f32 v[140:141], v[140:141], s[64:65], v[248:249] op_sel_hi:[1,0,0] neg_lo:[0,0,1] neg_hi:[0,0,1]
    v_pk_fma_f32 v[142:143], v[142:143], s[64:65], v[248:249] op_sel_hi:[1,0,0] neg_lo:[0,0,1] neg_hi:[0,0,1]
    v_pk_fma_f32 v[144:145], v[144:145], s[64:65], v[248:249] op_sel_hi:[1,0,0] neg_lo:[0,0,1] neg_hi:[0,0,1]
    v_pk_fma_f32 v[146:147], v[146:147], s[64:65], v[248:249] op_sel_hi:[1,0,0] neg_lo:[0,0,1] neg_hi:[0,0,1]
    v_pk_fma_f32 v[148:149], v[148:149], s[64:65], v[248:249] op_sel_hi:[1,0,0] neg_lo:[0,0,1] neg_hi:[0,0,1]
    v_pk_fma_f32 v[150:151], v[150:151], s[64:65], v[248:249] op_sel_hi:[1,0,0] neg_lo:[0,0,1] neg_hi:[0,0,1]
    v_exp_f32 v128, v128
    v_exp_f32 v129, v129
    v_mfma_f32_16x16x32_bf16 v[164:167], a[252:255], v[188:191], v[164:167]
    v_exp_f32 v130, v130
    v_exp_f32 v131, v131
    v_mfma_f32_16x16x32_bf16 v[168:171], v[204:207], v[188:191], v[168:171]
    v_cvt_pk_bf16_f32 v24, v128, v129
    v_exp_f32 v132, v132
    v_mfma_f32_16x16x32_bf16 v[172:175], v[220:223], v[188:191], v[172:175]
    s_add_u32 m0, s8, 4992
    v_exp_f32 v133, v133
    v_cvt_pk_bf16_f32 v25, v130, v131
    v_mfma_f32_16x16x32_bf16 v[104:107], a[0:3], v[12:15], 0
    buffer_load_dwordx4 v226, s[32:35], s63 offen offset:128 lds
    v_exp_f32 v134, v134
    v_mfma_f32_16x16x32_bf16 v[108:111], a[4:7], v[12:15], 0
    v_exp_f32 v135, v135
    v_cvt_pk_bf16_f32 v26, v132, v133
    v_mfma_f32_16x16x32_bf16 v[112:115], a[8:11], v[12:15], 0
    v_exp_f32 v136, v136
    v_exp_f32 v137, v137
    v_mfma_f32_16x16x32_bf16 v[116:119], a[12:15], v[12:15], 0
    v_cvt_pk_bf16_f32 v27, v134, v135
    v_exp_f32 v138, v138
    v_mfma_f32_16x16x32_bf16 v[120:123], a[16:19], v[12:15], 0
    v_exp_f32 v139, v139
    v_cvt_pk_bf16_f32 v28, v136, v137
    v_mfma_f32_16x16x32_bf16 v[124:127], a[20:23], v[12:15], 0
    v_exp_f32 v140, v140
    v_exp_f32 v141, v141
    v_mfma_f32_16x16x32_bf16 v[228:231], a[24:27], v[12:15], 0
    v_cvt_pk_bf16_f32 v29, v138, v139
    v_exp_f32 v142, v142
    v_mfma_f32_16x16x32_bf16 v[232:235], a[28:31], v[12:15], 0
    s_add_u32 m0, s8, 4096
    v_exp_f32 v143, v143
    v_cvt_pk_bf16_f32 v30, v140, v141
    v_mfma_f32_16x16x32_bf16 a[100:103], a[96:99], v[0:3], 0
    buffer_load_dwordx4 v226, s[32:35], s63 offen offset:2048 lds
    v_exp_f32 v144, v144
    v_mfma_f32_16x16x32_bf16 a[100:103], a[96:99], v[4:7], a[100:103]
    v_exp_f32 v145, v145
    v_cvt_pk_bf16_f32 v31, v142, v143
    v_mfma_f32_16x16x32_bf16 a[100:103], a[96:99], v[8:11], a[100:103]
    v_exp_f32 v146, v146
    v_exp_f32 v147, v147
    v_mfma_f32_16x16x32_bf16 a[104:107], a[96:99], v[12:15], 0
    v_cvt_pk_bf16_f32 v32, v144, v145
    v_exp_f32 v148, v148
    v_mfma_f32_16x16x32_bf16 a[104:107], a[96:99], v[16:19], a[104:107]
    v_exp_f32 v149, v149
    v_cvt_pk_bf16_f32 v33, v146, v147
    v_mfma_f32_16x16x32_bf16 a[104:107], a[96:99], v[20:23], a[104:107]
    v_exp_f32 v150, v150
    v_exp_f32 v151, v151
    v_cvt_pk_bf16_f32 v34, v148, v149
    v_cvt_pk_bf16_f32 v35, v150, v151
    v_accvgpr_read_b32 v244, a128
    v_accvgpr_read_b32 v245, a132
    v_cvt_pk_bf16_f32 v176, v244, v245
    v_accvgpr_read_b32 v246, a136
    v_accvgpr_read_b32 v247, a140
    v_cvt_pk_bf16_f32 v177, v246, v247
    v_accvgpr_read_b32 v244, a144
    v_accvgpr_read_b32 v245, a148
    v_cvt_pk_bf16_f32 v178, v244, v245
    v_accvgpr_read_b32 v246, a152
    v_accvgpr_read_b32 v247, a156
    v_cvt_pk_bf16_f32 v179, v246, v247
    s_nop 1
    v_mfma_f32_16x16x32_bf16 v[128:131], a[192:195], v[176:179], 0
    v_accvgpr_read_b32 v244, a129
    v_accvgpr_read_b32 v245, a133
    v_cvt_pk_bf16_f32 v180, v244, v245
    v_mfma_f32_16x16x32_bf16 v[132:135], a[208:211], v[176:179], 0
    s_add_u32 m0, s8, 4992
    v_accvgpr_read_b32 v246, a137
    v_accvgpr_read_b32 v247, a141
    v_cvt_pk_bf16_f32 v181, v246, v247
    v_mfma_f32_16x16x32_bf16 v[136:139], a[224:227], v[176:179], 0
    buffer_load_dwordx4 v226, s[32:35], s63 offen offset:2176 lds
    v_accvgpr_read_b32 v244, a145
    v_mfma_f32_16x16x32_bf16 v[140:143], a[240:243], v[176:179], 0
    s_add_u32 s70, s69, L_pC-L_k1_start
    v_accvgpr_read_b32 v245, a149
    v_cvt_pk_bf16_f32 v182, v244, v245
    v_accvgpr_read_b32 v246, a153
    v_mfma_f32_16x16x32_bf16 v[144:147], v[192:195], v[176:179], 0
    buffer_load_dword v225, v254, s[72:75], s70 offen
    v_accvgpr_read_b32 v247, a157
    v_mfma_f32_16x16x32_bf16 v[148:151], v[208:211], v[176:179], 0
    v_cvt_pk_bf16_f32 v183, v246, v247
    v_accvgpr_read_b32 v244, a130
    v_accvgpr_read_b32 v245, a134
    v_mfma_f32_16x16x32_bf16 v[128:131], a[196:199], v[180:183], v[128:131]
    v_cvt_pk_bf16_f32 v184, v244, v245
    v_accvgpr_read_b32 v246, a138
    v_accvgpr_read_b32 v247, a142
    v_mfma_f32_16x16x32_bf16 v[132:135], a[212:215], v[180:183], v[132:135]
    v_cvt_pk_bf16_f32 v185, v246, v247
    v_accvgpr_read_b32 v244, a146
    v_accvgpr_read_b32 v245, a150
    v_mfma_f32_16x16x32_bf16 v[136:139], a[228:231], v[180:183], v[136:139]
    v_cvt_pk_bf16_f32 v186, v244, v245
    v_accvgpr_read_b32 v246, a154
    v_accvgpr_read_b32 v247, a158
    v_mfma_f32_16x16x32_bf16 v[140:143], a[244:247], v[180:183], v[140:143]
    v_cvt_pk_bf16_f32 v187, v246, v247
    v_accvgpr_read_b32 v244, a131
    v_accvgpr_read_b32 v245, a135
    v_mfma_f32_16x16x32_bf16 v[144:147], v[196:199], v[180:183], v[144:147]
    v_cvt_pk_bf16_f32 v188, v244, v245
    v_accvgpr_read_b32 v246, a139
    v_accvgpr_read_b32 v247, a143
    v_mfma_f32_16x16x32_bf16 v[148:151], v[212:215], v[180:183], v[148:151]
    v_cvt_pk_bf16_f32 v189, v246, v247
    v_accvgpr_read_b32 v244, a147
    v_accvgpr_read_b32 v245, a151
    v_mfma_f32_16x16x32_bf16 v[128:131], a[200:203], v[184:187], v[128:131]
    v_cvt_pk_bf16_f32 v190, v244, v245
    v_accvgpr_read_b32 v246, a155
    v_accvgpr_read_b32 v247, a159
    v_mfma_f32_16x16x32_bf16 v[132:135], a[216:219], v[184:187], v[132:135]
    s_waitcnt vmcnt(9)
    v_cvt_pk_bf16_f32 v191, v246, v247
    ds_read_b64_tr_b16 a[32:33], v236 offset:0
    ds_read_b64_tr_b16 a[34:35], v236 offset:4096
    ds_read_b64_tr_b16 a[36:37], v237 offset:0
    ds_read_b64_tr_b16 a[38:39], v237 offset:4096
    v_mfma_f32_16x16x32_bf16 v[136:139], a[232:235], v[184:187], v[136:139]
    ds_read_b64_tr_b16 a[40:41], v238 offset:0
    ds_read_b64_tr_b16 a[42:43], v238 offset:4096
    ds_read_b64_tr_b16 a[44:45], v239 offset:0
    ds_read_b64_tr_b16 a[46:47], v239 offset:4096
    v_mfma_f32_16x16x32_bf16 v[140:143], a[248:251], v[184:187], v[140:143]
    ds_read_b64_tr_b16 a[48:49], v236 offset:1024
    ds_read_b64_tr_b16 a[50:51], v236 offset:5120
    ds_read_b64_tr_b16 a[52:53], v237 offset:1024
    ds_read_b64_tr_b16 a[54:55], v237 offset:5120
    v_mfma_f32_16x16x32_bf16 v[144:147], v[200:203], v[184:187], v[144:147]
    s_waitcnt lgkmcnt(11)
    ds_read_b64_tr_b16 a[56:57], v238 offset:1024
    ds_read_b64_tr_b16 a[58:59], v238 offset:5120
    ds_read_b64_tr_b16 a[60:61], v239 offset:1024
    ds_read_b64_tr_b16 a[62:63], v239 offset:5120
    v_mfma_f32_16x16x32_bf16 v[148:151], v[216:219], v[184:187], v[148:151]
    v_max3_f32 v248, v152, v153, v154
    v_max3_f32 v248, v248, v155, v156
    v_max3_f32 v248, v248, v157, v158
    v_mfma_f32_16x16x32_bf16 v[128:131], a[204:207], v[188:191], v[128:131]
    v_max3_f32 v248, v248, v159, v160
    v_max3_f32 v248, v248, v161, v162
    v_max3_f32 v248, v248, v163, v164
    v_mfma_f32_16x16x32_bf16 v[132:135], a[220:223], v[188:191], v[132:135]
    v_max3_f32 v248, v248, v165, v166
    v_max3_f32 v248, v248, v167, v168
    v_max3_f32 v248, v248, v169, v170
    v_mfma_f32_16x16x32_bf16 v[136:139], a[236:239], v[188:191], v[136:139]
    v_max3_f32 v248, v248, v171, v172
    v_max3_f32 v248, v248, v173, v174
    v_max3_f32 v248, v248, v175, v175
    v_mfma_f32_16x16x32_bf16 v[140:143], a[252:255], v[188:191], v[140:143]
    v_mov_b32 v249, v248
    s_nop 1
    v_permlane32_swap_b32 v248, v249
    v_max_f32 v248, v248, v249
    v_mfma_f32_16x16x32_bf16 v[144:147], v[204:207], v[188:191], v[144:147]
    v_mov_b32 v249, v248
    s_nop 1
    v_permlane16_swap_b32 v248, v249
    v_max_f32 v248, v248, v249
    v_mul_f32 v248, s64, v248
    v_pk_fma_f32 v[152:153], v[152:153], s[64:65], v[248:249] op_sel_hi:[1,0,0] neg_lo:[0,0,1] neg_hi:[0,0,1]
    v_pk_fma_f32 v[154:155], v[154:155], s[64:65], v[248:249] op_sel_hi:[1,0,0] neg_lo:[0,0,1] neg_hi:[0,0,1]
    v_pk_fma_f32 v[156:157], v[156:157], s[64:65], v[248:249] op_sel_hi:[1,0,0] neg_lo:[0,0,1] neg_hi:[0,0,1]
    v_pk_fma_f32 v[158:159], v[158:159], s[64:65], v[248:249] op_sel_hi:[1,0,0] neg_lo:[0,0,1] neg_hi:[0,0,1]
    v_pk_fma_f32 v[160:161], v[160:161], s[64:65], v[248:249] op_sel_hi:[1,0,0] neg_lo:[0,0,1] neg_hi:[0,0,1]
    v_pk_fma_f32 v[162:163], v[162:163], s[64:65], v[248:249] op_sel_hi:[1,0,0] neg_lo:[0,0,1] neg_hi:[0,0,1]
    v_pk_fma_f32 v[164:165], v[164:165], s[64:65], v[248:249] op_sel_hi:[1,0,0] neg_lo:[0,0,1] neg_hi:[0,0,1]
    v_pk_fma_f32 v[166:167], v[166:167], s[64:65], v[248:249] op_sel_hi:[1,0,0] neg_lo:[0,0,1] neg_hi:[0,0,1]
    v_pk_fma_f32 v[168:169], v[168:169], s[64:65], v[248:249] op_sel_hi:[1,0,0] neg_lo:[0,0,1] neg_hi:[0,0,1]
    v_pk_fma_f32 v[170:171], v[170:171], s[64:65], v[248:249] op_sel_hi:[1,0,0] neg_lo:[0,0,1] neg_hi:[0,0,1]
    v_pk_fma_f32 v[172:173], v[172:173], s[64:65], v[248:249] op_sel_hi:[1,0,0] neg_lo:[0,0,1] neg_hi:[0,0,1]
    v_pk_fma_f32 v[174:175], v[174:175], s[64:65], v[248:249] op_sel_hi:[1,0,0] neg_lo:[0,0,1] neg_hi:[0,0,1]
    v_exp_f32 v152, v152
    v_exp_f32 v153, v153
    v_mfma_f32_16x16x32_bf16 v[148:151], v[220:223], v[188:191], v[148:151]
    s_waitcnt lgkmcnt(14)
    v_exp_f32 v154, v154
    v_exp_f32 v155, v155
    v_mfma_f32_16x16x32_bf16 v[72:75], a[32:35], v[4:7], v[72:75]
    s_waitcnt lgkmcnt(12)
    v_cvt_pk_bf16_f32 v36, v152, v153
    v_exp_f32 v156, v156
    v_mfma_f32_16x16x32_bf16 v[76:79], a[36:39], v[4:7], v[76:79]
    s_waitcnt lgkmcnt(10)
    v_exp_f32 v157, v157
    v_cvt_pk_bf16_f32 v37, v154, v155
    v_mfma_f32_16x16x32_bf16 v[80:83], a[40:43], v[4:7], v[80:83]
    s_waitcnt lgkmcnt(8)
    v_exp_f32 v158, v158
    v_exp_f32 v159, v159
    v_mfma_f32_16x16x32_bf16 v[84:87], a[44:47], v[4:7], v[84:87]
    s_waitcnt lgkmcnt(6)
    v_cvt_pk_bf16_f32 v38, v156, v157
    v_exp_f32 v160, v160
    v_mfma_f32_16x16x32_bf16 v[88:91], a[48:51], v[4:7], v[88:91]
    s_waitcnt lgkmcnt(4)
    v_exp_f32 v161, v161
    v_cvt_pk_bf16_f32 v39, v158, v159
    v_mfma_f32_16x16x32_bf16 v[92:95], a[52:55], v[4:7], v[92:95]
    s_waitcnt lgkmcnt(2)
    v_exp_f32 v162, v162
    v_exp_f32 v163, v163
    v_mfma_f32_16x16x32_bf16 v[96:99], a[56:59], v[4:7], v[96:99]
    s_waitcnt lgkmcnt(0)
    v_cvt_pk_bf16_f32 v40, v160, v161
    v_exp_f32 v164, v164
    v_mfma_f32_16x16x32_bf16 v[100:103], a[60:63], v[4:7], v[100:103]
    v_exp_f32 v165, v165
    v_cvt_pk_bf16_f32 v41, v162, v163
    v_mfma_f32_16x16x32_bf16 v[104:107], a[32:35], v[16:19], v[104:107]
    v_exp_f32 v166, v166
    v_exp_f32 v167, v167
    v_mfma_f32_16x16x32_bf16 v[108:111], a[36:39], v[16:19], v[108:111]
    v_cvt_pk_bf16_f32 v42, v164, v165
    v_exp_f32 v168, v168
    v_mfma_f32_16x16x32_bf16 v[112:115], a[40:43], v[16:19], v[112:115]
    v_exp_f32 v169, v169
    v_cvt_pk_bf16_f32 v43, v166, v167
    v_mfma_f32_16x16x32_bf16 v[116:119], a[44:47], v[16:19], v[116:119]
    v_exp_f32 v170, v170
    v_exp_f32 v171, v171
    v_mfma_f32_16x16x32_bf16 v[120:123], a[48:51], v[16:19], v[120:123]
    v_cvt_pk_bf16_f32 v44, v168, v169
    v_exp_f32 v172, v172
    v_mfma_f32_16x16x32_bf16 v[124:127], a[52:55], v[16:19], v[124:127]
    v_exp_f32 v173, v173
    v_cvt_pk_bf16_f32 v45, v170, v171
    v_mfma_f32_16x16x32_bf16 v[228:231], a[56:59], v[16:19], v[228:231]
    v_exp_f32 v174, v174
    v_exp_f32 v175, v175
    v_mfma_f32_16x16x32_bf16 v[232:235], a[60:63], v[16:19], v[232:235]
    v_cvt_pk_bf16_f32 v46, v172, v173
    v_cvt_pk_bf16_f32 v47, v174, v175
    s_waitcnt lgkmcnt(0)
    s_or_b32 s3, s12, s13
    s_cbranch_scc0 L_tkf
L_tkb:
    s_mov_b64 s[6:7], s[12:13]
    v_mfma_f32_16x16x32_bf16 a[108:111], a[96:99], v[24:27], 0
    v_accvgpr_read_b32 v244, a160
    v_accvgpr_read_b32 v245, a164
    v_cvt_pk_bf16_f32 v176, v244, v245
    v_mfma_f32_16x16x32_bf16 a[108:111], a[96:99], v[28:31], a[108:111]
    v_accvgpr_read_b32 v246, a168
    v_accvgpr_read_b32 v247, a172
    v_cvt_pk_bf16_f32 v177, v246, v247
    v_mfma_f32_16x16x32_bf16 a[108:111], a[96:99], v[32:35], a[108:111]
    v_accvgpr_read_b32 v244, a176
    v_accvgpr_read_b32 v245, a180
    v_cvt_pk_bf16_f32 v178, v244, v245
    v_accvgpr_read_b32 v246, a184
    v_accvgpr_read_b32 v247, a188
    v_cvt_pk_bf16_f32 v179, v246, v247
    s_nop 1
    v_mfma_f32_16x16x32_bf16 v[152:155], a[192:195], v[176:179], 0
    v_accvgpr_read_b32 v244, a161
    v_accvgpr_read_b32 v245, a165
    v_cvt_pk_bf16_f32 v180, v244, v245
    v_mfma_f32_16x16x32_bf16 v[156:159], a[208:211], v[176:179], 0
    v_accvgpr_read_b32 v246, a169
    v_accvgpr_read_b32 v247, a173
    v_cvt_pk_bf16_f32 v181, v246, v247
    v_mfma_f32_16x16x32_bf16 v[160:163], a[224:227], v[176:179], 0
    v_accvgpr_read_b32 v244, a177
    v_accvgpr_read_b32 v245, a181
    v_cvt_pk_bf16_f32 v182, v244, v245
    v_mfma_f32_16x16x32_bf16 v[164:167], a[240:243], v[176:179], 0
    v_accvgpr_read_b32 v246, a185
    v_accvgpr_read_b32 v247, a189
    v_cvt_pk_bf16_f32 v183, v246, v247
    v_mfma_f32_16x16x32_bf16 v[168:171], v[192:195], v[176:179], 0
    v_accvgpr_read_b32 v244, a162
    v_accvgpr_read_b32 v245, a166
    v_cvt_pk_bf16_f32 v184, v244, v245
    v_mfma_f32_16x16x32_bf16 v[172:175], v[208:211], v[176:179], 0
    v_accvgpr_read_b32 v246, a170
    v_accvgpr_read_b32 v247, a174
    v_cvt_pk_bf16_f32 v185, v246, v247
    v_mfma_f32_16x16x32_bf16 v[152:155], a[196:199], v[180:183], v[152:155]
    v_accvgpr_read_b32 v244, a178
    v_accvgpr_read_b32 v245, a182
    v_cvt_pk_bf16_f32 v186, v244, v245
    v_mfma_f32_16x16x32_bf16 v[156:159], a[212:215], v[180:183], v[156:159]
    v_accvgpr_read_b32 v246, a186
    v_accvgpr_read_b32 v247, a190
    v_cvt_pk_bf16_f32 v187, v246, v247
    v_mfma_f32_16x16x32_bf16 v[160:163], a[228:231], v[180:183], v[160:163]
    v_accvgpr_read_b32 v244, a163
    v_accvgpr_read_b32 v245, a167
    v_cvt_pk_bf16_f32 v188, v244, v245
    v_mfma_f32_16x16x32_bf16 v[164:167], a[244:247], v[180:183], v[164:167]
    v_accvgpr_read_b32 v246, a171
    v_accvgpr_read_b32 v247, a175
    v_cvt_pk_bf16_f32 v189, v246, v247
    v_mfma_f32_16x16x32_bf16 v[168:171], v[196:199], v[180:183], v[168:171]
    v_accvgpr_read_b32 v244, a179
    v_accvgpr_read_b32 v245, a183
    v_cvt_pk_bf16_f32 v190, v244, v245
    v_mfma_f32_16x16x32_bf16 v[172:175], v[212:215], v[180:183], v[172:175]
    v_accvgpr_read_b32 v246, a187
    v_accvgpr_read_b32 v247, a191
    v_cvt_pk_bf16_f32 v191, v246, v247
    v_mfma_f32_16x16x32_bf16 v[152:155], a[200:203], v[184:187], v[152:155]
    v_max3_f32 v248, v128, v129, v130
    v_max3_f32 v248, v248, v131, v132
    v_max3_f32 v248, v248, v133, v134
    v_mfma_f32_16x16x32_bf16 v[156:159], a[216:219], v[184:187], v[156:159]
    v_max3_f32 v248, v248, v135, v136
    v_max3_f32 v248, v248, v137, v138
    v_max3_f32 v248, v248, v139, v140
    v_mfma_f32_16x16x32_bf16 v[160:163], a[232:235], v[184:187], v[160:163]
    v_max3_f32 v248, v248, v141, v142
    v_max3_f32 v248, v248, v143, v144
    v_max3_f32 v248, v248, v145, v146
    v_mfma_f32_16x16x32_bf16 v[164:167], a[248:251], v[184:187], v[164:167]
    v_max3_f32 v248, v248, v147, v148
    v_max3_f32 v248, v248, v149, v150
    v_max3_f32 v248, v248, v151, v151
    v_mfma_f32_16x16x32_bf16 v[168:171], v[200:203], v[184:187], v[168:171]
    v_mov_b32 v249, v248
    s_nop 1
    v_permlane32_swap_b32 v248, v249
    v_max_f32 v248, v248, v249
    v_mfma_f32_16x16x32_bf16 v[172:175], v[216:219], v[184:187], v[172:175]
    v_add_u32 v236, s8, v227
    v_xor_b32 v237, 32, v236
    v_xor_b32 v238, 64, v236
    v_mfma_f32_16x16x32_bf16 v[152:155], a[204:207], v[188:191], v[152:155]
    s_waitcnt vmcnt(1)
    v_xor_b32 v239, 96, v236
    ds_read_b64_tr_b16 a[64:65], v236 offset:0
    ds_read_b64_tr_b16 a[66:67], v236 offset:4096
    ds_read_b64_tr_b16 a[68:69], v237 offset:0
    ds_read_b64_tr_b16 a[70:71], v237 offset:4096
    v_mfma_f32_16x16x32_bf16 v[156:159], a[220:223], v[188:191], v[156:159]
    ds_read_b64_tr_b16 a[72:73], v238 offset:0
    ds_read_b64_tr_b16 a[74:75], v238 offset:4096
    ds_read_b64_tr_b16 a[76:77], v239 offset:0
    ds_read_b64_tr_b16 a[78:79], v239 offset:4096
    v_mfma_f32_16x16x32_bf16 v[160:163], a[236:239], v[188:191], v[160:163]
    ds_read_b64_tr_b16 a[80:81], v236 offset:1024
    ds_read_b64_tr_b16 a[82:83], v236 offset:5120
    ds_read_b64_tr_b16 a[84:85], v237 offset:1024
    ds_read_b64_tr_b16 a[86:87], v237 offset:5120
    v_mfma_f32_16x16x32_bf16 v[164:167], a[252:255], v[188:191], v[164:167]
    s_waitcnt lgkmcnt(11)
    ds_read_b64_tr_b16 a[88:89], v238 offset:1024
    ds_read_b64_tr_b16 a[90:91], v238 offset:5120
    ds_read_b64_tr_b16 a[92:93], v239 offset:1024
    ds_read_b64_tr_b16 a[94:95], v239 offset:5120
    v_mfma_f32_16x16x32_bf16 v[168:171], v[204:207], v[188:191], v[168:171]
    v_mov_b32 v249, v248
    s_nop 1
    v_permlane16_swap_b32 v248, v249
    v_max_f32 v248, v248, v249
    v_mul_f32 v248, s64, v248
    v_pk_fma_f32 v[128:129], v[128:129], s[64:65], v[248:249] op_sel_hi:[1,0,0] neg_lo:[0,0,1] neg_hi:[0,0,1]
    v_pk_fma_f32 v[130:131], v[130:131], s[64:65], v[248:249] op_sel_hi:[1,0,0] neg_lo:[0,0,1] neg_hi:[0,0,1]
    v_pk_fma_f32 v[132:133], v[132:133], s[64:65], v[248:249] op_sel_hi:[1,0,0] neg_lo:[0,0,1] neg_hi:[0,0,1]
    v_pk_fma_f32 v[134:135], v[134:135], s[64:65], v[248:249] op_sel_hi:[1,0,0] neg_lo:[0,0,1] neg_hi:[0,0,1]
    v_pk_fma_f32 v[136:137], v[136:137], s[64:65], v[248:249] op_sel_hi:[1,0,0] neg_lo:[0,0,1] neg_hi:[0,0,1]
    v_pk_fma_f32 v[138:139], v[138:139], s[64:65], v[248:249] op_sel_hi:[1,0,0] neg_lo:[0,0,1] neg_hi:[0,0,1]
    v_pk_fma_f32 v[140:141], v[140:141], s[64:65], v[248:249] op_sel_hi:[1,0,0] neg_lo:[0,0,1] neg_hi:[0,0,1]
    v_pk_fma_f32 v[142:143], v[142:143], s[64:65], v[248:249] op_sel_hi:[1,0,0] neg_lo:[0,0,1] neg_hi:[0,0,1]
    v_pk_fma_f32 v[144:145], v[144:145], s[64:65], v[248:249] op_sel_hi:[1,0,0] neg_lo:[0,0,1] neg_hi:[0,0,1]
    v_pk_fma_f32 v[146:147], v[146:147], s[64:65], v[248:249] op_sel_hi:[1,0,0] neg_lo:[0,0,1] neg_hi:[0,0,1]
    v_pk_fma_f32 v[148:149], v[148:149], s[64:65], v[248:249] op_sel_hi:[1,0,0] neg_lo:[0,0,1] neg_hi:[0,0,1]
    v_pk_fma_f32 v[150:151], v[150:151], s[64:65], v[248:249] op_sel_hi:[1,0,0] neg_lo:[0,0,1] neg_hi:[0,0,1]
    v_exp_f32 v128, v128
    v_exp_f32 v129, v129
    v_mfma_f32_16x16x32_bf16 v[172:175], v[220:223], v[188:191], v[172:175]
    v_exp_f32 v130, v130
    v_exp_f32 v131, v131
    v_mfma_f32_16x16x32_bf16 a[112:115], a[96:99], v[36:39], 0
    v_cvt_pk_bf16_f32 v48, v128, v129
    v_exp_f32 v132, v132
    v_mfma_f32_16x16x32_bf16 a[112:115], a[96:99], v[40:43], a[112:115]
    v_exp_f32 v133, v133
    v_cvt_pk_bf16_f32 v49, v130, v131
    v_mfma_f32_16x16x32_bf16 a[112:115], a[96:99], v[44:47], a[112:115]
    s_waitcnt lgkmcnt(14)
    v_exp_f32 v134, v134
    v_exp_f32 v135, v135
    v_mfma_f32_16x16x32_bf16 v[72:75], a[64:67], v[8:11], v[72:75]
    s_waitcnt lgkmcnt(12)
    v_cvt_pk_bf16_f32 v50, v132, v133
    v_exp_f32 v136, v136
    v_mfma_f32_16x16x32_bf16 v[76:79], a[68:71], v[8:11], v[76:79]
    s_waitcnt lgkmcnt(10)
    v_exp_f32 v137, v137
    v_cvt_pk_bf16_f32 v51, v134, v135
    v_mfma_f32_16x16x32_bf16 v[80:83], a[72:75], v[8:11], v[80:83]
    s_waitcnt lgkmcnt(8)
    v_exp_f32 v138, v138
    v_exp_f32 v139, v139
    v_mfma_f32_16x16x32_bf16 v[84:87], a[76:79], v[8:11], v[84:87]
    s_waitcnt lgkmcnt(6)
    v_cvt_pk_bf16_f32 v52, v136, v137
    v_exp_f32 v140, v140
    v_mfma_f32_16x16x32_bf16 v[88:91], a[80:83], v[8:11], v[88:91]
    s_waitcnt lgkmcnt(4)
    v_exp_f32 v141, v141
    v_cvt_pk_bf16_f32 v53, v138, v139
    v_mfma_f32_16x16x32_bf16 v[92:95], a[84:87], v[8:11], v[92:95]
    s_waitcnt lgkmcnt(2)
    v_exp_f32 v142, v142
    v_exp_f32 v143, v143
    v_mfma_f32_16x16x32_bf16 v[96:99], a[88:91], v[8:11], v[96:99]
    s_waitcnt lgkmcnt(0)
    v_cvt_pk_bf16_f32 v54, v140, v141
    v_exp_f32 v144, v144
    v_mfma_f32_16x16x32_bf16 v[100:103], a[92:95], v[8:11], v[100:103]
    v_exp_f32 v145, v145
    v_cvt_pk_bf16_f32 v55, v142, v143
    v_mfma_f32_16x16x32_bf16 v[104:107], a[64:67], v[20:23], v[104:107]
    v_exp_f32 v146, v146
    v_mfma_f32_16x16x32_bf16 v[108:111], a[68:71], v[20:23], v[108:111]
    v_exp_f32 v147, v147
    v_mfma_f32_16x16x32_bf16 v[112:115], a[72:75], v[20:23], v[112:115]
    v_cvt_pk_bf16_f32 v56, v144, v145
    v_exp_f32 v148, v148
    v_mfma_f32_16x16x32_bf16 v[116:119], a[76:79], v[20:23], v[116:119]
    v_exp_f32 v149, v149
    v_mfma_f32_16x16x32_bf16 v[120:123], a[80:83], v[20:23], v[120:123]
    v_cvt_pk_bf16_f32 v57, v146, v147
    v_exp_f32 v150, v150
    v_mfma_f32_16x16x32_bf16 v[124:127], a[84:87], v[20:23], v[124:127]
    v_exp_f32 v151, v151
    v_mfma_f32_16x16x32_bf16 v[228:231], a[88:91], v[20:23], v[228:231]
    v_cvt_pk_bf16_f32 v58, v148, v149
    v_cvt_pk_bf16_f32 v59, v150, v151
    v_mfma_f32_16x16x32_bf16 v[232:235], a[92:95], v[20:23], v[232:235]
    s_lshl_b32 s71, s101, 16
    v_accvgpr_read_b32 v224, a100
    v_rcp_f32 v224, v224
    s_nop 0
    v_pk_mul_f32 v[72:73], v[72:73], v[224:225] op_sel_hi:[1,0]
    v_pk_mul_f32 v[74:75], v[74:75], v[224:225] op_sel_hi:[1,0]
    v_pk_mul_f32 v[76:77], v[76:77], v[224:225] op_sel_hi:[1,0]
    v_pk_mul_f32 v[78:79], v[78:79], v[224:225] op_sel_hi:[1,0]
    v_pk_mul_f32 v[80:81], v[80:81], v[224:225] op_sel_hi:[1,0]
    v_pk_mul_f32 v[82:83], v[82:83], v[224:225] op_sel_hi:[1,0]
    v_pk_mul_f32 v[84:85], v[84:85], v[224:225] op_sel_hi:[1,0]
    v_pk_mul_f32 v[86:87], v[86:87], v[224:225] op_sel_hi:[1,0]
    v_pk_mul_f32 v[88:89], v[88:89], v[224:225] op_sel_hi:[1,0]
    v_pk_mul_f32 v[90:91], v[90:91], v[224:225] op_sel_hi:[1,0]
    v_pk_mul_f32 v[92:93], v[92:93], v[224:225] op_sel_hi:[1,0]
    v_pk_mul_f32 v[94:95], v[94:95], v[224:225] op_sel_hi:[1,0]
    v_pk_mul_f32 v[96:97], v[96:97], v[224:225] op_sel_hi:[1,0]
    v_pk_mul_f32 v[98:99], v[98:99], v[224:225] op_sel_hi:[1,0]
    v_pk_mul_f32 v[100:101], v[100:101], v[224:225] op_sel_hi:[1,0]
    v_pk_mul_f32 v[102:103], v[102:103], v[224:225] op_sel_hi:[1,0]
    v_cvt_pk_bf16_f32 v236, v72, v73
    v_cvt_pk_bf16_f32 v237, v74, v75
    v_cvt_pk_bf16_f32 v238, v76, v77
    v_cvt_pk_bf16_f32 v239, v78, v79
    v_mfma_f32_16x16x32_bf16 v[72:75], a[0:3], v[24:27], 0
    s_add_u32 s40, s99, s71
    v_cvt_pk_bf16_f32 v240, v80, v81
    s_addc_u32 s41, s100, 0
    s_add_u32 s101, s101, 1
    s_and_b32 s101, s101, 7
    buffer_load_dwordx4 v[192:195], v252, s[40:43], 0 offen offset:0
    buffer_load_dwordx4 v[196:199], v252, s[40:43], 0 offen offset:1024
    ds_write_b128 v253, v[236:239] offset:0
    v_cvt_pk_bf16_f32 v241, v82, v83
    v_mfma_f32_16x16x32_bf16 v[76:79], a[4:7], v[24:27], 0
    v_cvt_pk_bf16_f32 v242, v84, v85
    v_cvt_pk_bf16_f32 v243, v86, v87
    v_mfma_f32_16x16x32_bf16 v[80:83], a[8:11], v[24:27], 0
    ds_write_b128 v253, v[240:243] offset:6144
    v_mfma_f32_16x16x32_bf16 v[84:87], a[12:15], v[24:27], 0
    v_cvt_pk_bf16_f32 v236, v88, v89
    v_cvt_pk_bf16_f32 v237, v90, v91
    v_cvt_pk_bf16_f32 v238, v92, v93
    v_cvt_pk_bf16_f32 v239, v94, v95
    v_mfma_f32_16x16x32_bf16 v[88:91], a[16:19], v[24:27], 0
    buffer_load_dwordx4 v[200:203], v252, s[40:43], 0 offen offset:2048
    v_mfma_f32_16x16x32_bf16 v[92:95], a[20:23], v[24:27], 0
    ds_write_b128 v253, v[236:239] offset:12288
    v_cvt_pk_bf16_f32 v240, v96, v97
    v_cvt_pk_bf16_f32 v241, v98, v99
    v_cvt_pk_bf16_f32 v242, v100, v101
    v_cvt_pk_bf16_f32 v243, v102, v103
    v_mfma_f32_16x16x32_bf16 v[96:99], a[24:27], v[24:27], 0
    buffer_load_dwordx4 v[204:207], v252, s[40:43], 0 offen offset:3072
    v_mfma_f32_16x16x32_bf16 v[100:103], a[28:31], v[24:27], 0
    ds_write_b128 v253, v[240:243] offset:18432
    v_mfma_f32_16x16x32_bf16 a[116:119], a[96:99], v[48:51], 0
    v_accvgpr_read_b32 v224, a104
    v_rcp_f32 v224, v224
    v_mfma_f32_16x16x32_bf16 a[116:119], a[96:99], v[52:55], a[116:119]
    v_pk_mul_f32 v[104:105], v[104:105], v[224:225] op_sel_hi:[1,0]
    v_pk_mul_f32 v[106:107], v[106:107], v[224:225] op_sel_hi:[1,0]
    v_pk_mul_f32 v[108:109], v[108:109], v[224:225] op_sel_hi:[1,0]
    v_pk_mul_f32 v[110:111], v[110:111], v[224:225] op_sel_hi:[1,0]
    v_pk_mul_f32 v[112:113], v[112:113], v[224:225] op_sel_hi:[1,0]
    v_pk_mul_f32 v[114:115], v[114:115], v[224:225] op_sel_hi:[1,0]
    v_pk_mul_f32 v[116:117], v[116:117], v[224:225] op_sel_hi:[1,0]
    v_pk_mul_f32 v[118:119], v[118:119], v[224:225] op_sel_hi:[1,0]
    v_pk_mul_f32 v[120:121], v[120:121], v[224:225] op_sel_hi:[1,0]
    v_pk_mul_f32 v[122:123], v[122:123], v[224:225] op_sel_hi:[1,0]
    v_pk_mul_f32 v[124:125], v[124:125], v[224:225] op_sel_hi:[1,0]
    v_pk_mul_f32 v[126:127], v[126:127], v[224:225] op_sel_hi:[1,0]
    v_pk_mul_f32 v[228:229], v[228:229], v[224:225] op_sel_hi:[1,0]
    v_pk_mul_f32 v[230:231], v[230:231], v[224:225] op_sel_hi:[1,0]
    v_pk_mul_f32 v[232:233], v[232:233], v[224:225] op_sel_hi:[1,0]
    v_pk_mul_f32 v[234:235], v[234:235], v[224:225] op_sel_hi:[1,0]
    v_cvt_pk_bf16_f32 v236, v104, v105
    v_cvt_pk_bf16_f32 v237, v106, v107
    v_cvt_pk_bf16_f32 v238, v108, v109
    v_cvt_pk_bf16_f32 v239, v110, v111
    v_mfma_f32_16x16x32_bf16 a[116:119], a[96:99], v[56:59], a[116:119]
    buffer_load_dwordx4 v[208:211], v252, s[40:43], s62 offen offset:0
    v_mfma_f32_16x16x32_bf16 v[72:75], a[32:35], v[28:31], v[72:75]
    ds_write_b128 v253, v[236:239] offset:1024
    v_mfma_f32_16x16x32_bf16 v[76:79], a[36:39], v[28:31], v[76:79]
    v_cvt_pk_bf16_f32 v240, v112, v113
    v_cvt_pk_bf16_f32 v241, v114, v115
    v_mfma_f32_16x16x32_bf16 v[80:83], a[40:43], v[28:31], v[80:83]
    v_cvt_pk_bf16_f32 v242, v116, v117
    v_cvt_pk_bf16_f32 v243, v118, v119
    v_mfma_f32_16x16x32_bf16 v[84:87], a[44:47], v[28:31], v[84:87]
    ds_write_b128 v253, v[240:243] offset:7168
    v_mfma_f32_16x16x32_bf16 v[88:91], a[48:51], v[28:31], v[88:91]
    v_cvt_pk_bf16_f32 v236, v120, v121
    v_cvt_pk_bf16_f32 v237, v122, v123
    v_mfma_f32_16x16x32_bf16 v[92:95], a[52:55], v[28:31], v[92:95]
    buffer_load_dwordx4 v[212:215], v252, s[40:43], s62 offen offset:1024
    v_mfma_f32_16x16x32_bf16 v[96:99], a[56:59], v[28:31], v[96:99]
    v_cvt_pk_bf16_f32 v238, v124, v125
    v_cvt_pk_bf16_f32 v239, v126, v127
    v_mfma_f32_16x16x32_bf16 v[100:103], a[60:63], v[28:31], v[100:103]
    ds_write_b128 v253, v[236:239] offset:13312
    v_mfma_f32_16x16x32_bf16 v[72:75], a[64:67], v[32:35], v[72:75]
    v_cvt_pk_bf16_f32 v240, v228, v229
    v_cvt_pk_bf16_f32 v241, v230, v231
    v_mfma_f32_16x16x32_bf16 v[76:79], a[68:71], v[32:35], v[76:79]
    buffer_load_dwordx4 v[216:219], v252, s[40:43], s62 offen offset:2048
    v_mfma_f32_16x16x32_bf16 v[80:83], a[72:75], v[32:35], v[80:83]
    v_cvt_pk_bf16_f32 v242, v232, v233
    v_cvt_pk_bf16_f32 v243, v234, v235
    v_mfma_f32_16x16x32_bf16 v[84:87], a[76:79], v[32:35], v[84:87]
    ds_write_b128 v253, v[240:243] offset:19456
    v_mfma_f32_16x16x32_bf16 v[88:91], a[80:83], v[32:35], v[88:91]
    v_max3_f32 v248, v152, v153, v154
    v_max3_f32 v248, v248, v155, v156
    v_mfma_f32_16x16x32_bf16 v[92:95], a[84:87], v[32:35], v[92:95]
    v_max3_f32 v248, v248, v157, v158
    v_max3_f32 v248, v248, v159, v160
    v_mfma_f32_16x16x32_bf16 v[96:99], a[88:91], v[32:35], v[96:99]
    buffer_load_dwordx4 v[220:223], v252, s[40:43], s62 offen offset:3072
    v_mfma_f32_16x16x32_bf16 v[100:103], a[92:95], v[32:35], v[100:103]
    v_max3_f32 v248, v248, v161, v162
    v_max3_f32 v248, v248, v163, v164
    v_mfma_f32_16x16x32_bf16 v[104:107], a[0:3], v[36:39], 0
    v_max3_f32 v248, v248, v165, v166
    v_max3_f32 v248, v248, v167, v168
    v_mfma_f32_16x16x32_bf16 v[108:111], a[4:7], v[36:39], 0
    s_lshl_b32 s71, s101, 16
    v_max3_f32 v248, v248, v169, v170
    v_max3_f32 v248, v248, v171, v172
    v_mfma_f32_16x16x32_bf16 v[112:115], a[8:11], v[36:39], 0
    s_add_u32 s40, s99, s71
    v_max3_f32 v248, v248, v173, v174
    v_max3_f32 v248, v248, v175, v175
    v_mfma_f32_16x16x32_bf16 v[116:119], a[12:15], v[36:39], 0
    s_addc_u32 s41, s100, 0
    v_mov_b32 v249, v248
    s_nop 1
    v_permlane32_swap_b32 v248, v249
    v_mfma_f32_16x16x32_bf16 v[120:123], a[16:19], v[36:39], 0
    s_add_u32 s101, s101, 1
    v_max_f32 v248, v248, v249
    v_mov_b32 v249, v248
    s_nop 1
    v_permlane16_swap_b32 v248, v249
    v_max_f32 v248, v248, v249
    v_mul_f32 v248, s64, v248
    v_pk_fma_f32 v[152:153], v[152:153], s[64:65], v[248:249] op_sel_hi:[1,0,0] neg_lo:[0,0,1] neg_hi:[0,0,1]
    v_pk_fma_f32 v[154:155], v[154:155], s[64:65], v[248:249] op_sel_hi:[1,0,0] neg_lo:[0,0,1] neg_hi:[0,0,1]
    v_pk_fma_f32 v[156:157], v[156:157], s[64:65], v[248:249] op_sel_hi:[1,0,0] neg_lo:[0,0,1] neg_hi:[0,0,1]
    v_pk_fma_f32 v[158:159], v[158:159], s[64:65], v[248:249] op_sel_hi:[1,0,0] neg_lo:[0,0,1] neg_hi:[0,0,1]
    v_pk_fma_f32 v[160:161], v[160:161], s[64:65], v[248:249] op_sel_hi:[1,0,0] neg_lo:[0,0,1] neg_hi:[0,0,1]
    v_pk_fma_f32 v[162:163], v[162:163], s[64:65], v[248:249] op_sel_hi:[1,0,0] neg_lo:[0,0,1] neg_hi:[0,0,1]
    v_pk_fma_f32 v[164:165], v[164:165], s[64:65], v[248:249] op_sel_hi:[1,0,0] neg_lo:[0,0,1] neg_hi:[0,0,1]
    v_pk_fma_f32 v[166:167], v[166:167], s[64:65], v[248:249] op_sel_hi:[1,0,0] neg_lo:[0,0,1] neg_hi:[0,0,1]
    v_pk_fma_f32 v[168:169], v[168:169], s[64:65], v[248:249] op_sel_hi:[1,0,0] neg_lo:[0,0,1] neg_hi:[0,0,1]
    v_pk_fma_f32 v[170:171], v[170:171], s[64:65], v[248:249] op_sel_hi:[1,0,0] neg_lo:[0,0,1] neg_hi:[0,0,1]
    v_pk_fma_f32 v[172:173], v[172:173], s[64:65], v[248:249] op_sel_hi:[1,0,0] neg_lo:[0,0,1] neg_hi:[0,0,1]
    v_pk_fma_f32 v[174:175], v[174:175], s[64:65], v[248:249] op_sel_hi:[1,0,0] neg_lo:[0,0,1] neg_hi:[0,0,1]
    v_exp_f32 v152, v152
    v_exp_f32 v153, v153
    v_mfma_f32_16x16x32_bf16 v[124:127], a[20:23], v[36:39], 0
    s_and_b32 s101, s101, 7
    v_exp_f32 v154, v154
    v_mfma_f32_16x16x32_bf16 v[228:231], a[24:27], v[36:39], 0
    buffer_load_dwordx4 v[176:179], v252, s[40:43], 0 offen offset:0
    v_mfma_f32_16x16x32_bf16 v[232:235], a[28:31], v[36:39], 0
    buffer_load_dwordx4 v[180:183], v252, s[40:43], 0 offen offset:1024
    v_mfma_f32_16x16x32_bf16 v[104:107], a[32:35], v[40:43], v[104:107]
    buffer_load_dwordx4 v[184:187], v252, s[40:43], 0 offen offset:2048
    v_mfma_f32_16x16x32_bf16 v[108:111], a[36:39], v[40:43], v[108:111]
    v_exp_f32 v155, v155
    v_mfma_f32_16x16x32_bf16 v[112:115], a[40:43], v[40:43], v[112:115]
    v_cvt_pk_bf16_f32 v60, v152, v153
    v_exp_f32 v156, v156
    v_mfma_f32_16x16x32_bf16 v[116:119], a[44:47], v[40:43], v[116:119]
    v_exp_f32 v157, v157
    v_mfma_f32_16x16x32_bf16 v[120:123], a[48:51], v[40:43], v[120:123]
    buffer_load_dwordx4 v[188:191], v252, s[40:43], 0 offen offset:3072
    v_mfma_f32_16x16x32_bf16 v[124:127], a[52:55], v[40:43], v[124:127]
    v_cvt_pk_bf16_f32 v61, v154, v155
    v_exp_f32 v158, v158
    v_mfma_f32_16x16x32_bf16 v[228:231], a[56:59], v[40:43], v[228:231]
    v_exp_f32 v159, v159
    v_mfma_f32_16x16x32_bf16 v[232:235], a[60:63], v[40:43], v[232:235]
    v_cvt_pk_bf16_f32 v62, v156, v157
    v_exp_f32 v160, v160
    v_mfma_f32_16x16x32_bf16 v[104:107], a[64:67], v[44:47], v[104:107]
    buffer_load_dwordx4 v[128:131], v252, s[40:43], s62 offen offset:0
    v_mfma_f32_16x16x32_bf16 v[108:111], a[68:71], v[44:47], v[108:111]
    v_exp_f32 v161, v161
    v_mfma_f32_16x16x32_bf16 v[112:115], a[72:75], v[44:47], v[112:115]
    v_cvt_pk_bf16_f32 v63, v158, v159
    v_exp_f32 v162, v162
    v_mfma_f32_16x16x32_bf16 v[116:119], a[76:79], v[44:47], v[116:119]
    v_exp_f32 v163, v163
    v_mfma_f32_16x16x32_bf16 v[120:123], a[80:83], v[44:47], v[120:123]
    v_cvt_pk_bf16_f32 v64, v160, v161
    v_exp_f32 v164, v164
    v_mfma_f32_16x16x32_bf16 v[124:127], a[84:87], v[44:47], v[124:127]
    buffer_load_dwordx4 v[132:135], v252, s[40:43], s62 offen offset:1024
    v_mfma_f32_16x16x32_bf16 v[228:231], a[88:91], v[44:47], v[228:231]
    v_exp_f32 v165, v165
    v_mfma_f32_16x16x32_bf16 v[232:235], a[92:95], v[44:47], v[232:235]
    v_cvt_pk_bf16_f32 v65, v162, v163
    v_exp_f32 v166, v166
    v_exp_f32 v167, v167
    v_cvt_pk_bf16_f32 v66, v164, v165
    v_exp_f32 v168, v168
    v_exp_f32 v169, v169
    v_cvt_pk_bf16_f32 v67, v166, v167
    v_exp_f32 v170, v170
    v_exp_f32 v171, v171
    v_cvt_pk_bf16_f32 v68, v168, v169
    v_exp_f32 v172, v172
    v_exp_f32 v173, v173
    v_cvt_pk_bf16_f32 v69, v170, v171
    v_exp_f32 v174, v174
    v_exp_f32 v175, v175
    v_cvt_pk_bf16_f32 v70, v172, v173
    v_cvt_pk_bf16_f32 v71, v174, v175
    v_mfma_f32_16x16x32_bf16 a[120:123], a[96:99], v[60:63], 0
    buffer_load_dwordx4 v[136:139], v252, s[40:43], s62 offen offset:2048
    v_mfma_f32_16x16x32_bf16 a[120:123], a[96:99], v[64:67], a[120:123]
    buffer_load_dwordx4 v[140:143], v252, s[40:43], s62 offen offset:3072
    v_mfma_f32_16x16x32_bf16 a[120:123], a[96:99], v[68:71], a[120:123]
    s_lshl_b32 s71, s101, 16
    v_accvgpr_read_b32 v224, a108
    v_rcp_f32 v224, v224
    s_nop 0
    v_pk_mul_f32 v[72:73], v[72:73], v[224:225] op_sel_hi:[1,0]
    v_pk_mul_f32 v[74:75], v[74:75], v[224:225] op_sel_hi:[1,0]
    v_pk_mul_f32 v[76:77], v[76:77], v[224:225] op_sel_hi:[1,0]
    v_pk_mul_f32 v[78:79], v[78:79], v[224:225] op_sel_hi:[1,0]
    v_pk_mul_f32 v[80:81], v[80:81], v[224:225] op_sel_hi:[1,0]
    v_pk_mul_f32 v[82:83], v[82:83], v[224:225] op_sel_hi:[1,0]
    v_pk_mul_f32 v[84:85], v[84:85], v[224:225] op_sel_hi:[1,0]
    v_pk_mul_f32 v[86:87], v[86:87], v[224:225] op_sel_hi:[1,0]
    v_pk_mul_f32 v[88:89], v[88:89], v[224:225] op_sel_hi:[1,0]
    v_pk_mul_f32 v[90:91], v[90:91], v[224:225] op_sel_hi:[1,0]
    v_pk_mul_f32 v[92:93], v[92:93], v[224:225] op_sel_hi:[1,0]
    v_pk_mul_f32 v[94:95], v[94:95], v[224:225] op_sel_hi:[1,0]
    v_pk_mul_f32 v[96:97], v[96:97], v[224:225] op_sel_hi:[1,0]
    v_pk_mul_f32 v[98:99], v[98:99], v[224:225] op_sel_hi:[1,0]
    v_pk_mul_f32 v[100:101], v[100:101], v[224:225] op_sel_hi:[1,0]
    v_pk_mul_f32 v[102:103], v[102:103], v[224:225] op_sel_hi:[1,0]
    v_cvt_pk_bf16_f32 v236, v72, v73
    v_cvt_pk_bf16_f32 v237, v74, v75
    v_cvt_pk_bf16_f32 v238, v76, v77
    v_cvt_pk_bf16_f32 v239, v78, v79
    v_mfma_f32_16x16x32_bf16 v[72:75], a[0:3], v[48:51], 0
    s_add_u32 s40, s99, s71
    v_cvt_pk_bf16_f32 v240, v80, v81
    s_addc_u32 s41, s100, 0
    s_add_u32 s101, s101, 1
    s_and_b32 s101, s101, 7
    buffer_load_dwordx4 v[144:147], v252, s[40:43], 0 offen offset:0
    buffer_load_dwordx4 v[148:151], v252, s[40:43], 0 offen offset:1024
    ds_write_b128 v253, v[236:239] offset:2048
    v_cvt_pk_bf16_f32 v241, v82, v83
    v_mfma_f32_16x16x32_bf16 v[76:79], a[4:7], v[48:51], 0
    v_cvt_pk_bf16_f32 v242, v84, v85
    v_cvt_pk_bf16_f32 v243, v86, v87
    v_mfma_f32_16x16x32_bf16 v[80:83], a[8:11], v[48:51], 0
    ds_write_b128 v253, v[240:243] offset:8192
    v_mfma_f32_16x16x32_bf16 v[84:87], a[12:15], v[48:51], 0
    v_cvt_pk_bf16_f32 v236, v88, v89
    v_cvt_pk_bf16_f32 v237, v90, v91
    v_cvt_pk_bf16_f32 v238, v92, v93
    v_cvt_pk_bf16_f32 v239, v94, v95
    v_mfma_f32_16x16x32_bf16 v[88:91], a[16:19], v[48:51], 0
    buffer_load_dwordx4 v[152:155], v252, s[40:43], 0 offen offset:2048
    v_mfma_f32_16x16x32_bf16 v[92:95], a[20:23], v[48:51], 0
    ds_write_b128 v253, v[236:239] offset:14336
    v_cvt_pk_bf16_f32 v240, v96, v97
    v_cvt_pk_bf16_f32 v241, v98, v99
    v_cvt_pk_bf16_f32 v242, v100, v101
    v_cvt_pk_bf16_f32 v243, v102, v103
    v_mfma_f32_16x16x32_bf16 v[96:99], a[24:27], v[48:51], 0
    buffer_load_dwordx4 v[156:159], v252, s[40:43], 0 offen offset:3072
    v_mfma_f32_16x16x32_bf16 v[100:103], a[28:31], v[48:51], 0
    ds_write_b128 v253, v[240:243] offset:20480
    v_mfma_f32_16x16x32_bf16 v[72:75], a[32:35], v[52:55], v[72:75]
    v_accvgpr_read_b32 v224, a112
    v_rcp_f32 v224, v224
    v_mfma_f32_16x16x32_bf16 v[76:79], a[36:39], v[52:55], v[76:79]
    v_pk_mul_f32 v[104:105], v[104:105], v[224:225] op_sel_hi:[1,0]
    v_pk_mul_f32 v[106:107], v[106:107], v[224:225] op_sel_hi:[1,0]
    v_pk_mul_f32 v[108:109], v[108:109], v[224:225] op_sel_hi:[1,0]
    v_pk_mul_f32 v[110:111], v[110:111], v[224:225] op_sel_hi:[1,0]
    v_pk_mul_f32 v[112:113], v[112:113], v[224:225] op_sel_hi:[1,0]
    v_pk_mul_f32 v[114:115], v[114:115], v[224:225] op_sel_hi:[1,0]
    v_pk_mul_f32 v[116:117], v[116:117], v[224:225] op_sel_hi:[1,0]
    v_pk_mul_f32 v[118:119], v[118:119], v[224:225] op_sel_hi:[1,0]
    v_pk_mul_f32 v[120:121], v[120:121], v[224:225] op_sel_hi:[1,0]
    v_pk_mul_f32 v[122:123], v[122:123], v[224:225] op_sel_hi:[1,0]
    v_pk_mul_f32 v[124:125], v[124:125], v[224:225] op_sel_hi:[1,0]
    v_pk_mul_f32 v[126:127], v[126:127], v[224:225] op_sel_hi:[1,0]
    v_pk_mul_f32 v[228:229], v[228:229], v[224:225] op_sel_hi:[1,0]
    v_pk_mul_f32 v[230:231], v[230:231], v[224:225] op_sel_hi:[1,0]
    v_pk_mul_f32 v[232:233], v[232:233], v[224:225] op_sel_hi:[1,0]
    v_pk_mul_f32 v[234:235], v[234:235], v[224:225] op_sel_hi:[1,0]
    v_cvt_pk_bf16_f32 v236, v104, v105
    v_cvt_pk_bf16_f32 v237, v106, v107
    v_cvt_pk_bf16_f32 v238, v108, v109
    v_cvt_pk_bf16_f32 v239, v110, v111
    v_mfma_f32_16x16x32_bf16 v[80:83], a[40:43], v[52:55], v[80:83]
    buffer_load_dwordx4 v[160:163], v252, s[40:43], s62 offen offset:0
    v_mfma_f32_16x16x32_bf16 v[84:87], a[44:47], v[52:55], v[84:87]
    ds_write_b128 v253, v[236:239] offset:3072
    v_mfma_f32_16x16x32_bf16 v[88:91], a[48:51], v[52:55], v[88:91]
    v_cvt_pk_bf16_f32 v240, v112, v113
    v_cvt_pk_bf16_f32 v241, v114, v115
    v_mfma_f32_16x16x32_bf16 v[92:95], a[52:55], v[52:55], v[92:95]
    v_cvt_pk_bf16_f32 v242, v116, v117
    v_cvt_pk_bf16_f32 v243, v118, v119
    v_mfma_f32_16x16x32_bf16 v[96:99], a[56:59], v[52:55], v[96:99]
    ds_write_b128 v253, v[240:243] offset:9216
    v_mfma_f32_16x16x32_bf16 v[100:103], a[60:63], v[52:55], v[100:103]
    v_cvt_pk_bf16_f32 v236, v120, v121
    v_cvt_pk_bf16_f32 v237, v122, v123
    v_mfma_f32_16x16x32_bf16 v[72:75], a[64:67], v[56:59], v[72:75]
    buffer_load_dwordx4 v[164:167], v252, s[40:43], s62 offen offset:1024
    v_mfma_f32_16x16x32_bf16 v[76:79], a[68:71], v[56:59], v[76:79]
    v_cvt_pk_bf16_f32 v238, v124, v125
    v_cvt_pk_bf16_f32 v239, v126, v127
    v_mfma_f32_16x16x32_bf16 v[80:83], a[72:75], v[56:59], v[80:83]
    ds_write_b128 v253, v[236:239] offset:15360
    v_mfma_f32_16x16x32_bf16 v[84:87], a[76:79], v[56:59], v[84:87]
    v_cvt_pk_bf16_f32 v240, v228, v229
    v_cvt_pk_bf16_f32 v241, v230, v231
    v_mfma_f32_16x16x32_bf16 v[88:91], a[80:83], v[56:59], v[88:91]
    buffer_load_dwordx4 v[168:171], v252, s[40:43], s62 offen offset:2048
    v_mfma_f32_16x16x32_bf16 v[92:95], a[84:87], v[56:59], v[92:95]
    v_cvt_pk_bf16_f32 v242, v232, v233
    v_cvt_pk_bf16_f32 v243, v234, v235
    v_mfma_f32_16x16x32_bf16 v[96:99], a[88:91], v[56:59], v[96:99]
    s_waitcnt lgkmcnt(14)
    ds_write_b128 v253, v[240:243] offset:21504
    v_mfma_f32_16x16x32_bf16 v[100:103], a[92:95], v[56:59], v[100:103]
    v_accvgpr_read_b32 v224, a116
    v_rcp_f32 v224, v224
    v_mfma_f32_16x16x32_bf16 v[104:107], a[0:3], v[60:63], 0
    v_mfma_f32_16x16x32_bf16 v[108:111], a[4:7], v[60:63], 0
    v_pk_mul_f32 v[72:73], v[72:73], v[224:225] op_sel_hi:[1,0]
    v_pk_mul_f32 v[74:75], v[74:75], v[224:225] op_sel_hi:[1,0]
    v_pk_mul_f32 v[76:77], v[76:77], v[224:225] op_sel_hi:[1,0]
    v_pk_mul_f32 v[78:79], v[78:79], v[224:225] op_sel_hi:[1,0]
    v_pk_mul_f32 v[80:81], v[80:81], v[224:225] op_sel_hi:[1,0]
    v_pk_mul_f32 v[82:83], v[82:83], v[224:225] op_sel_hi:[1,0]
    v_pk_mul_f32 v[84:85], v[84:85], v[224:225] op_sel_hi:[1,0]
    v_pk_mul_f32 v[86:87], v[86:87], v[224:225] op_sel_hi:[1,0]
    v_pk_mul_f32 v[88:89], v[88:89], v[224:225] op_sel_hi:[1,0]
    v_pk_mul_f32 v[90:91], v[90:91], v[224:225] op_sel_hi:[1,0]
    v_pk_mul_f32 v[92:93], v[92:93], v[224:225] op_sel_hi:[1,0]
    v_pk_mul_f32 v[94:95], v[94:95], v[224:225] op_sel_hi:[1,0]
    v_pk_mul_f32 v[96:97], v[96:97], v[224:225] op_sel_hi:[1,0]
    v_pk_mul_f32 v[98:99], v[98:99], v[224:225] op_sel_hi:[1,0]
    v_pk_mul_f32 v[100:101], v[100:101], v[224:225] op_sel_hi:[1,0]
    v_pk_mul_f32 v[102:103], v[102:103], v[224:225] op_sel_hi:[1,0]
    v_cvt_pk_bf16_f32 v236, v72, v73
    v_cvt_pk_bf16_f32 v237, v74, v75
    v_cvt_pk_bf16_f32 v238, v76, v77
    v_cvt_pk_bf16_f32 v239, v78, v79
    v_mfma_f32_16x16x32_bf16 v[112:115], a[8:11], v[60:63], 0
    buffer_load_dwordx4 v[172:175], v252, s[40:43], s62 offen offset:3072
    v_mfma_f32_16x16x32_bf16 v[116:119], a[12:15], v[60:63], 0
    s_waitcnt lgkmcnt(14)
    ds_write_b128 v253, v[236:239] offset:4096
    v_mfma_f32_16x16x32_bf16 v[120:123], a[16:19], v[60:63], 0
    v_cvt_pk_bf16_f32 v240, v80, v81
    v_cvt_pk_bf16_f32 v241, v82, v83
    v_mfma_f32_16x16x32_bf16 v[124:127], a[20:23], v[60:63], 0
    v_cvt_pk_bf16_f32 v242, v84, v85
    v_cvt_pk_bf16_f32 v243, v86, v87
    v_mfma_f32_16x16x32_bf16 v[228:231], a[24:27], v[60:63], 0
    s_waitcnt lgkmcnt(14)
    ds_write_b128 v253, v[240:243] offset:10240
    v_mfma_f32_16x16x32_bf16 v[232:235], a[28:31], v[60:63], 0
    v_cvt_pk_bf16_f32 v236, v88, v89
    v_cvt_pk_bf16_f32 v237, v90, v91
    v_mfma_f32_16x16x32_bf16 v[104:107], a[32:35], v[64:67], v[104:107]
    v_cvt_pk_bf16_f32 v238, v92, v93
    v_cvt_pk_bf16_f32 v239, v94, v95
    v_mfma_f32_16x16x32_bf16 v[108:111], a[36:39], v[64:67], v[108:111]
    s_waitcnt lgkmcnt(14)
    ds_write_b128 v253, v[236:239] offset:16384
    v_mfma_f32_16x16x32_bf16 v[112:115], a[40:43], v[64:67], v[112:115]
    v_cvt_pk_bf16_f32 v240, v96, v97
    v_cvt_pk_bf16_f32 v241, v98, v99
    v_mfma_f32_16x16x32_bf16 v[116:119], a[44:47], v[64:67], v[116:119]
    v_cvt_pk_bf16_f32 v242, v100, v101
    v_cvt_pk_bf16_f32 v243, v102, v103
    v_mfma_f32_16x16x32_bf16 v[120:123], a[48:51], v[64:67], v[120:123]
    s_waitcnt lgkmcnt(14)
    ds_write_b128 v253, v[240:243] offset:22528
    v_mfma_f32_16x16x32_bf16 v[124:127], a[52:55], v[64:67], v[124:127]
    s_lshl_b32 s71, s101, 16
    v_accvgpr_read_b32 v224, a120
    v_rcp_f32 v224, v224
    v_mfma_f32_16x16x32_bf16 v[228:231], a[56:59], v[64:67], v[228:231]
    s_add_u32 s40, s99, s71
    v_mfma_f32_16x16x32_bf16 v[232:235], a[60:63], v[64:67], v[232:235]
    s_addc_u32 s41, s100, 0
    v_mfma_f32_16x16x32_bf16 v[104:107], a[64:67], v[68:71], v[104:107]
    s_add_u32 s101, s101, 1
    v_mfma_f32_16x16x32_bf16 v[108:111], a[68:71], v[68:71], v[108:111]
    s_and_b32 s101, s101, 7
    v_mfma_f32_16x16x32_bf16 v[112:115], a[72:75], v[68:71], v[112:115]
    buffer_load_dwordx4 v[72:75], v252, s[40:43], 0 offen offset:0
    v_mfma_f32_16x16x32_bf16 v[116:119], a[76:79], v[68:71], v[116:119]
    v_mfma_f32_16x16x32_bf16 v[120:123], a[80:83], v[68:71], v[120:123]
    v_mfma_f32_16x16x32_bf16 v[124:127], a[84:87], v[68:71], v[124:127]
    v_mfma_f32_16x16x32_bf16 v[228:231], a[88:91], v[68:71], v[228:231]
    v_mfma_f32_16x16x32_bf16 v[232:235], a[92:95], v[68:71], v[232:235]
    v_pk_mul_f32 v[104:105], v[104:105], v[224:225] op_sel_hi:[1,0]
    v_pk_mul_f32 v[106:107], v[106:107], v[224:225] op_sel_hi:[1,0]
    v_pk_mul_f32 v[108:109], v[108:109], v[224:225] op_sel_hi:[1,0]
    v_pk_mul_f32 v[110:111], v[110:111], v[224:225] op_sel_hi:[1,0]
    v_pk_mul_f32 v[112:113], v[112:113], v[224:225] op_sel_hi:[1,0]
    v_pk_mul_f32 v[114:115], v[114:115], v[224:225] op_sel_hi:[1,0]
    v_pk_mul_f32 v[116:117], v[116:117], v[224:225] op_sel_hi:[1,0]
    v_pk_mul_f32 v[118:119], v[118:119], v[224:225] op_sel_hi:[1,0]
    v_pk_mul_f32 v[120:121], v[120:121], v[224:225] op_sel_hi:[1,0]
    v_pk_mul_f32 v[122:123], v[122:123], v[224:225] op_sel_hi:[1,0]
    v_pk_mul_f32 v[124:125], v[124:125], v[224:225] op_sel_hi:[1,0]
    v_pk_mul_f32 v[126:127], v[126:127], v[224:225] op_sel_hi:[1,0]
    v_pk_mul_f32 v[228:229], v[228:229], v[224:225] op_sel_hi:[1,0]
    v_pk_mul_f32 v[230:231], v[230:231], v[224:225] op_sel_hi:[1,0]
    v_pk_mul_f32 v[232:233], v[232:233], v[224:225] op_sel_hi:[1,0]
    v_pk_mul_f32 v[234:235], v[234:235], v[224:225] op_sel_hi:[1,0]
    v_cvt_pk_bf16_f32 v236, v104, v105
    v_cvt_pk_bf16_f32 v237, v106, v107
    v_cvt_pk_bf16_f32 v238, v108, v109
    v_cvt_pk_bf16_f32 v239, v110, v111
    v_cvt_pk_bf16_f32 v240, v112, v113
    buffer_load_dwordx4 v[76:79], v252, s[40:43], 0 offen offset:1024
    s_waitcnt lgkmcnt(14)
    ds_write_b128 v253, v[236:239] offset:5120
    v_cvt_pk_bf16_f32 v241, v114, v115
    v_cvt_pk_bf16_f32 v242, v116, v117
    v_cvt_pk_bf16_f32 v243, v118, v119
    v_cvt_pk_bf16_f32 v236, v120, v121
    s_waitcnt lgkmcnt(14)
    ds_write_b128 v253, v[240:243] offset:11264
    v_cvt_pk_bf16_f32 v237, v122, v123
    v_cvt_pk_bf16_f32 v238, v124, v125
    v_cvt_pk_bf16_f32 v239, v126, v127
    v_cvt_pk_bf16_f32 v240, v228, v229
    buffer_load_dwordx4 v[80:83], v252, s[40:43], 0 offen offset:2048
    s_waitcnt lgkmcnt(14)
    ds_write_b128 v253, v[236:239] offset:17408
    v_cvt_pk_bf16_f32 v241, v230, v231
    v_cvt_pk_bf16_f32 v242, v232, v233
    v_cvt_pk_bf16_f32 v243, v234, v235
    buffer_load_dwordx4 v[84:87], v252, s[40:43], 0 offen offset:3072
    s_waitcnt lgkmcnt(14)
    ds_write_b128 v253, v[240:243] offset:23552
    buffer_load_dwordx4 v[88:91], v252, s[40:43], s62 offen offset:0
    buffer_load_dwordx4 v[92:95], v252, s[40:43], s62 offen offset:1024
    buffer_load_dwordx4 v[96:99], v252, s[40:43], s62 offen offset:2048
    buffer_load_dwordx4 v[100:103], v252, s[40:43], s62 offen offset:3072
    s_waitcnt lgkmcnt(0)
    s_barrier
L_pC:
    s_add_u32 s71, s58, 0
    s_and_b32 s71, s71, 15
    s_mul_i32 s71, s71, 6144
    v_add_u32 v224, s71, v254
    ds_read_b128 v[0:3], v224 offset:0
    ds_read_b128 v[4:7], v224 offset:1024
    ds_read_b128 v[8:11], v224 offset:2048
    ds_read_b128 v[12:15], v224 offset:3072
    ds_read_b128 v[16:19], v224 offset:4096
    ds_read_b128 v[20:23], v224 offset:5120
    s_mov_b32 vcc_lo, 0xff00ff
    s_mov_b32 vcc_hi, 0xff00ff
    s_waitcnt vmcnt(24)
    v_cndmask_b32_dpp v104, v194, v192, vcc row_ror:8 row_mask:0xf bank_mask:0xf
    v_cndmask_b32_dpp v105, v198, v196, vcc row_ror:8 row_mask:0xf bank_mask:0xf
    v_cndmask_b32_dpp v106, v202, v200, vcc row_ror:8 row_mask:0xf bank_mask:0xf
    v_cndmask_b32_dpp v107, v206, v204, vcc row_ror:8 row_mask:0xf bank_mask:0xf
    v_cndmask_b32_dpp v108, v210, v208, vcc row_ror:8 row_mask:0xf bank_mask:0xf
    v_cndmask_b32_dpp v109, v214, v212, vcc row_ror:8 row_mask:0xf bank_mask:0xf
    v_cndmask_b32_dpp v110, v218, v216, vcc row_ror:8 row_mask:0xf bank_mask:0xf
    v_cndmask_b32_dpp v111, v222, v220, vcc row_ror:8 row_mask:0xf bank_mask:0xf
    v_perm_b32 v48, v105, v104, s65
    v_perm_b32 v49, v107, v106, s65
    v_perm_b32 v50, v109, v108, s65
    v_perm_b32 v51, v111, v110, s65
    v_perm_b32 v52, v105, v104, s66
    v_perm_b32 v53, v107, v106, s66
    v_perm_b32 v54, v109, v108, s66
    v_perm_b32 v55, v111, v110, s66
    s_waitcnt lgkmcnt(0)
    v_mfma_f32_16x16x32_bf16 a[0:3], v[48:51], v[0:3], 0
    s_add_u32 s71, s58, 1
    v_cndmask_b32_dpp v112, v195, v193, vcc row_ror:8 row_mask:0xf bank_mask:0xf
    v_cndmask_b32_dpp v113, v199, v197, vcc row_ror:8 row_mask:0xf bank_mask:0xf
    v_cndmask_b32_dpp v114, v203, v201, vcc row_ror:8 row_mask:0xf bank_mask:0xf
    v_mfma_f32_16x16x32_bf16 a[4:7], v[52:55], v[0:3], 0
    s_and_b32 s71, s71, 15
    v_cndmask_b32_dpp v115, v207, v205, vcc row_ror:8 row_mask:0xf bank_mask:0xf
    v_cndmask_b32_dpp v116, v211, v209, vcc row_ror:8 row_mask:0xf bank_mask:0xf
    v_cndmask_b32_dpp v117, v215, v213, vcc row_ror:8 row_mask:0xf bank_mask:0xf
    v_mfma_f32_16x16x32_bf16 a[20:23], v[52:55], v[4:7], 0
    s_mul_i32 s71, s71, 6144
    v_cndmask_b32_dpp v118, v219, v217, vcc row_ror:8 row_mask:0xf bank_mask:0xf
    v_cndmask_b32_dpp v119, v223, v221, vcc row_ror:8 row_mask:0xf bank_mask:0xf
    v_mfma_f32_16x16x32_bf16 a[16:19], v[48:51], v[4:7], 0
    s_not_b64 vcc, vcc
    v_perm_b32 v56, v113, v112, s65
    v_perm_b32 v57, v115, v114, s65
    v_mfma_f32_16x16x32_bf16 a[32:35], v[48:51], v[8:11], 0
    v_perm_b32 v58, v117, v116, s65
    v_perm_b32 v59, v119, v118, s65
    v_mfma_f32_16x16x32_bf16 a[36:39], v[52:55], v[8:11], 0
    v_perm_b32 v60, v113, v112, s66
    v_perm_b32 v61, v115, v114, s66
    v_mfma_f32_16x16x32_bf16 a[52:55], v[52:55], v[12:15], 0
    v_perm_b32 v62, v117, v116, s66
    v_perm_b32 v63, v119, v118, s66
    v_mfma_f32_16x16x32_bf16 a[48:51], v[48:51], v[12:15], 0
    v_add_u32 v224, s71, v254
    v_mfma_f32_16x16x32_bf16 a[64:67], v[48:51], v[16:19], 0
    ds_read_b128 v[24:27], v224 offset:0
    v_cndmask_b32_dpp v104, v192, v194, vcc row_ror:8 row_mask:0xf bank_mask:0xf
    v_mfma_f32_16x16x32_bf16 a[68:71], v[52:55], v[16:19], 0
    ds_read_b128 v[28:31], v224 offset:1024
    v_cndmask_b32_dpp v105, v196, v198, vcc row_ror:8 row_mask:0xf bank_mask:0xf
    v_mfma_f32_16x16x32_bf16 a[84:87], v[52:55], v[20:23], 0
    ds_read_b128 v[32:35], v224 offset:2048
    v_cndmask_b32_dpp v106, v200, v202, vcc row_ror:8 row_mask:0xf bank_mask:0xf
    v_mfma_f32_16x16x32_bf16 a[80:83], v[48:51], v[20:23], 0
    ds_read_b128 v[36:39], v224 offset:3072
    v_cndmask_b32_dpp v107, v204, v206, vcc row_ror:8 row_mask:0xf bank_mask:0xf
    v_mfma_f32_16x16x32_bf16 a[88:91], v[56:59], v[20:23], 0
    ds_read_b128 v[40:43], v224 offset:4096
    v_cndmask_b32_dpp v108, v208, v210, vcc row_ror:8 row_mask:0xf bank_mask:0xf
    v_mfma_f32_16x16x32_bf16 a[92:95], v[60:63], v[20:23], 0
    ds_read_b128 v[44:47], v224 offset:5120
    v_cndmask_b32_dpp v109, v212, v214, vcc row_ror:8 row_mask:0xf bank_mask:0xf
    v_mfma_f32_16x16x32_bf16 a[76:79], v[60:63], v[16:19], 0
    v_cndmask_b32_dpp v110, v216, v218, vcc row_ror:8 row_mask:0xf bank_mask:0xf
    v_cndmask_b32_dpp v111, v220, v222, vcc row_ror:8 row_mask:0xf bank_mask:0xf
    v_mfma_f32_16x16x32_bf16 a[72:75], v[56:59], v[16:19], 0
    v_perm_b32 v48, v105, v104, s65
    v_perm_b32 v49, v107, v106, s65
    v_mfma_f32_16x16x32_bf16 a[56:59], v[56:59], v[12:15], 0
    v_perm_b32 v50, v109, v108, s65
    v_perm_b32 v51, v111, v110, s65
    v_mfma_f32_16x16x32_bf16 a[60:63], v[60:63], v[12:15], 0
    v_perm_b32 v52, v105, v104, s66
    v_perm_b32 v53, v107, v106, s66
    v_mfma_f32_16x16x32_bf16 a[44:47], v[60:63], v[8:11], 0
    v_perm_b32 v54, v109, v108, s66
    v_perm_b32 v55, v111, v110, s66
    v_mfma_f32_16x16x32_bf16 a[40:43], v[56:59], v[8:11], 0
    v_cndmask_b32_dpp v112, v193, v195, vcc row_ror:8 row_mask:0xf bank_mask:0xf
    v_mfma_f32_16x16x32_bf16 a[24:27], v[56:59], v[4:7], 0
    v_cndmask_b32_dpp v113, v197, v199, vcc row_ror:8 row_mask:0xf bank_mask:0xf
    v_mfma_f32_16x16x32_bf16 a[28:31], v[60:63], v[4:7], 0
    s_add_u32 s71, s58, 2
    v_cndmask_b32_dpp v114, v201, v203, vcc row_ror:8 row_mask:0xf bank_mask:0xf
    v_cndmask_b32_dpp v115, v205, v207, vcc row_ror:8 row_mask:0xf bank_mask:0xf
    v_mfma_f32_16x16x32_bf16 a[12:15], v[60:63], v[0:3], 0
    s_and_b32 s71, s71, 15
    v_cndmask_b32_dpp v116, v209, v211, vcc row_ror:8 row_mask:0xf bank_mask:0xf
    v_cndmask_b32_dpp v117, v213, v215, vcc row_ror:8 row_mask:0xf bank_mask:0xf
    v_mfma_f32_16x16x32_bf16 a[8:11], v[56:59], v[0:3], 0
    s_waitcnt lgkmcnt(0)
    v_cndmask_b32_dpp v118, v217, v219, vcc row_ror:8 row_mask:0xf bank_mask:0xf
    v_cndmask_b32_dpp v119, v221, v223, vcc row_ror:8 row_mask:0xf bank_mask:0xf
    v_mfma_f32_16x16x32_bf16 a[0:3], v[48:51], v[24:27], a[0:3]
    s_mul_i32 s71, s71, 6144
    v_perm_b32 v56, v113, v112, s65
    v_perm_b32 v57, v115, v114, s65
    v_mfma_f32_16x16x32_bf16 a[4:7], v[52:55], v[24:27], a[4:7]
    v_perm_b32 v58, v117, v116, s65
    v_perm_b32 v59, v119, v118, s65
    v_mfma_f32_16x16x32_bf16 a[20:23], v[52:55], v[28:31], a[20:23]
    v_perm_b32 v60, v113, v112, s66
    v_perm_b32 v61, v115, v114, s66
    v_mfma_f32_16x16x32_bf16 a[16:19], v[48:51], v[28:31], a[16:19]
    v_perm_b32 v62, v117, v116, s66
    v_perm_b32 v63, v119, v118, s66
    v_mfma_f32_16x16x32_bf16 a[32:35], v[48:51], v[32:35], a[32:35]
    v_add_u32 v224, s71, v254
    v_mfma_f32_16x16x32_bf16 a[36:39], v[52:55], v[32:35], a[36:39]
    s_lshl_b32 s71, s101, 16
    s_add_u32 s40, s99, s71
    s_addc_u32 s41, s100, 0
    v_mfma_f32_16x16x32_bf16 a[52:55], v[52:55], v[36:39], a[52:55]
    s_add_u32 s101, s101, 1
    s_and_b32 s101, s101, 7
    s_not_b64 vcc, vcc
    v_mfma_f32_16x16x32_bf16 a[48:51], v[48:51], v[36:39], a[48:51]
    s_waitcnt vmcnt(16)
    ds_read_b128 v[0:3], v224 offset:0
    v_cndmask_b32_dpp v104, v178, v176, vcc row_ror:8 row_mask:0xf bank_mask:0xf
    v_mfma_f32_16x16x32_bf16 a[64:67], v[48:51], v[40:43], a[64:67]
    ds_read_b128 v[4:7], v224 offset:1024
    v_cndmask_b32_dpp v105, v182, v180, vcc row_ror:8 row_mask:0xf bank_mask:0xf
    v_mfma_f32_16x16x32_bf16 a[68:71], v[52:55], v[40:43], a[68:71]
    ds_read_b128 v[8:11], v224 offset:2048
    v_cndmask_b32_dpp v106, v186, v184, vcc row_ror:8 row_mask:0xf bank_mask:0xf
    v_mfma_f32_16x16x32_bf16 a[84:87], v[52:55], v[44:47], a[84:87]
    ds_read_b128 v[12:15], v224 offset:3072
    v_cndmask_b32_dpp v107, v190, v188, vcc row_ror:8 row_mask:0xf bank_mask:0xf
    v_mfma_f32_16x16x32_bf16 a[80:83], v[48:51], v[44:47], a[80:83]
    ds_read_b128 v[16:19], v224 offset:4096
    v_cndmask_b32_dpp v108, v130, v128, vcc row_ror:8 row_mask:0xf bank_mask:0xf
    v_mfma_f32_16x16x32_bf16 a[88:91], v[56:59], v[44:47], a[88:91]
    ds_read_b128 v[20:23], v224 offset:5120
    v_cndmask_b32_dpp v109, v134, v132, vcc row_ror:8 row_mask:0xf bank_mask:0xf
    v_mfma_f32_16x16x32_bf16 a[92:95], v[60:63], v[44:47], a[92:95]
    buffer_load_dwordx4 v[192:195], v252, s[40:43], 0 offen offset:0
    v_mfma_f32_16x16x32_bf16 a[76:79], v[60:63], v[40:43], a[76:79]
    v_cndmask_b32_dpp v110, v138, v136, vcc row_ror:8 row_mask:0xf bank_mask:0xf
    v_cndmask_b32_dpp v111, v142, v140, vcc row_ror:8 row_mask:0xf bank_mask:0xf
    v_mfma_f32_16x16x32_bf16 a[72:75], v[56:59], v[40:43], a[72:75]
    v_perm_b32 v48, v105, v104, s65
    v_perm_b32 v49, v107, v106, s65
    v_mfma_f32_16x16x32_bf16 a[56:59], v[56:59], v[36:39], a[56:59]
    v_perm_b32 v50, v109, v108, s65
    v_perm_b32 v51, v111, v110, s65
    v_mfma_f32_16x16x32_bf16 a[60:63], v[60:63], v[36:39], a[60:63]
    buffer_load_dwordx4 v[196:199], v252, s[40:43], 0 offen offset:1024
    v_mfma_f32_16x16x32_bf16 a[44:47], v[60:63], v[32:35], a[44:47]
    v_perm_b32 v52, v105, v104, s66
    v_perm_b32 v53, v107, v106, s66
    v_mfma_f32_16x16x32_bf16 a[40:43], v[56:59], v[32:35], a[40:43]
    v_perm_b32 v54, v109, v108, s66
    v_perm_b32 v55, v111, v110, s66
    v_mfma_f32_16x16x32_bf16 a[24:27], v[56:59], v[28:31], a[24:27]
    v_cndmask_b32_dpp v112, v179, v177, vcc row_ror:8 row_mask:0xf bank_mask:0xf
    v_cndmask_b32_dpp v113, v183, v181, vcc row_ror:8 row_mask:0xf bank_mask:0xf
    v_mfma_f32_16x16x32_bf16 a[28:31], v[60:63], v[28:31], a[28:31]
    v_cndmask_b32_dpp v114, v187, v185, vcc row_ror:8 row_mask:0xf bank_mask:0xf
    v_cndmask_b32_dpp v115, v191, v189, vcc row_ror:8 row_mask:0xf bank_mask:0xf
    v_mfma_f32_16x16x32_bf16 a[12:15], v[60:63], v[24:27], a[12:15]
    s_add_u32 s71, s58, 3
    v_cndmask_b32_dpp v116, v131, v129, vcc row_ror:8 row_mask:0xf bank_mask:0xf
    v_cndmask_b32_dpp v117, v135, v133, vcc row_ror:8 row_mask:0xf bank_mask:0xf
    v_mfma_f32_16x16x32_bf16 a[8:11], v[56:59], v[24:27], a[8:11]
    s_waitcnt lgkmcnt(0)
    buffer_load_dwordx4 v[200:203], v252, s[40:43], 0 offen offset:2048
    v_mfma_f32_16x16x32_bf16 a[0:3], v[48:51], v[0:3], a[0:3]
    s_and_b32 s71, s71, 15
    v_cndmask_b32_dpp v118, v139, v137, vcc row_ror:8 row_mask:0xf bank_mask:0xf
    v_cndmask_b32_dpp v119, v143, v141, vcc row_ror:8 row_mask:0xf bank_mask:0xf
    v_mfma_f32_16x16x32_bf16 a[4:7], v[52:55], v[0:3], a[4:7]
    s_mul_i32 s71, s71, 6144
    v_perm_b32 v56, v113, v112, s65
    v_perm_b32 v57, v115, v114, s65
    v_mfma_f32_16x16x32_bf16 a[20:23], v[52:55], v[4:7], a[20:23]
    s_not_b64 vcc, vcc
    v_perm_b32 v58, v117, v116, s65
    v_perm_b32 v59, v119, v118, s65
    v_mfma_f32_16x16x32_bf16 a[16:19], v[48:51], v[4:7], a[16:19]
    v_perm_b32 v60, v113, v112, s66
    v_perm_b32 v61, v115, v114, s66
    v_mfma_f32_16x16x32_bf16 a[32:35], v[48:51], v[8:11], a[32:35]
    v_perm_b32 v62, v117, v116, s66
    v_perm_b32 v63, v119, v118, s66
    v_mfma_f32_16x16x32_bf16 a[36:39], v[52:55], v[8:11], a[36:39]
    buffer_load_dwordx4 v[204:207], v252, s[40:43], 0 offen offset:3072
    v_mfma_f32_16x16x32_bf16 a[52:55], v[52:55], v[12:15], a[52:55]
    v_add_u32 v224, s71, v254
    v_mfma_f32_16x16x32_bf16 a[48:51], v[48:51], v[12:15], a[48:51]
    v_cndmask_b32_dpp v104, v176, v178, vcc row_ror:8 row_mask:0xf bank_mask:0xf
    v_mfma_f32_16x16x32_bf16 a[64:67], v[48:51], v[16:19], a[64:67]
    ds_read_b128 v[24:27], v224 offset:0
    v_cndmask_b32_dpp v105, v180, v182, vcc row_ror:8 row_mask:0xf bank_mask:0xf
    v_mfma_f32_16x16x32_bf16 a[68:71], v[52:55], v[16:19], a[68:71]
    ds_read_b128 v[28:31], v224 offset:1024
    v_cndmask_b32_dpp v106, v184, v186, vcc row_ror:8 row_mask:0xf bank_mask:0xf
    v_mfma_f32_16x16x32_bf16 a[84:87], v[52:55], v[20:23], a[84:87]
    ds_read_b128 v[32:35], v224 offset:2048
    v_cndmask_b32_dpp v107, v188, v190, vcc row_ror:8 row_mask:0xf bank_mask:0xf
    v_mfma_f32_16x16x32_bf16 a[80:83], v[48:51], v[20:23], a[80:83]
    ds_read_b128 v[36:39], v224 offset:3072
    v_cndmask_b32_dpp v108, v128, v130, vcc row_ror:8 row_mask:0xf bank_mask:0xf
    v_mfma_f32_16x16x32_bf16 a[88:91], v[56:59], v[20:23], a[88:91]
    ds_read_b128 v[40:43], v224 offset:4096
    v_cndmask_b32_dpp v109, v132, v134, vcc row_ror:8 row_mask:0xf bank_mask:0xf
    v_mfma_f32_16x16x32_bf16 a[92:95], v[60:63], v[20:23], a[92:95]
    ds_read_b128 v[44:47], v224 offset:5120
    v_cndmask_b32_dpp v110, v136, v138, vcc row_ror:8 row_mask:0xf bank_mask:0xf
    v_mfma_f32_16x16x32_bf16 a[76:79], v[60:63], v[16:19], a[76:79]
    buffer_load_dwordx4 v[208:211], v252, s[40:43], s62 offen offset:0
    v_mfma_f32_16x16x32_bf16 a[72:75], v[56:59], v[16:19], a[72:75]
    v_cndmask_b32_dpp v111, v140, v142, vcc row_ror:8 row_mask:0xf bank_mask:0xf
    v_perm_b32 v48, v105, v104, s65
    v_mfma_f32_16x16x32_bf16 a[56:59], v[56:59], v[12:15], a[56:59]
    v_perm_b32 v49, v107, v106, s65
    v_perm_b32 v50, v109, v108, s65
    v_mfma_f32_16x16x32_bf16 a[60:63], v[60:63], v[12:15], a[60:63]
    buffer_load_dwordx4 v[212:215], v252, s[40:43], s62 offen offset:1024
    v_mfma_f32_16x16x32_bf16 a[44:47], v[60:63], v[8:11], a[44:47]
    v_perm_b32 v51, v111, v110, s65
    v_perm_b32 v52, v105, v104, s66
    v_mfma_f32_16x16x32_bf16 a[40:43], v[56:59], v[8:11], a[40:43]
    v_perm_b32 v53, v107, v106, s66
    v_perm_b32 v54, v109, v108, s66
    v_mfma_f32_16x16x32_bf16 a[24:27], v[56:59], v[4:7], a[24:27]
    v_perm_b32 v55, v111, v110, s66
    v_cndmask_b32_dpp v112, v177, v179, vcc row_ror:8 row_mask:0xf bank_mask:0xf
    v_mfma_f32_16x16x32_bf16 a[28:31], v[60:63], v[4:7], a[28:31]
    v_cndmask_b32_dpp v113, v181, v183, vcc row_ror:8 row_mask:0xf bank_mask:0xf
    v_cndmask_b32_dpp v114, v185, v187, vcc row_ror:8 row_mask:0xf bank_mask:0xf
    v_mfma_f32_16x16x32_bf16 a[12:15], v[60:63], v[0:3], a[12:15]
    s_add_u32 s71, s58, 4
    v_cndmask_b32_dpp v115, v189, v191, vcc row_ror:8 row_mask:0xf bank_mask:0xf
    v_cndmask_b32_dpp v116, v129, v131, vcc row_ror:8 row_mask:0xf bank_mask:0xf
    v_mfma_f32_16x16x32_bf16 a[8:11], v[56:59], v[0:3], a[8:11]
    s_waitcnt lgkmcnt(0)
    buffer_load_dwordx4 v[216:219], v252, s[40:43], s62 offen offset:2048
    v_mfma_f32_16x16x32_bf16 a[0:3], v[48:51], v[24:27], a[0:3]
    s_and_b32 s71, s71, 15
    v_cndmask_b32_dpp v117, v133, v135, vcc row_ror:8 row_mask:0xf bank_mask:0xf
    v_cndmask_b32_dpp v118, v137, v139, vcc row_ror:8 row_mask:0xf bank_mask:0xf
    v_mfma_f32_16x16x32_bf16 a[4:7], v[52:55], v[24:27], a[4:7]
    s_mul_i32 s71, s71, 6144
    v_cndmask_b32_dpp v119, v141, v143, vcc row_ror:8 row_mask:0xf bank_mask:0xf
    v_perm_b32 v56, v113, v112, s65
    v_mfma_f32_16x16x32_bf16 a[20:23], v[52:55], v[28:31], a[20:23]
    v_perm_b32 v57, v115, v114, s65
    v_perm_b32 v58, v117, v116, s65
    v_mfma_f32_16x16x32_bf16 a[16:19], v[48:51], v[28:31], a[16:19]
    v_perm_b32 v59, v119, v118, s65
    v_perm_b32 v60, v113, v112, s66
    v_mfma_f32_16x16x32_bf16 a[32:35], v[48:51], v[32:35], a[32:35]
    v_perm_b32 v61, v115, v114, s66
    v_perm_b32 v62, v117, v116, s66
    v_mfma_f32_16x16x32_bf16 a[36:39], v[52:55], v[32:35], a[36:39]
    buffer_load_dwordx4 v[220:223], v252, s[40:43], s62 offen offset:3072
    v_mfma_f32_16x16x32_bf16 a[52:55], v[52:55], v[36:39], a[52:55]
    v_perm_b32 v63, v119, v118, s66
    v_add_u32 v224, s71, v254
    v_mfma_f32_16x16x32_bf16 a[48:51], v[48:51], v[36:39], a[48:51]
    s_lshl_b32 s71, s101, 16
    s_add_u32 s40, s99, s71
    s_addc_u32 s41, s100, 0
    v_mfma_f32_16x16x32_bf16 a[64:67], v[48:51], v[40:43], a[64:67]
    s_add_u32 s101, s101, 1
    ds_read_b128 v[0:3], v224 offset:0
    ds_read_b128 v[4:7], v224 offset:1024
    v_mfma_f32_16x16x32_bf16 a[68:71], v[52:55], v[40:43], a[68:71]
    s_and_b32 s101, s101, 7
    ds_read_b128 v[8:11], v224 offset:2048
    ds_read_b128 v[12:15], v224 offset:3072
    v_mfma_f32_16x16x32_bf16 a[84:87], v[52:55], v[44:47], a[84:87]
    ds_read_b128 v[16:19], v224 offset:4096
    ds_read_b128 v[20:23], v224 offset:5120
    v_mfma_f32_16x16x32_bf16 a[80:83], v[48:51], v[44:47], a[80:83]
    buffer_load_dwordx4 v[176:179], v252, s[40:43], 0 offen offset:0
    v_mfma_f32_16x16x32_bf16 a[88:91], v[56:59], v[44:47], a[88:91]
    s_waitcnt vmcnt(17)
    s_not_b64 vcc, vcc
    v_cndmask_b32_dpp v104, v146, v144, vcc row_ror:8 row_mask:0xf bank_mask:0xf
    v_mfma_f32_16x16x32_bf16 a[92:95], v[60:63], v[44:47], a[92:95]
    v_cndmask_b32_dpp v105, v150, v148, vcc row_ror:8 row_mask:0xf bank_mask:0xf
    v_cndmask_b32_dpp v106, v154, v152, vcc row_ror:8 row_mask:0xf bank_mask:0xf
    v_mfma_f32_16x16x32_bf16 a[76:79], v[60:63], v[40:43], a[76:79]
    v_cndmask_b32_dpp v107, v158, v156, vcc row_ror:8 row_mask:0xf bank_mask:0xf
    v_cndmask_b32_dpp v108, v162, v160, vcc row_ror:8 row_mask:0xf bank_mask:0xf
    v_mfma_f32_16x16x32_bf16 a[72:75], v[56:59], v[40:43], a[72:75]
    v_cndmask_b32_dpp v109, v166, v164, vcc row_ror:8 row_mask:0xf bank_mask:0xf
    v_cndmask_b32_dpp v110, v170, v168, vcc row_ror:8 row_mask:0xf bank_mask:0xf
    v_mfma_f32_16x16x32_bf16 a[56:59], v[56:59], v[36:39], a[56:59]
    v_cndmask_b32_dpp v111, v174, v172, vcc row_ror:8 row_mask:0xf bank_mask:0xf
    v_perm_b32 v48, v105, v104, s65
    v_mfma_f32_16x16x32_bf16 a[60:63], v[60:63], v[36:39], a[60:63]
    buffer_load_dwordx4 v[180:183], v252, s[40:43], 0 offen offset:1024
    v_mfma_f32_16x16x32_bf16 a[44:47], v[60:63], v[32:35], a[44:47]
    v_perm_b32 v49, v107, v106, s65
    v_perm_b32 v50, v109, v108, s65
    v_mfma_f32_16x16x32_bf16 a[40:43], v[56:59], v[32:35], a[40:43]
    v_perm_b32 v51, v111, v110, s65
    v_perm_b32 v52, v105, v104, s66
    v_mfma_f32_16x16x32_bf16 a[24:27], v[56:59], v[28:31], a[24:27]
    v_perm_b32 v53, v107, v106, s66
    v_perm_b32 v54, v109, v108, s66
    v_mfma_f32_16x16x32_bf16 a[28:31], v[60:63], v[28:31], a[28:31]
    v_perm_b32 v55, v111, v110, s66
    v_cndmask_b32_dpp v112, v147, v145, vcc row_ror:8 row_mask:0xf bank_mask:0xf
    v_mfma_f32_16x16x32_bf16 a[12:15], v[60:63], v[24:27], a[12:15]
    s_add_u32 s71, s58, 5
    v_cndmask_b32_dpp v113, v151, v149, vcc row_ror:8 row_mask:0xf bank_mask:0xf
    v_cndmask_b32_dpp v114, v155, v153, vcc row_ror:8 row_mask:0xf bank_mask:0xf
    v_mfma_f32_16x16x32_bf16 a[8:11], v[56:59], v[24:27], a[8:11]
    s_waitcnt lgkmcnt(0)
    buffer_load_dwordx4 v[184:187], v252, s[40:43], 0 offen offset:2048
    v_mfma_f32_16x16x32_bf16 a[0:3], v[48:51], v[0:3], a[0:3]
    s_and_b32 s71, s71, 15
    v_cndmask_b32_dpp v115, v159, v157, vcc row_ror:8 row_mask:0xf bank_mask:0xf
    v_cndmask_b32_dpp v116, v163, v161, vcc row_ror:8 row_mask:0xf bank_mask:0xf
    v_mfma_f32_16x16x32_bf16 a[4:7], v[52:55], v[0:3], a[4:7]
    s_mul_i32 s71, s71, 6144
    v_cndmask_b32_dpp v117, v167, v165, vcc row_ror:8 row_mask:0xf bank_mask:0xf
    v_cndmask_b32_dpp v118, v171, v169, vcc row_ror:8 row_mask:0xf bank_mask:0xf
    v_mfma_f32_16x16x32_bf16 a[20:23], v[52:55], v[4:7], a[20:23]
    v_cndmask_b32_dpp v119, v175, v173, vcc row_ror:8 row_mask:0xf bank_mask:0xf
    v_perm_b32 v56, v113, v112, s65
    v_mfma_f32_16x16x32_bf16 a[16:19], v[48:51], v[4:7], a[16:19]
    s_not_b64 vcc, vcc
    v_perm_b32 v57, v115, v114, s65
    v_perm_b32 v58, v117, v116, s65
    v_mfma_f32_16x16x32_bf16 a[32:35], v[48:51], v[8:11], a[32:35]
    v_perm_b32 v59, v119, v118, s65
    v_perm_b32 v60, v113, v112, s66
    v_perm_b32 v61, v115, v114, s66
    v_mfma_f32_16x16x32_bf16 a[36:39], v[52:55], v[8:11], a[36:39]
    buffer_load_dwordx4 v[188:191], v252, s[40:43], 0 offen offset:3072
    v_mfma_f32_16x16x32_bf16 a[52:55], v[52:55], v[12:15], a[52:55]
    v_perm_b32 v62, v117, v116, s66
    v_perm_b32 v63, v119, v118, s66
    v_add_u32 v224, s71, v254
    v_mfma_f32_16x16x32_bf16 a[48:51], v[48:51], v[12:15], a[48:51]
    v_cndmask_b32_dpp v104, v144, v146, vcc row_ror:8 row_mask:0xf bank_mask:0xf
    v_cndmask_b32_dpp v105, v148, v150, vcc row_ror:8 row_mask:0xf bank_mask:0xf
    v_cndmask_b32_dpp v106, v152, v154, vcc row_ror:8 row_mask:0xf bank_mask:0xf
    v_mfma_f32_16x16x32_bf16 a[64:67], v[48:51], v[16:19], a[64:67]
    ds_read_b128 v[24:27], v224 offset:0
    v_cndmask_b32_dpp v107, v156, v158, vcc row_ror:8 row_mask:0xf bank_mask:0xf
    v_mfma_f32_16x16x32_bf16 a[68:71], v[52:55], v[16:19], a[68:71]
    ds_read_b128 v[28:31], v224 offset:1024
    v_cndmask_b32_dpp v108, v160, v162, vcc row_ror:8 row_mask:0xf bank_mask:0xf
    v_mfma_f32_16x16x32_bf16 a[84:87], v[52:55], v[20:23], a[84:87]
    ds_read_b128 v[32:35], v224 offset:2048
    v_cndmask_b32_dpp v109, v164, v166, vcc row_ror:8 row_mask:0xf bank_mask:0xf
    v_mfma_f32_16x16x32_bf16 a[80:83], v[48:51], v[20:23], a[80:83]
    s_add_u32 s70, s69, L_k1_code_end-32768-L_k1_start
    ds_read_b128 v[36:39], v224 offset:3072
    v_cndmask_b32_dpp v110, v168, v170, vcc row_ror:8 row_mask:0xf bank_mask:0xf
    v_mfma_f32_16x16x32_bf16 a[88:91], v[56:59], v[20:23], a[88:91]
    s_lshl_b32 s9, s44, 1
    ds_read_b128 v[40:43], v224 offset:4096
    v_cndmask_b32_dpp v111, v172, v174, vcc row_ror:8 row_mask:0xf bank_mask:0xf
    v_mfma_f32_16x16x32_bf16 a[92:95], v[60:63], v[20:23], a[92:95]
    s_xor_b32 s9, s9, s46
    ds_read_b128 v[44:47], v224 offset:5120
    v_perm_b32 v48, v105, v104, s65
    v_mfma_f32_16x16x32_bf16 a[76:79], v[60:63], v[16:19], a[76:79]
    buffer_load_dwordx4 v[128:131], v252, s[40:43], s62 offen offset:0
    v_mfma_f32_16x16x32_bf16 a[72:75], v[56:59], v[16:19], a[72:75]
    s_min_u32 s10, s9, 1
    v_perm_b32 v49, v107, v106, s65
    v_perm_b32 v50, v109, v108, s65
    v_perm_b32 v51, v111, v110, s65
    v_mfma_f32_16x16x32_bf16 a[56:59], v[56:59], v[12:15], a[56:59]
    buffer_load_dwordx4 v[132:135], v252, s[40:43], s62 offen offset:1024
    v_mfma_f32_16x16x32_bf16 a[60:63], v[60:63], v[12:15], a[60:63]
    s_lshl_b32 s10, s10, 14
    v_perm_b32 v52, v105, v104, s66
    v_perm_b32 v53, v107, v106, s66
    v_perm_b32 v54, v109, v108, s66
    v_mfma_f32_16x16x32_bf16 a[44:47], v[60:63], v[8:11], a[44:47]
    s_add_u32 s10, s10, 98304
    v_perm_b32 v55, v111, v110, s66
    v_add_u32 v228, s10, v254
    v_mfma_f32_16x16x32_bf16 a[40:43], v[56:59], v[8:11], a[40:43]
    s_sub_u32 s10, 114688, s10
    s_lshl_b32 s10, s10, 15
    s_xor_b32 s9, s9, 1
    v_mfma_f32_16x16x32_bf16 a[24:27], v[56:59], v[4:7], a[24:27]
    s_min_u32 s9, s9, 1
    s_lshl_b32 s9, s9, 14
    v_add_u32 v230, s10, v253
    v_mfma_f32_16x16x32_bf16 a[28:31], v[60:63], v[4:7], a[28:31]
    buffer_load_dword v225, v254, s[72:75], s70 offen
    v_mfma_f32_16x16x32_bf16 a[12:15], v[60:63], v[0:3], a[12:15]
    s_add_u32 s9, s9, 98304
    v_add_u32 v229, s9, v254
    v_mfma_f32_16x16x32_bf16 a[8:11], v[56:59], v[0:3], a[8:11]
    s_waitcnt lgkmcnt(0)
    buffer_load_dwordx4 v[136:139], v252, s[40:43], s62 offen offset:2048
    v_mfma_f32_16x16x32_bf16 a[0:3], v[48:51], v[24:27], a[0:3]
    s_sub_u32 s9, 114688, s9
    s_lshl_b32 s9, s9, 15
    s_add_u32 s71, s58, 6
    v_mfma_f32_16x16x32_bf16 a[4:7], v[52:55], v[24:27], a[4:7]
    s_and_b32 s71, s71, 15
    v_add_u32 v231, s9, v253
    v_cndmask_b32_dpp v112, v145, v147, vcc row_ror:8 row_mask:0xf bank_mask:0xf
    v_cndmask_b32_dpp v113, v149, v151, vcc row_ror:8 row_mask:0xf bank_mask:0xf
    v_mfma_f32_16x16x32_bf16 a[20:23], v[52:55], v[28:31], a[20:23]
    s_mul_i32 s71, s71, 6144
    v_cndmask_b32_dpp v114, v153, v155, vcc row_ror:8 row_mask:0xf bank_mask:0xf
    v_cndmask_b32_dpp v115, v157, v159, vcc row_ror:8 row_mask:0xf bank_mask:0xf
    v_cndmask_b32_dpp v116, v161, v163, vcc row_ror:8 row_mask:0xf bank_mask:0xf
    v_mfma_f32_16x16x32_bf16 a[16:19], v[48:51], v[28:31], a[16:19]
    v_cndmask_b32_dpp v117, v165, v167, vcc row_ror:8 row_mask:0xf bank_mask:0xf
    v_cndmask_b32_dpp v118, v169, v171, vcc row_ror:8 row_mask:0xf bank_mask:0xf
    v_cndmask_b32_dpp v119, v173, v175, vcc row_ror:8 row_mask:0xf bank_mask:0xf
    v_mfma_f32_16x16x32_bf16 a[32:35], v[48:51], v[32:35], a[32:35]
    v_perm_b32 v56, v113, v112, s65
    v_perm_b32 v57, v115, v114, s65
    v_perm_b32 v58, v117, v116, s65
    v_mfma_f32_16x16x32_bf16 a[36:39], v[52:55], v[32:35], a[36:39]
    buffer_load_dwordx4 v[140:143], v252, s[40:43], s62 offen offset:3072
    v_mfma_f32_16x16x32_bf16 a[52:55], v[52:55], v[36:39], a[52:55]
    v_perm_b32 v59, v119, v118, s65
    v_perm_b32 v60, v113, v112, s66
    v_perm_b32 v61, v115, v114, s66
    v_mfma_f32_16x16x32_bf16 a[48:51], v[48:51], v[36:39], a[48:51]
    v_perm_b32 v62, v117, v116, s66
    v_perm_b32 v63, v119, v118, s66
    v_add_u32 v224, s71, v254
    v_mfma_f32_16x16x32_bf16 a[64:67], v[48:51], v[40:43], a[64:67]
    s_lshl_b32 s71, s101, 16
    ds_read_b128 v[0:3], v224 offset:0
    ds_read_b128 v[4:7], v224 offset:1024
    v_mfma_f32_16x16x32_bf16 a[68:71], v[52:55], v[40:43], a[68:71]
    s_add_u32 s40, s99, s71
    ds_read_b128 v[8:11], v224 offset:2048
    ds_read_b128 v[12:15], v224 offset:3072
    v_mfma_f32_16x16x32_bf16 a[84:87], v[52:55], v[44:47], a[84:87]
    s_addc_u32 s41, s100, 0
    ds_read_b128 v[16:19], v224 offset:4096
    ds_read_b128 v[20:23], v224 offset:5120
    v_mfma_f32_16x16x32_bf16 a[80:83], v[48:51], v[44:47], a[80:83]
    buffer_load_dwordx4 v[144:147], v252, s[40:43], 0 offen offset:0
    v_mfma_f32_16x16x32_bf16 a[88:91], v[56:59], v[44:47], a[88:91]
    s_add_u32 s101, s101, 1
    s_and_b32 s101, s101, 7
    s_not_b64 vcc, vcc
    v_mfma_f32_16x16x32_bf16 a[92:95], v[60:63], v[44:47], a[92:95]
    s_waitcnt vmcnt(18)
    v_cndmask_b32_dpp v104, v74, v72, vcc row_ror:8 row_mask:0xf bank_mask:0xf
    v_cndmask_b32_dpp v105, v78, v76, vcc row_ror:8 row_mask:0xf bank_mask:0xf
    v_cndmask_b32_dpp v106, v82, v80, vcc row_ror:8 row_mask:0xf bank_mask:0xf
    v_mfma_f32_16x16x32_bf16 a[76:79], v[60:63], v[40:43], a[76:79]
    v_cndmask_b32_dpp v107, v86, v84, vcc row_ror:8 row_mask:0xf bank_mask:0xf
    v_cndmask_b32_dpp v108, v90, v88, vcc row_ror:8 row_mask:0xf bank_mask:0xf
    v_mfma_f32_16x16x32_bf16 a[72:75], v[56:59], v[40:43], a[72:75]
    v_cndmask_b32_dpp v109, v94, v92, vcc row_ror:8 row_mask:0xf bank_mask:0xf
    v_cndmask_b32_dpp v110, v98, v96, vcc row_ror:8 row_mask:0xf bank_mask:0xf
    v_mfma_f32_16x16x32_bf16 a[56:59], v[56:59], v[36:39], a[56:59]
    v_cndmask_b32_dpp v111, v102, v100, vcc row_ror:8 row_mask:0xf bank_mask:0xf
    v_perm_b32 v48, v105, v104, s65
    v_mfma_f32_16x16x32_bf16 a[60:63], v[60:63], v[36:39], a[60:63]
    buffer_load_dwordx4 v[148:151], v252, s[40:43], 0 offen offset:1024
    v_mfma_f32_16x16x32_bf16 a[44:47], v[60:63], v[32:35], a[44:47]
    v_perm_b32 v49, v107, v106, s65
    v_perm_b32 v50, v109, v108, s65
    v_mfma_f32_16x16x32_bf16 a[40:43], v[56:59], v[32:35], a[40:43]
    v_perm_b32 v51, v111, v110, s65
    v_perm_b32 v52, v105, v104, s66
    v_mfma_f32_16x16x32_bf16 a[24:27], v[56:59], v[28:31], a[24:27]
    v_perm_b32 v53, v107, v106, s66
    v_perm_b32 v54, v109, v108, s66
    v_mfma_f32_16x16x32_bf16 a[28:31], v[60:63], v[28:31], a[28:31]
    v_perm_b32 v55, v111, v110, s66
    v_cndmask_b32_dpp v112, v75, v73, vcc row_ror:8 row_mask:0xf bank_mask:0xf
    v_mfma_f32_16x16x32_bf16 a[12:15], v[60:63], v[24:27], a[12:15]
    s_add_u32 s71, s58, 7
    v_cndmask_b32_dpp v113, v79, v77, vcc row_ror:8 row_mask:0xf bank_mask:0xf
    v_cndmask_b32_dpp v114, v83, v81, vcc row_ror:8 row_mask:0xf bank_mask:0xf
    v_mfma_f32_16x16x32_bf16 a[8:11], v[56:59], v[24:27], a[8:11]
    s_waitcnt lgkmcnt(0)
    buffer_load_dwordx4 v[152:155], v252, s[40:43], 0 offen offset:2048
    v_mfma_f32_16x16x32_bf16 a[0:3], v[48:51], v[0:3], a[0:3]
    s_and_b32 s71, s71, 15
    v_cndmask_b32_dpp v115, v87, v85, vcc row_ror:8 row_mask:0xf bank_mask:0xf
    v_cndmask_b32_dpp v116, v91, v89, vcc row_ror:8 row_mask:0xf bank_mask:0xf
    v_mfma_f32_16x16x32_bf16 a[4:7], v[52:55], v[0:3], a[4:7]
    s_mul_i32 s71, s71, 6144
    v_cndmask_b32_dpp v117, v95, v93, vcc row_ror:8 row_mask:0xf bank_mask:0xf
    v_cndmask_b32_dpp v118, v99, v97, vcc row_ror:8 row_mask:0xf bank_mask:0xf
    v_mfma_f32_16x16x32_bf16 a[20:23], v[52:55], v[4:7], a[20:23]
    v_cndmask_b32_dpp v119, v103, v101, vcc row_ror:8 row_mask:0xf bank_mask:0xf
    v_perm_b32 v56, v113, v112, s65
    v_mfma_f32_16x16x32_bf16 a[16:19], v[48:51], v[4:7], a[16:19]
    s_not_b64 vcc, vcc
    v_perm_b32 v57, v115, v114, s65
    v_perm_b32 v58, v117, v116, s65
    v_mfma_f32_16x16x32_bf16 a[32:35], v[48:51], v[8:11], a[32:35]
    v_perm_b32 v59, v119, v118, s65
    v_perm_b32 v60, v113, v112, s66
    v_mfma_f32_16x16x32_bf16 a[36:39], v[52:55], v[8:11], a[36:39]
    buffer_load_dwordx4 v[156:159], v252, s[40:43], 0 offen offset:3072
    v_mfma_f32_16x16x32_bf16 a[52:55], v[52:55], v[12:15], a[52:55]
    v_perm_b32 v61, v115, v114, s66
    v_perm_b32 v62, v117, v116, s66
    v_mfma_f32_16x16x32_bf16 a[48:51], v[48:51], v[12:15], a[48:51]
    v_perm_b32 v63, v119, v118, s66
    v_add_u32 v224, s71, v254
    v_mfma_f32_16x16x32_bf16 a[64:67], v[48:51], v[16:19], a[64:67]
    ds_read_b128 v[24:27], v224 offset:0
    v_cndmask_b32_dpp v104, v72, v74, vcc row_ror:8 row_mask:0xf bank_mask:0xf
    v_mfma_f32_16x16x32_bf16 a[68:71], v[52:55], v[16:19], a[68:71]
    ds_read_b128 v[28:31], v224 offset:1024
    v_cndmask_b32_dpp v105, v76, v78, vcc row_ror:8 row_mask:0xf bank_mask:0xf
    v_mfma_f32_16x16x32_bf16 a[84:87], v[52:55], v[20:23], a[84:87]
    ds_read_b128 v[32:35], v224 offset:2048
    v_cndmask_b32_dpp v106, v80, v82, vcc row_ror:8 row_mask:0xf bank_mask:0xf
    v_mfma_f32_16x16x32_bf16 a[80:83], v[48:51], v[20:23], a[80:83]
    ds_read_b128 v[36:39], v224 offset:3072
    v_cndmask_b32_dpp v107, v84, v86, vcc row_ror:8 row_mask:0xf bank_mask:0xf
    v_mfma_f32_16x16x32_bf16 a[88:91], v[56:59], v[20:23], a[88:91]
    ds_read_b128 v[40:43], v224 offset:4096
    v_cndmask_b32_dpp v108, v88, v90, vcc row_ror:8 row_mask:0xf bank_mask:0xf
    v_mfma_f32_16x16x32_bf16 a[92:95], v[60:63], v[20:23], a[92:95]
    ds_read_b128 v[44:47], v224 offset:5120
    v_cndmask_b32_dpp v109, v92, v94, vcc row_ror:8 row_mask:0xf bank_mask:0xf
    v_mfma_f32_16x16x32_bf16 a[76:79], v[60:63], v[16:19], a[76:79]
    buffer_load_dwordx4 v[160:163], v252, s[40:43], s62 offen offset:0
    v_mfma_f32_16x16x32_bf16 a[72:75], v[56:59], v[16:19], a[72:75]
    v_cndmask_b32_dpp v110, v96, v98, vcc row_ror:8 row_mask:0xf bank_mask:0xf
    v_cndmask_b32_dpp v111, v100, v102, vcc row_ror:8 row_mask:0xf bank_mask:0xf
    v_mfma_f32_16x16x32_bf16 a[56:59], v[56:59], v[12:15], a[56:59]
    v_perm_b32 v48, v105, v104, s65
    v_perm_b32 v49, v107, v106, s65
    v_mfma_f32_16x16x32_bf16 a[60:63], v[60:63], v[12:15], a[60:63]
    buffer_load_dwordx4 v[164:167], v252, s[40:43], s62 offen offset:1024
    v_mfma_f32_16x16x32_bf16 a[44:47], v[60:63], v[8:11], a[44:47]
    v_perm_b32 v50, v109, v108, s65
    v_perm_b32 v51, v111, v110, s65
    v_mfma_f32_16x16x32_bf16 a[40:43], v[56:59], v[8:11], a[40:43]
    v_perm_b32 v52, v105, v104, s66
    v_perm_b32 v53, v107, v106, s66
    v_mfma_f32_16x16x32_bf16 a[24:27], v[56:59], v[4:7], a[24:27]
    v_perm_b32 v54, v109, v108, s66
    v_perm_b32 v55, v111, v110, s66
    v_mfma_f32_16x16x32_bf16 a[28:31], v[60:63], v[4:7], a[28:31]
    v_cndmask_b32_dpp v112, v73, v75, vcc row_ror:8 row_mask:0xf bank_mask:0xf
    v_cndmask_b32_dpp v113, v77, v79, vcc row_ror:8 row_mask:0xf bank_mask:0xf
    v_mfma_f32_16x16x32_bf16 a[12:15], v[60:63], v[0:3], a[12:15]
    s_add_u32 s71, s58, 8
    v_cndmask_b32_dpp v114, v81, v83, vcc row_ror:8 row_mask:0xf bank_mask:0xf
    v_cndmask_b32_dpp v115, v85, v87, vcc row_ror:8 row_mask:0xf bank_mask:0xf
    v_mfma_f32_16x16x32_bf16 a[8:11], v[56:59], v[0:3], a[8:11]
    s_waitcnt lgkmcnt(0)
    buffer_load_dwordx4 v[168:171], v252, s[40:43], s62 offen offset:2048
    v_mfma_f32_16x16x32_bf16 a[0:3], v[48:51], v[24:27], a[0:3]
    s_and_b32 s71, s71, 15
    v_cndmask_b32_dpp v116, v89, v91, vcc row_ror:8 row_mask:0xf bank_mask:0xf
    v_cndmask_b32_dpp v117, v93, v95, vcc row_ror:8 row_mask:0xf bank_mask:0xf
    v_mfma_f32_16x16x32_bf16 a[4:7], v[52:55], v[24:27], a[4:7]
    s_mul_i32 s71, s71, 6144
    v_cndmask_b32_dpp v118, v97, v99, vcc row_ror:8 row_mask:0xf bank_mask:0xf
    v_cndmask_b32_dpp v119, v101, v103, vcc row_ror:8 row_mask:0xf bank_mask:0xf
    v_mfma_f32_16x16x32_bf16 a[20:23], v[52:55], v[28:31], a[20:23]
    v_perm_b32 v56, v113, v112, s65
    v_perm_b32 v57, v115, v114, s65
    v_mfma_f32_16x16x32_bf16 a[16:19], v[48:51], v[28:31], a[16:19]
    v_perm_b32 v58, v117, v116, s65
    v_perm_b32 v59, v119, v118, s65
    v_mfma_f32_16x16x32_bf16 a[32:35], v[48:51], v[32:35], a[32:35]
    v_perm_b32 v60, v113, v112, s66
    v_perm_b32 v61, v115, v114, s66
    v_mfma_f32_16x16x32_bf16 a[36:39], v[52:55], v[32:35], a[36:39]
    buffer_load_dwordx4 v[172:175], v252, s[40:43], s62 offen offset:3072
    v_mfma_f32_16x16x32_bf16 a[52:55], v[52:55], v[36:39], a[52:55]
    v_perm_b32 v62, v117, v116, s66
    v_perm_b32 v63, v119, v118, s66
    v_mfma_f32_16x16x32_bf16 a[48:51], v[48:51], v[36:39], a[48:51]
    v_add_u32 v224, s71, v254
    v_mfma_f32_16x16x32_bf16 a[64:67], v[48:51], v[40:43], a[64:67]
    s_lshl_b32 s71, s101, 16
    ds_read_b128 v[0:3], v224 offset:0
    ds_read_b128 v[4:7], v224 offset:1024
    v_mfma_f32_16x16x32_bf16 a[68:71], v[52:55], v[40:43], a[68:71]
    s_add_u32 s40, s99, s71
    ds_read_b128 v[8:11], v224 offset:2048
    ds_read_b128 v[12:15], v224 offset:3072
    v_mfma_f32_16x16x32_bf16 a[84:87], v[52:55], v[44:47], a[84:87]
    s_addc_u32 s41, s100, 0
    ds_read_b128 v[16:19], v224 offset:4096
    ds_read_b128 v[20:23], v224 offset:5120
    v_mfma_f32_16x16x32_bf16 a[80:83], v[48:51], v[44:47], a[80:83]
    buffer_load_dwordx4 v[72:75], v252, s[40:43], 0 offen offset:0
    v_mfma_f32_16x16x32_bf16 a[88:91], v[56:59], v[44:47], a[88:91]
    s_add_u32 s101, s101, 1
    s_and_b32 s101, s101, 7
    s_not_b64 vcc, vcc
    v_mfma_f32_16x16x32_bf16 a[92:95], v[60:63], v[44:47], a[92:95]
    s_waitcnt vmcnt(18)
    v_cndmask_b32_dpp v104, v194, v192, vcc row_ror:8 row_mask:0xf bank_mask:0xf
    v_cndmask_b32_dpp v105, v198, v196, vcc row_ror:8 row_mask:0xf bank_mask:0xf
    v_cndmask_b32_dpp v106, v202, v200, vcc row_ror:8 row_mask:0xf bank_mask:0xf
    v_mfma_f32_16x16x32_bf16 a[76:79], v[60:63], v[40:43], a[76:79]
    v_cndmask_b32_dpp v107, v206, v204, vcc row_ror:8 row_mask:0xf bank_mask:0xf
    v_cndmask_b32_dpp v108, v210, v208, vcc row_ror:8 row_mask:0xf bank_mask:0xf
    v_mfma_f32_16x16x32_bf16 a[72:75], v[56:59], v[40:43], a[72:75]
    v_cndmask_b32_dpp v109, v214, v212, vcc row_ror:8 row_mask:0xf bank_mask:0xf
    v_cndmask_b32_dpp v110, v218, v216, vcc row_ror:8 row_mask:0xf bank_mask:0xf
    v_mfma_f32_16x16x32_bf16 a[56:59], v[56:59], v[36:39], a[56:59]
    v_cndmask_b32_dpp v111, v222, v220, vcc row_ror:8 row_mask:0xf bank_mask:0xf
    v_perm_b32 v48, v105, v104, s65
    v_mfma_f32_16x16x32_bf16 a[60:63], v[60:63], v[36:39], a[60:63]
    buffer_load_dwordx4 v[76:79], v252, s[40:43], 0 offen offset:1024
    v_mfma_f32_16x16x32_bf16 a[44:47], v[60:63], v[32:35], a[44:47]
    v_perm_b32 v49, v107, v106, s65
    v_perm_b32 v50, v109, v108, s65
    v_mfma_f32_16x16x32_bf16 a[40:43], v[56:59], v[32:35], a[40:43]
    v_perm_b32 v51, v111, v110, s65
    v_perm_b32 v52, v105, v104, s66
    v_mfma_f32_16x16x32_bf16 a[24:27], v[56:59], v[28:31], a[24:27]
    v_perm_b32 v53, v107, v106, s66
    v_perm_b32 v54, v109, v108, s66
    v_mfma_f32_16x16x32_bf16 a[28:31], v[60:63], v[28:31], a[28:31]
    v_perm_b32 v55, v111, v110, s66
    v_cndmask_b32_dpp v112, v195, v193, vcc row_ror:8 row_mask:0xf bank_mask:0xf
    v_mfma_f32_16x16x32_bf16 a[12:15], v[60:63], v[24:27], a[12:15]
    s_add_u32 s71, s58, 9
    v_cndmask_b32_dpp v113, v199, v197, vcc row_ror:8 row_mask:0xf bank_mask:0xf
    v_cndmask_b32_dpp v114, v203, v201, vcc row_ror:8 row_mask:0xf bank_mask:0xf
    v_mfma_f32_16x16x32_bf16 a[8:11], v[56:59], v[24:27], a[8:11]
    s_waitcnt lgkmcnt(0)
    buffer_load_dwordx4 v[80:83], v252, s[40:43], 0 offen offset:2048
    v_mfma_f32_16x16x32_bf16 a[0:3], v[48:51], v[0:3], a[0:3]
    s_and_b32 s71, s71, 15
    v_cndmask_b32_dpp v115, v207, v205, vcc row_ror:8 row_mask:0xf bank_mask:0xf
    v_cndmask_b32_dpp v116, v211, v209, vcc row_ror:8 row_mask:0xf bank_mask:0xf
    v_mfma_f32_16x16x32_bf16 a[4:7], v[52:55], v[0:3], a[4:7]
    s_mul_i32 s71, s71, 6144
    v_cndmask_b32_dpp v117, v215, v213, vcc row_ror:8 row_mask:0xf bank_mask:0xf
    v_cndmask_b32_dpp v118, v219, v217, vcc row_ror:8 row_mask:0xf bank_mask:0xf
    v_mfma_f32_16x16x32_bf16 a[20:23], v[52:55], v[4:7], a[20:23]
    v_cndmask_b32_dpp v119, v223, v221, vcc row_ror:8 row_mask:0xf bank_mask:0xf
    v_perm_b32 v56, v113, v112, s65
    v_mfma_f32_16x16x32_bf16 a[16:19], v[48:51], v[4:7], a[16:19]
    s_not_b64 vcc, vcc
    v_perm_b32 v57, v115, v114, s65
    v_perm_b32 v58, v117, v116, s65
    v_mfma_f32_16x16x32_bf16 a[32:35], v[48:51], v[8:11], a[32:35]
    v_perm_b32 v59, v119, v118, s65
    v_perm_b32 v60, v113, v112, s66
    v_mfma_f32_16x16x32_bf16 a[36:39], v[52:55], v[8:11], a[36:39]
    buffer_load_dwordx4 v[84:87], v252, s[40:43], 0 offen offset:3072
    v_mfma_f32_16x16x32_bf16 a[52:55], v[52:55], v[12:15], a[52:55]
    v_perm_b32 v61, v115, v114, s66
    v_perm_b32 v62, v117, v116, s66
    v_mfma_f32_16x16x32_bf16 a[48:51], v[48:51], v[12:15], a[48:51]
    v_perm_b32 v63, v119, v118, s66
    v_add_u32 v224, s71, v254
    v_mfma_f32_16x16x32_bf16 a[64:67], v[48:51], v[16:19], a[64:67]
    ds_read_b128 v[24:27], v224 offset:0
    v_cndmask_b32_dpp v104, v192, v194, vcc row_ror:8 row_mask:0xf bank_mask:0xf
    v_mfma_f32_16x16x32_bf16 a[68:71], v[52:55], v[16:19], a[68:71]
    ds_read_b128 v[28:31], v224 offset:1024
    v_cndmask_b32_dpp v105, v196, v198, vcc row_ror:8 row_mask:0xf bank_mask:0xf
    v_mfma_f32_16x16x32_bf16 a[84:87], v[52:55], v[20:23], a[84:87]
    ds_read_b128 v[32:35], v224 offset:2048
    v_cndmask_b32_dpp v106, v200, v202, vcc row_ror:8 row_mask:0xf bank_mask:0xf
    v_mfma_f32_16x16x32_bf16 a[80:83], v[48:51], v[20:23], a[80:83]
    ds_read_b128 v[36:39], v224 offset:3072
    v_cndmask_b32_dpp v107, v204, v206, vcc row_ror:8 row_mask:0xf bank_mask:0xf
    v_mfma_f32_16x16x32_bf16 a[88:91], v[56:59], v[20:23], a[88:91]
    ds_read_b128 v[40:43], v224 offset:4096
    v_cndmask_b32_dpp v108, v208, v210, vcc row_ror:8 row_mask:0xf bank_mask:0xf
    v_mfma_f32_16x16x32_bf16 a[92:95], v[60:63], v[20:23], a[92:95]
    ds_read_b128 v[44:47], v224 offset:5120
    v_cndmask_b32_dpp v109, v212, v214, vcc row_ror:8 row_mask:0xf bank_mask:0xf
    v_mfma_f32_16x16x32_bf16 a[76:79], v[60:63], v[16:19], a[76:79]
    buffer_load_dwordx4 v[88:91], v252, s[40:43], s62 offen offset:0
    v_mfma_f32_16x16x32_bf16 a[72:75], v[56:59], v[16:19], a[72:75]
    v_cndmask_b32_dpp v110, v216, v218, vcc row_ror:8 row_mask:0xf bank_mask:0xf
    v_cndmask_b32_dpp v111, v220, v222, vcc row_ror:8 row_mask:0xf bank_mask:0xf
    v_mfma_f32_16x16x32_bf16 a[56:59], v[56:59], v[12:15], a[56:59]
    v_perm_b32 v48, v105, v104, s65
    v_perm_b32 v49, v107, v106, s65
    v_mfma_f32_16x16x32_bf16 a[60:63], v[60:63], v[12:15], a[60:63]
    buffer_load_dwordx4 v[92:95], v252, s[40:43], s62 offen offset:1024
    v_mfma_f32_16x16x32_bf16 a[44:47], v[60:63], v[8:11], a[44:47]
    v_perm_b32 v50, v109, v108, s65
    v_perm_b32 v51, v111, v110, s65
    v_mfma_f32_16x16x32_bf16 a[40:43], v[56:59], v[8:11], a[40:43]
    v_perm_b32 v52, v105, v104, s66
    v_perm_b32 v53, v107, v106, s66
    v_mfma_f32_16x16x32_bf16 a[24:27], v[56:59], v[4:7], a[24:27]
    v_perm_b32 v54, v109, v108, s66
    v_perm_b32 v55, v111, v110, s66
    v_mfma_f32_16x16x32_bf16 a[28:31], v[60:63], v[4:7], a[28:31]
    v_cndmask_b32_dpp v112, v193, v195, vcc row_ror:8 row_mask:0xf bank_mask:0xf
    v_cndmask_b32_dpp v113, v197, v199, vcc row_ror:8 row_mask:0xf bank_mask:0xf
    v_mfma_f32_16x16x32_bf16 a[12:15], v[60:63], v[0:3], a[12:15]
    s_add_u32 s71, s58, 10
    v_cndmask_b32_dpp v114, v201, v203, vcc row_ror:8 row_mask:0xf bank_mask:0xf
    v_cndmask_b32_dpp v115, v205, v207, vcc row_ror:8 row_mask:0xf bank_mask:0xf
    v_mfma_f32_16x16x32_bf16 a[8:11], v[56:59], v[0:3], a[8:11]
    s_waitcnt lgkmcnt(0)
    buffer_load_dwordx4 v[96:99], v252, s[40:43], s62 offen offset:2048
    v_mfma_f32_16x16x32_bf16 a[0:3], v[48:51], v[24:27], a[0:3]
    s_and_b32 s71, s71, 15
    v_cndmask_b32_dpp v116, v209, v211, vcc row_ror:8 row_mask:0xf bank_mask:0xf
    v_cndmask_b32_dpp v117, v213, v215, vcc row_ror:8 row_mask:0xf bank_mask:0xf
    v_mfma_f32_16x16x32_bf16 a[4:7], v[52:55], v[24:27], a[4:7]
    s_mul_i32 s71, s71, 6144
    v_cndmask_b32_dpp v118, v217, v219, vcc row_ror:8 row_mask:0xf bank_mask:0xf
    v_cndmask_b32_dpp v119, v221, v223, vcc row_ror:8 row_mask:0xf bank_mask:0xf
    v_mfma_f32_16x16x32_bf16 a[20:23], v[52:55], v[28:31], a[20:23]
    v_perm_b32 v56, v113, v112, s65
    v_perm_b32 v57, v115, v114, s65
    v_mfma_f32_16x16x32_bf16 a[16:19], v[48:51], v[28:31], a[16:19]
    v_perm_b32 v58, v117, v116, s65
    v_perm_b32 v59, v119, v118, s65
    v_mfma_f32_16x16x32_bf16 a[32:35], v[48:51], v[32:35], a[32:35]
    v_perm_b32 v60, v113, v112, s66
    v_perm_b32 v61, v115, v114, s66
    v_mfma_f32_16x16x32_bf16 a[36:39], v[52:55], v[32:35], a[36:39]
    buffer_load_dwordx4 v[100:103], v252, s[40:43], s62 offen offset:3072
    v_mfma_f32_16x16x32_bf16 a[52:55], v[52:55], v[36:39], a[52:55]
    v_perm_b32 v62, v117, v116, s66
    v_perm_b32 v63, v119, v118, s66
    v_mfma_f32_16x16x32_bf16 a[48:51], v[48:51], v[36:39], a[48:51]
    v_add_u32 v224, s71, v254
    v_mfma_f32_16x16x32_bf16 a[64:67], v[48:51], v[40:43], a[64:67]
    s_lshl_b32 s71, s101, 16
    ds_read_b128 v[0:3], v224 offset:0
    ds_read_b128 v[4:7], v224 offset:1024
    v_mfma_f32_16x16x32_bf16 a[68:71], v[52:55], v[40:43], a[68:71]
    s_add_u32 s40, s99, s71
    ds_read_b128 v[8:11], v224 offset:2048
    ds_read_b128 v[12:15], v224 offset:3072
    v_mfma_f32_16x16x32_bf16 a[84:87], v[52:55], v[44:47], a[84:87]
    s_addc_u32 s41, s100, 0
    ds_read_b128 v[16:19], v224 offset:4096
    ds_read_b128 v[20:23], v224 offset:5120
    v_mfma_f32_16x16x32_bf16 a[80:83], v[48:51], v[44:47], a[80:83]
    buffer_load_dwordx4 v[192:195], v252, s[40:43], 0 offen offset:128
    v_mfma_f32_16x16x32_bf16 a[88:91], v[56:59], v[44:47], a[88:91]
    s_add_u32 s101, s101, 1
    s_and_b32 s101, s101, 7
    s_not_b64 vcc, vcc
    v_mfma_f32_16x16x32_bf16 a[92:95], v[60:63], v[44:47], a[92:95]
    s_waitcnt vmcnt(17)
    v_cndmask_b32_dpp v104, v178, v176, vcc row_ror:8 row_mask:0xf bank_mask:0xf
    v_cndmask_b32_dpp v105, v182, v180, vcc row_ror:8 row_mask:0xf bank_mask:0xf
    v_cndmask_b32_dpp v106, v186, v184, vcc row_ror:8 row_mask:0xf bank_mask:0xf
    v_mfma_f32_16x16x32_bf16 a[76:79], v[60:63], v[40:43], a[76:79]
    v_cndmask_b32_dpp v107, v190, v188, vcc row_ror:8 row_mask:0xf bank_mask:0xf
    v_cndmask_b32_dpp v108, v130, v128, vcc row_ror:8 row_mask:0xf bank_mask:0xf
    v_mfma_f32_16x16x32_bf16 a[72:75], v[56:59], v[40:43], a[72:75]
    v_cndmask_b32_dpp v109, v134, v132, vcc row_ror:8 row_mask:0xf bank_mask:0xf
    v_cndmask_b32_dpp v110, v138, v136, vcc row_ror:8 row_mask:0xf bank_mask:0xf
    v_mfma_f32_16x16x32_bf16 a[56:59], v[56:59], v[36:39], a[56:59]
    v_cndmask_b32_dpp v111, v142, v140, vcc row_ror:8 row_mask:0xf bank_mask:0xf
    v_perm_b32 v48, v105, v104, s65
    v_mfma_f32_16x16x32_bf16 a[60:63], v[60:63], v[36:39], a[60:63]
    buffer_load_dwordx4 v[196:199], v252, s[40:43], 0 offen offset:1152
    v_mfma_f32_16x16x32_bf16 a[44:47], v[60:63], v[32:35], a[44:47]
    v_perm_b32 v49, v107, v106, s65
    v_perm_b32 v50, v109, v108, s65
    v_mfma_f32_16x16x32_bf16 a[40:43], v[56:59], v[32:35], a[40:43]
    v_perm_b32 v51, v111, v110, s65
    v_perm_b32 v52, v105, v104, s66
    v_mfma_f32_16x16x32_bf16 a[24:27], v[56:59], v[28:31], a[24:27]
    v_perm_b32 v53, v107, v106, s66
    v_perm_b32 v54, v109, v108, s66
    v_mfma_f32_16x16x32_bf16 a[28:31], v[60:63], v[28:31], a[28:31]
    v_perm_b32 v55, v111, v110, s66
    v_cndmask_b32_dpp v112, v179, v177, vcc row_ror:8 row_mask:0xf bank_mask:0xf
    v_mfma_f32_16x16x32_bf16 a[12:15], v[60:63], v[24:27], a[12:15]
    s_add_u32 s71, s58, 11
    v_cndmask_b32_dpp v113, v183, v181, vcc row_ror:8 row_mask:0xf bank_mask:0xf
    v_cndmask_b32_dpp v114, v187, v185, vcc row_ror:8 row_mask:0xf bank_mask:0xf
    v_mfma_f32_16x16x32_bf16 a[8:11], v[56:59], v[24:27], a[8:11]
    s_waitcnt lgkmcnt(0)
    buffer_load_dwordx4 v[200:203], v252, s[40:43], 0 offen offset:2176
    v_mfma_f32_16x16x32_bf16 a[0:3], v[48:51], v[0:3], a[0:3]
    s_and_b32 s71, s71, 15
    v_cndmask_b32_dpp v115, v191, v189, vcc row_ror:8 row_mask:0xf bank_mask:0xf
    v_cndmask_b32_dpp v116, v131, v129, vcc row_ror:8 row_mask:0xf bank_mask:0xf
    v_mfma_f32_16x16x32_bf16 a[4:7], v[52:55], v[0:3], a[4:7]
    s_mul_i32 s71, s71, 6144
    v_cndmask_b32_dpp v117, v135, v133, vcc row_ror:8 row_mask:0xf bank_mask:0xf
    v_cndmask_b32_dpp v118, v139, v137, vcc row_ror:8 row_mask:0xf bank_mask:0xf
    v_mfma_f32_16x16x32_bf16 a[20:23], v[52:55], v[4:7], a[20:23]
    v_cndmask_b32_dpp v119, v143, v141, vcc row_ror:8 row_mask:0xf bank_mask:0xf
    v_perm_b32 v56, v113, v112, s65
    v_mfma_f32_16x16x32_bf16 a[16:19], v[48:51], v[4:7], a[16:19]
    s_not_b64 vcc, vcc
    v_perm_b32 v57, v115, v114, s65
    v_perm_b32 v58, v117, v116, s65
    v_mfma_f32_16x16x32_bf16 a[32:35], v[48:51], v[8:11], a[32:35]
    v_perm_b32 v59, v119, v118, s65
    v_perm_b32 v60, v113, v112, s66
    v_mfma_f32_16x16x32_bf16 a[36:39], v[52:55], v[8:11], a[36:39]
    buffer_load_dwordx4 v[204:207], v252, s[40:43], 0 offen offset:3200
    v_mfma_f32_16x16x32_bf16 a[52:55], v[52:55], v[12:15], a[52:55]
    v_perm_b32 v61, v115, v114, s66
    v_perm_b32 v62, v117, v116, s66
    v_mfma_f32_16x16x32_bf16 a[48:51], v[48:51], v[12:15], a[48:51]
    v_perm_b32 v63, v119, v118, s66
    v_add_u32 v224, s71, v254
    v_mfma_f32_16x16x32_bf16 a[64:67], v[48:51], v[16:19], a[64:67]
    ds_read_b128 v[24:27], v224 offset:0
    v_cndmask_b32_dpp v104, v176, v178, vcc row_ror:8 row_mask:0xf bank_mask:0xf
    v_mfma_f32_16x16x32_bf16 a[68:71], v[52:55], v[16:19], a[68:71]
    ds_read_b128 v[28:31], v224 offset:1024
    v_cndmask_b32_dpp v105, v180, v182, vcc row_ror:8 row_mask:0xf bank_mask:0xf
    v_mfma_f32_16x16x32_bf16 a[84:87], v[52:55], v[20:23], a[84:87]
    ds_read_b128 v[32:35], v224 offset:2048
    v_cndmask_b32_dpp v106, v184, v186, vcc row_ror:8 row_mask:0xf bank_mask:0xf
    v_mfma_f32_16x16x32_bf16 a[80:83], v[48:51], v[20:23], a[80:83]
    ds_read_b128 v[36:39], v224 offset:3072
    v_cndmask_b32_dpp v107, v188, v190, vcc row_ror:8 row_mask:0xf bank_mask:0xf
    v_mfma_f32_16x16x32_bf16 a[88:91], v[56:59], v[20:23], a[88:91]
    ds_read_b128 v[40:43], v224 offset:4096
    v_cndmask_b32_dpp v108, v128, v130, vcc row_ror:8 row_mask:0xf bank_mask:0xf
    v_mfma_f32_16x16x32_bf16 a[92:95], v[60:63], v[20:23], a[92:95]
    ds_read_b128 v[44:47], v224 offset:5120
    v_cndmask_b32_dpp v109, v132, v134, vcc row_ror:8 row_mask:0xf bank_mask:0xf
    v_mfma_f32_16x16x32_bf16 a[76:79], v[60:63], v[16:19], a[76:79]
    buffer_load_dwordx4 v[208:211], v252, s[40:43], s62 offen offset:128
    v_mfma_f32_16x16x32_bf16 a[72:75], v[56:59], v[16:19], a[72:75]
    v_cndmask_b32_dpp v110, v136, v138, vcc row_ror:8 row_mask:0xf bank_mask:0xf
    v_cndmask_b32_dpp v111, v140, v142, vcc row_ror:8 row_mask:0xf bank_mask:0xf
    v_mfma_f32_16x16x32_bf16 a[56:59], v[56:59], v[12:15], a[56:59]
    v_perm_b32 v48, v105, v104, s65
    v_perm_b32 v49, v107, v106, s65
    v_mfma_f32_16x16x32_bf16 a[60:63], v[60:63], v[12:15], a[60:63]
    buffer_load_dwordx4 v[212:215], v252, s[40:43], s62 offen offset:1152
    v_mfma_f32_16x16x32_bf16 a[44:47], v[60:63], v[8:11], a[44:47]
    v_perm_b32 v50, v109, v108, s65
    v_perm_b32 v51, v111, v110, s65
    v_mfma_f32_16x16x32_bf16 a[40:43], v[56:59], v[8:11], a[40:43]
    v_perm_b32 v52, v105, v104, s66
    v_perm_b32 v53, v107, v106, s66
    v_mfma_f32_16x16x32_bf16 a[24:27], v[56:59], v[4:7], a[24:27]
    v_perm_b32 v54, v109, v108, s66
    v_perm_b32 v55, v111, v110, s66
    v_mfma_f32_16x16x32_bf16 a[28:31], v[60:63], v[4:7], a[28:31]
    v_cndmask_b32_dpp v112, v177, v179, vcc row_ror:8 row_mask:0xf bank_mask:0xf
    v_cndmask_b32_dpp v113, v181, v183, vcc row_ror:8 row_mask:0xf bank_mask:0xf
    v_mfma_f32_16x16x32_bf16 a[12:15], v[60:63], v[0:3], a[12:15]
    s_add_u32 s71, s58, 12
    v_cndmask_b32_dpp v114, v185, v187, vcc row_ror:8 row_mask:0xf bank_mask:0xf
    v_cndmask_b32_dpp v115, v189, v191, vcc row_ror:8 row_mask:0xf bank_mask:0xf
    v_mfma_f32_16x16x32_bf16 a[8:11], v[56:59], v[0:3], a[8:11]
    s_waitcnt lgkmcnt(0)
    buffer_load_dwordx4 v[216:219], v252, s[40:43], s62 offen offset:2176
    v_mfma_f32_16x16x32_bf16 a[0:3], v[48:51], v[24:27], a[0:3]
    s_and_b32 s71, s71, 15
    v_cndmask_b32_dpp v116, v129, v131, vcc row_ror:8 row_mask:0xf bank_mask:0xf
    v_cndmask_b32_dpp v117, v133, v135, vcc row_ror:8 row_mask:0xf bank_mask:0xf
    v_mfma_f32_16x16x32_bf16 a[4:7], v[52:55], v[24:27], a[4:7]
    s_mul_i32 s71, s71, 6144
    v_cndmask_b32_dpp v118, v137, v139, vcc row_ror:8 row_mask:0xf bank_mask:0xf
    v_cndmask_b32_dpp v119, v141, v143, vcc row_ror:8 row_mask:0xf bank_mask:0xf
    v_mfma_f32_16x16x32_bf16 a[20:23], v[52:55], v[28:31], a[20:23]
    v_perm_b32 v56, v113, v112, s65
    v_perm_b32 v57, v115, v114, s65
    v_mfma_f32_16x16x32_bf16 a[16:19], v[48:51], v[28:31], a[16:19]
    v_perm_b32 v58, v117, v116, s65
    v_perm_b32 v59, v119, v118, s65
    v_mfma_f32_16x16x32_bf16 a[32:35], v[48:51], v[32:35], a[32:35]
    v_perm_b32 v60, v113, v112, s66
    v_perm_b32 v61, v115, v114, s66
    v_mfma_f32_16x16x32_bf16 a[36:39], v[52:55], v[32:35], a[36:39]
    buffer_load_dwordx4 v[220:223], v252, s[40:43], s62 offen offset:3200
    v_mfma_f32_16x16x32_bf16 a[52:55], v[52:55], v[36:39], a[52:55]
    v_perm_b32 v62, v117, v116, s66
    v_perm_b32 v63, v119, v118, s66
    v_mfma_f32_16x16x32_bf16 a[48:51], v[48:51], v[36:39], a[48:51]
    v_add_u32 v224, s71, v254
    v_mfma_f32_16x16x32_bf16 a[64:67], v[48:51], v[40:43], a[64:67]
    s_lshl_b32 s71, s101, 16
    ds_read_b128 v[0:3], v224 offset:0
    ds_read_b128 v[4:7], v224 offset:1024
    v_mfma_f32_16x16x32_bf16 a[68:71], v[52:55], v[40:43], a[68:71]
    s_add_u32 s40, s99, s71
    ds_read_b128 v[8:11], v224 offset:2048
    ds_read_b128 v[12:15], v224 offset:3072
    v_mfma_f32_16x16x32_bf16 a[84:87], v[52:55], v[44:47], a[84:87]
    s_addc_u32 s41, s100, 0
    ds_read_b128 v[16:19], v224 offset:4096
    ds_read_b128 v[20:23], v224 offset:5120
    v_mfma_f32_16x16x32_bf16 a[80:83], v[48:51], v[44:47], a[80:83]
    buffer_load_dwordx4 v[176:179], v252, s[40:43], 0 offen offset:128
    v_mfma_f32_16x16x32_bf16 a[88:91], v[56:59], v[44:47], a[88:91]
    s_add_u32 s101, s101, 1
    s_and_b32 s101, s101, 7
    s_not_b64 vcc, vcc
    v_mfma_f32_16x16x32_bf16 a[92:95], v[60:63], v[44:47], a[92:95]
    s_waitcnt vmcnt(17)
    v_cndmask_b32_dpp v104, v146, v144, vcc row_ror:8 row_mask:0xf bank_mask:0xf
    v_cndmask_b32_dpp v105, v150, v148, vcc row_ror:8 row_mask:0xf bank_mask:0xf
    v_cndmask_b32_dpp v106, v154, v152, vcc row_ror:8 row_mask:0xf bank_mask:0xf
    v_mfma_f32_16x16x32_bf16 a[76:79], v[60:63], v[40:43], a[76:79]
    v_cndmask_b32_dpp v107, v158, v156, vcc row_ror:8 row_mask:0xf bank_mask:0xf
    v_cndmask_b32_dpp v108, v162, v160, vcc row_ror:8 row_mask:0xf bank_mask:0xf
    v_mfma_f32_16x16x32_bf16 a[72:75], v[56:59], v[40:43], a[72:75]
    v_cndmask_b32_dpp v109, v166, v164, vcc row_ror:8 row_mask:0xf bank_mask:0xf
    v_cndmask_b32_dpp v110, v170, v168, vcc row_ror:8 row_mask:0xf bank_mask:0xf
    v_mfma_f32_16x16x32_bf16 a[56:59], v[56:59], v[36:39], a[56:59]
    v_cndmask_b32_dpp v111, v174, v172, vcc row_ror:8 row_mask:0xf bank_mask:0xf
    v_perm_b32 v48, v105, v104, s65
    v_mfma_f32_16x16x32_bf16 a[60:63], v[60:63], v[36:39], a[60:63]
    buffer_load_dwordx4 v[180:183], v252, s[40:43], 0 offen offset:1152
    v_mfma_f32_16x16x32_bf16 a[44:47], v[60:63], v[32:35], a[44:47]
    v_perm_b32 v49, v107, v106, s65
    v_perm_b32 v50, v109, v108, s65
    v_mfma_f32_16x16x32_bf16 a[40:43], v[56:59], v[32:35], a[40:43]
    v_perm_b32 v51, v111, v110, s65
    v_perm_b32 v52, v105, v104, s66
    v_mfma_f32_16x16x32_bf16 a[24:27], v[56:59], v[28:31], a[24:27]
    v_perm_b32 v53, v107, v106, s66
    v_perm_b32 v54, v109, v108, s66
    v_mfma_f32_16x16x32_bf16 a[28:31], v[60:63], v[28:31], a[28:31]
    v_perm_b32 v55, v111, v110, s66
    v_cndmask_b32_dpp v112, v147, v145, vcc row_ror:8 row_mask:0xf bank_mask:0xf
    v_mfma_f32_16x16x32_bf16 a[12:15], v[60:63], v[24:27], a[12:15]
    s_add_u32 s71, s58, 13
    v_cndmask_b32_dpp v113, v151, v149, vcc row_ror:8 row_mask:0xf bank_mask:0xf
    v_cndmask_b32_dpp v114, v155, v153, vcc row_ror:8 row_mask:0xf bank_mask:0xf
    v_mfma_f32_16x16x32_bf16 a[8:11], v[56:59], v[24:27], a[8:11]
    s_waitcnt lgkmcnt(0)
    buffer_load_dwordx4 v[184:187], v252, s[40:43], 0 offen offset:2176
    v_mfma_f32_16x16x32_bf16 a[0:3], v[48:51], v[0:3], a[0:3]
    s_and_b32 s71, s71, 15
    v_cndmask_b32_dpp v115, v159, v157, vcc row_ror:8 row_mask:0xf bank_mask:0xf
    v_cndmask_b32_dpp v116, v163, v161, vcc row_ror:8 row_mask:0xf bank_mask:0xf
    v_mfma_f32_16x16x32_bf16 a[4:7], v[52:55], v[0:3], a[4:7]
    s_mul_i32 s71, s71, 6144
    v_cndmask_b32_dpp v117, v167, v165, vcc row_ror:8 row_mask:0xf bank_mask:0xf
    v_cndmask_b32_dpp v118, v171, v169, vcc row_ror:8 row_mask:0xf bank_mask:0xf
    v_mfma_f32_16x16x32_bf16 a[20:23], v[52:55], v[4:7], a[20:23]
    v_cndmask_b32_dpp v119, v175, v173, vcc row_ror:8 row_mask:0xf bank_mask:0xf
    v_perm_b32 v56, v113, v112, s65
    v_mfma_f32_16x16x32_bf16 a[16:19], v[48:51], v[4:7], a[16:19]
    s_not_b64 vcc, vcc
    v_perm_b32 v57, v115, v114, s65
    v_perm_b32 v58, v117, v116, s65
    v_mfma_f32_16x16x32_bf16 a[32:35], v[48:51], v[8:11], a[32:35]
    v_perm_b32 v59, v119, v118, s65
    v_perm_b32 v60, v113, v112, s66
    v_mfma_f32_16x16x32_bf16 a[36:39], v[52:55], v[8:11], a[36:39]
    buffer_load_dwordx4 v[188:191], v252, s[40:43], 0 offen offset:3200
    v_mfma_f32_16x16x32_bf16 a[52:55], v[52:55], v[12:15], a[52:55]
    v_perm_b32 v61, v115, v114, s66
    v_perm_b32 v62, v117, v116, s66
    v_mfma_f32_16x16x32_bf16 a[48:51], v[48:51], v[12:15], a[48:51]
    v_perm_b32 v63, v119, v118, s66
    v_add_u32 v224, s71, v254
    v_mfma_f32_16x16x32_bf16 a[64:67], v[48:51], v[16:19], a[64:67]
    ds_read_b128 v[24:27], v224 offset:0
    v_cndmask_b32_dpp v104, v144, v146, vcc row_ror:8 row_mask:0xf bank_mask:0xf
    v_mfma_f32_16x16x32_bf16 a[68:71], v[52:55], v[16:19], a[68:71]
    ds_read_b128 v[28:31], v224 offset:1024
    v_cndmask_b32_dpp v105, v148, v150, vcc row_ror:8 row_mask:0xf bank_mask:0xf
    v_mfma_f32_16x16x32_bf16 a[84:87], v[52:55], v[20:23], a[84:87]
    ds_read_b128 v[32:35], v224 offset:2048
    v_cndmask_b32_dpp v106, v152, v154, vcc row_ror:8 row_mask:0xf bank_mask:0xf
    v_mfma_f32_16x16x32_bf16 a[80:83], v[48:51], v[20:23], a[80:83]
    ds_read_b128 v[36:39], v224 offset:3072
    v_cndmask_b32_dpp v107, v156, v158, vcc row_ror:8 row_mask:0xf bank_mask:0xf
    v_mfma_f32_16x16x32_bf16 a[88:91], v[56:59], v[20:23], a[88:91]
    ds_read_b128 v[40:43], v224 offset:4096
    v_cndmask_b32_dpp v108, v160, v162, vcc row_ror:8 row_mask:0xf bank_mask:0xf
    v_mfma_f32_16x16x32_bf16 a[92:95], v[60:63], v[20:23], a[92:95]
    ds_read_b128 v[44:47], v224 offset:5120
    v_cndmask_b32_dpp v109, v164, v166, vcc row_ror:8 row_mask:0xf bank_mask:0xf
    v_mfma_f32_16x16x32_bf16 a[76:79], v[60:63], v[16:19], a[76:79]
    buffer_load_dwordx4 v[128:131], v252, s[40:43], s62 offen offset:128
    v_mfma_f32_16x16x32_bf16 a[72:75], v[56:59], v[16:19], a[72:75]
    v_cndmask_b32_dpp v110, v168, v170, vcc row_ror:8 row_mask:0xf bank_mask:0xf
    v_cndmask_b32_dpp v111, v172, v174, vcc row_ror:8 row_mask:0xf bank_mask:0xf
    v_mfma_f32_16x16x32_bf16 a[56:59], v[56:59], v[12:15], a[56:59]
    v_perm_b32 v48, v105, v104, s65
    v_perm_b32 v49, v107, v106, s65
    v_mfma_f32_16x16x32_bf16 a[60:63], v[60:63], v[12:15], a[60:63]
    buffer_load_dwordx4 v[132:135], v252, s[40:43], s62 offen offset:1152
    v_mfma_f32_16x16x32_bf16 a[44:47], v[60:63], v[8:11], a[44:47]
    v_perm_b32 v50, v109, v108, s65
    v_perm_b32 v51, v111, v110, s65
    v_mfma_f32_16x16x32_bf16 a[40:43], v[56:59], v[8:11], a[40:43]
    v_perm_b32 v52, v105, v104, s66
    v_perm_b32 v53, v107, v106, s66
    v_mfma_f32_16x16x32_bf16 a[24:27], v[56:59], v[4:7], a[24:27]
    v_perm_b32 v54, v109, v108, s66
    v_perm_b32 v55, v111, v110, s66
    v_mfma_f32_16x16x32_bf16 a[28:31], v[60:63], v[4:7], a[28:31]
    v_cndmask_b32_dpp v112, v145, v147, vcc row_ror:8 row_mask:0xf bank_mask:0xf
    v_cndmask_b32_dpp v113, v149, v151, vcc row_ror:8 row_mask:0xf bank_mask:0xf
    v_mfma_f32_16x16x32_bf16 a[12:15], v[60:63], v[0:3], a[12:15]
    s_add_u32 s71, s58, 14
    v_cndmask_b32_dpp v114, v153, v155, vcc row_ror:8 row_mask:0xf bank_mask:0xf
    v_cndmask_b32_dpp v115, v157, v159, vcc row_ror:8 row_mask:0xf bank_mask:0xf
    v_mfma_f32_16x16x32_bf16 a[8:11], v[56:59], v[0:3], a[8:11]
    s_waitcnt lgkmcnt(0)
    buffer_load_dwordx4 v[136:139], v252, s[40:43], s62 offen offset:2176
    v_mfma_f32_16x16x32_bf16 a[0:3], v[48:51], v[24:27], a[0:3]
    s_and_b32 s71, s71, 15
    v_cndmask_b32_dpp v116, v161, v163, vcc row_ror:8 row_mask:0xf bank_mask:0xf
    v_cndmask_b32_dpp v117, v165, v167, vcc row_ror:8 row_mask:0xf bank_mask:0xf
    v_mfma_f32_16x16x32_bf16 a[4:7], v[52:55], v[24:27], a[4:7]
    s_mul_i32 s71, s71, 6144
    v_cndmask_b32_dpp v118, v169, v171, vcc row_ror:8 row_mask:0xf bank_mask:0xf
    v_cndmask_b32_dpp v119, v173, v175, vcc row_ror:8 row_mask:0xf bank_mask:0xf
    v_mfma_f32_16x16x32_bf16 a[20:23], v[52:55], v[28:31], a[20:23]
    v_perm_b32 v56, v113, v112, s65
    v_perm_b32 v57, v115, v114, s65
    v_mfma_f32_16x16x32_bf16 a[16:19], v[48:51], v[28:31], a[16:19]
    v_perm_b32 v58, v117, v116, s65
    v_perm_b32 v59, v119, v118, s65
    v_mfma_f32_16x16x32_bf16 a[32:35], v[48:51], v[32:35], a[32:35]
    v_perm_b32 v60, v113, v112, s66
    v_perm_b32 v61, v115, v114, s66
    v_mfma_f32_16x16x32_bf16 a[36:39], v[52:55], v[32:35], a[36:39]
    buffer_load_dwordx4 v[140:143], v252, s[40:43], s62 offen offset:3200
    v_mfma_f32_16x16x32_bf16 a[52:55], v[52:55], v[36:39], a[52:55]
    v_perm_b32 v62, v117, v116, s66
    v_perm_b32 v63, v119, v118, s66
    v_mfma_f32_16x16x32_bf16 a[48:51], v[48:51], v[36:39], a[48:51]
    v_add_u32 v224, s71, v254
    v_mfma_f32_16x16x32_bf16 a[64:67], v[48:51], v[40:43], a[64:67]
    s_lshl_b32 s71, s101, 16
    ds_read_b128 v[0:3], v224 offset:0
    ds_read_b128 v[4:7], v224 offset:1024
    v_mfma_f32_16x16x32_bf16 a[68:71], v[52:55], v[40:43], a[68:71]
    s_add_u32 s40, s99, s71
    ds_read_b128 v[8:11], v224 offset:2048
    ds_read_b128 v[12:15], v224 offset:3072
    v_mfma_f32_16x16x32_bf16 a[84:87], v[52:55], v[44:47], a[84:87]
    s_addc_u32 s41, s100, 0
    ds_read_b128 v[16:19], v224 offset:4096
    ds_read_b128 v[20:23], v224 offset:5120
    v_mfma_f32_16x16x32_bf16 a[80:83], v[48:51], v[44:47], a[80:83]
    buffer_load_dwordx4 v[144:147], v252, s[40:43], 0 offen offset:128
    v_mfma_f32_16x16x32_bf16 a[88:91], v[56:59], v[44:47], a[88:91]
    s_add_u32 s101, s101, 1
    s_and_b32 s101, s101, 7
    s_not_b64 vcc, vcc
    v_mfma_f32_16x16x32_bf16 a[92:95], v[60:63], v[44:47], a[92:95]
    s_waitcnt vmcnt(17)
    v_cndmask_b32_dpp v104, v74, v72, vcc row_ror:8 row_mask:0xf bank_mask:0xf
    v_cndmask_b32_dpp v105, v78, v76, vcc row_ror:8 row_mask:0xf bank_mask:0xf
    v_cndmask_b32_dpp v106, v82, v80, vcc row_ror:8 row_mask:0xf bank_mask:0xf
    v_mfma_f32_16x16x32_bf16 a[76:79], v[60:63], v[40:43], a[76:79]
    v_cndmask_b32_dpp v107, v86, v84, vcc row_ror:8 row_mask:0xf bank_mask:0xf
    v_cndmask_b32_dpp v108, v90, v88, vcc row_ror:8 row_mask:0xf bank_mask:0xf
    v_mfma_f32_16x16x32_bf16 a[72:75], v[56:59], v[40:43], a[72:75]
    v_cndmask_b32_dpp v109, v94, v92, vcc row_ror:8 row_mask:0xf bank_mask:0xf
    v_cndmask_b32_dpp v110, v98, v96, vcc row_ror:8 row_mask:0xf bank_mask:0xf
    v_mfma_f32_16x16x32_bf16 a[56:59], v[56:59], v[36:39], a[56:59]
    v_cndmask_b32_dpp v111, v102, v100, vcc row_ror:8 row_mask:0xf bank_mask:0xf
    v_perm_b32 v48, v105, v104, s65
    v_mfma_f32_16x16x32_bf16 a[60:63], v[60:63], v[36:39], a[60:63]
    buffer_load_dwordx4 v[148:151], v252, s[40:43], 0 offen offset:1152
    v_mfma_f32_16x16x32_bf16 a[44:47], v[60:63], v[32:35], a[44:47]
    v_perm_b32 v49, v107, v106, s65
    v_perm_b32 v50, v109, v108, s65
    v_mfma_f32_16x16x32_bf16 a[40:43], v[56:59], v[32:35], a[40:43]
    v_perm_b32 v51, v111, v110, s65
    v_perm_b32 v52, v105, v104, s66
    v_mfma_f32_16x16x32_bf16 a[24:27], v[56:59], v[28:31], a[24:27]
    v_perm_b32 v53, v107, v106, s66
    v_perm_b32 v54, v109, v108, s66
    v_mfma_f32_16x16x32_bf16 a[28:31], v[60:63], v[28:31], a[28:31]
    v_perm_b32 v55, v111, v110, s66
    v_cndmask_b32_dpp v112, v75, v73, vcc row_ror:8 row_mask:0xf bank_mask:0xf
    v_mfma_f32_16x16x32_bf16 a[12:15], v[60:63], v[24:27], a[12:15]
    s_add_u32 s71, s58, 15
    v_cndmask_b32_dpp v113, v79, v77, vcc row_ror:8 row_mask:0xf bank_mask:0xf
    v_cndmask_b32_dpp v114, v83, v81, vcc row_ror:8 row_mask:0xf bank_mask:0xf
    v_mfma_f32_16x16x32_bf16 a[8:11], v[56:59], v[24:27], a[8:11]
    s_waitcnt lgkmcnt(0)
    buffer_load_dwordx4 v[152:155], v252, s[40:43], 0 offen offset:2176
    v_mfma_f32_16x16x32_bf16 a[0:3], v[48:51], v[0:3], a[0:3]
    s_and_b32 s71, s71, 15
    v_cndmask_b32_dpp v115, v87, v85, vcc row_ror:8 row_mask:0xf bank_mask:0xf
    v_cndmask_b32_dpp v116, v91, v89, vcc row_ror:8 row_mask:0xf bank_mask:0xf
    v_mfma_f32_16x16x32_bf16 a[4:7], v[52:55], v[0:3], a[4:7]
    s_mul_i32 s71, s71, 6144
    v_cndmask_b32_dpp v117, v95, v93, vcc row_ror:8 row_mask:0xf bank_mask:0xf
    v_cndmask_b32_dpp v118, v99, v97, vcc row_ror:8 row_mask:0xf bank_mask:0xf
    v_mfma_f32_16x16x32_bf16 a[20:23], v[52:55], v[4:7], a[20:23]
    v_cndmask_b32_dpp v119, v103, v101, vcc row_ror:8 row_mask:0xf bank_mask:0xf
    v_perm_b32 v56, v113, v112, s65
    v_mfma_f32_16x16x32_bf16 a[16:19], v[48:51], v[4:7], a[16:19]
    s_not_b64 vcc, vcc
    v_perm_b32 v57, v115, v114, s65
    v_perm_b32 v58, v117, v116, s65
    v_mfma_f32_16x16x32_bf16 a[32:35], v[48:51], v[8:11], a[32:35]
    v_perm_b32 v59, v119, v118, s65
    v_perm_b32 v60, v113, v112, s66
    v_mfma_f32_16x16x32_bf16 a[36:39], v[52:55], v[8:11], a[36:39]
    buffer_load_dwordx4 v[156:159], v252, s[40:43], 0 offen offset:3200
    v_mfma_f32_16x16x32_bf16 a[52:55], v[52:55], v[12:15], a[52:55]
    v_perm_b32 v61, v115, v114, s66
    v_perm_b32 v62, v117, v116, s66
    v_mfma_f32_16x16x32_bf16 a[48:51], v[48:51], v[12:15], a[48:51]
    v_perm_b32 v63, v119, v118, s66
    v_add_u32 v224, s71, v254
    v_mfma_f32_16x16x32_bf16 a[64:67], v[48:51], v[16:19], a[64:67]
    ds_read_b128 v[24:27], v224 offset:0
    v_cndmask_b32_dpp v104, v72, v74, vcc row_ror:8 row_mask:0xf bank_mask:0xf
    v_mfma_f32_16x16x32_bf16 a[68:71], v[52:55], v[16:19], a[68:71]
    ds_read_b128 v[28:31], v224 offset:1024
    v_cndmask_b32_dpp v105, v76, v78, vcc row_ror:8 row_mask:0xf bank_mask:0xf
    v_mfma_f32_16x16x32_bf16 a[84:87], v[52:55], v[20:23], a[84:87]
    ds_read_b128 v[32:35], v224 offset:2048
    v_cndmask_b32_dpp v106, v80, v82, vcc row_ror:8 row_mask:0xf bank_mask:0xf
    v_mfma_f32_16x16x32_bf16 a[80:83], v[48:51], v[20:23], a[80:83]
    ds_read_b128 v[36:39], v224 offset:3072
    v_cndmask_b32_dpp v107, v84, v86, vcc row_ror:8 row_mask:0xf bank_mask:0xf
    v_mfma_f32_16x16x32_bf16 a[88:91], v[56:59], v[20:23], a[88:91]
    ds_read_b128 v[40:43], v224 offset:4096
    v_cndmask_b32_dpp v108, v88, v90, vcc row_ror:8 row_mask:0xf bank_mask:0xf
    v_mfma_f32_16x16x32_bf16 a[92:95], v[60:63], v[20:23], a[92:95]
    ds_read_b128 v[44:47], v224 offset:5120
    v_cndmask_b32_dpp v109, v92, v94, vcc row_ror:8 row_mask:0xf bank_mask:0xf
    v_mfma_f32_16x16x32_bf16 a[76:79], v[60:63], v[16:19], a[76:79]
    buffer_load_dwordx4 v[160:163], v252, s[40:43], s62 offen offset:128
    v_mfma_f32_16x16x32_bf16 a[72:75], v[56:59], v[16:19], a[72:75]
    v_cndmask_b32_dpp v110, v96, v98, vcc row_ror:8 row_mask:0xf bank_mask:0xf
    v_cndmask_b32_dpp v111, v100, v102, vcc row_ror:8 row_mask:0xf bank_mask:0xf
    v_mfma_f32_16x16x32_bf16 a[56:59], v[56:59], v[12:15], a[56:59]
    v_perm_b32 v48, v105, v104, s65
    v_perm_b32 v49, v107, v106, s65
    v_mfma_f32_16x16x32_bf16 a[60:63], v[60:63], v[12:15], a[60:63]
    buffer_load_dwordx4 v[164:167], v252, s[40:43], s62 offen offset:1152
    v_mfma_f32_16x16x32_bf16 a[44:47], v[60:63], v[8:11], a[44:47]
    v_perm_b32 v50, v109, v108, s65
    v_perm_b32 v51, v111, v110, s65
    v_mfma_f32_16x16x32_bf16 a[40:43], v[56:59], v[8:11], a[40:43]
    v_perm_b32 v52, v105, v104, s66
    v_perm_b32 v53, v107, v106, s66
    v_mfma_f32_16x16x32_bf16 a[24:27], v[56:59], v[4:7], a[24:27]
    v_perm_b32 v54, v109, v108, s66
    v_perm_b32 v55, v111, v110, s66
    v_mfma_f32_16x16x32_bf16 a[28:31], v[60:63], v[4:7], a[28:31]
    v_cndmask_b32_dpp v112, v73, v75, vcc row_ror:8 row_mask:0xf bank_mask:0xf
    v_cndmask_b32_dpp v113, v77, v79, vcc row_ror:8 row_mask:0xf bank_mask:0xf
    v_mfma_f32_16x16x32_bf16 a[12:15], v[60:63], v[0:3], a[12:15]
    s_add_u32 s71, s58, 0
    v_cndmask_b32_dpp v114, v81, v83, vcc row_ror:8 row_mask:0xf bank_mask:0xf
    v_cndmask_b32_dpp v115, v85, v87, vcc row_ror:8 row_mask:0xf bank_mask:0xf
    v_mfma_f32_16x16x32_bf16 a[8:11], v[56:59], v[0:3], a[8:11]
    s_waitcnt lgkmcnt(0)
    buffer_load_dwordx4 v[168:171], v252, s[40:43], s62 offen offset:2176
    v_mfma_f32_16x16x32_bf16 a[0:3], v[48:51], v[24:27], a[0:3]
    s_and_b32 s71, s71, 15
    v_cndmask_b32_dpp v116, v89, v91, vcc row_ror:8 row_mask:0xf bank_mask:0xf
    v_cndmask_b32_dpp v117, v93, v95, vcc row_ror:8 row_mask:0xf bank_mask:0xf
    v_mfma_f32_16x16x32_bf16 a[4:7], v[52:55], v[24:27], a[4:7]
    s_mul_i32 s71, s71, 6144
    v_cndmask_b32_dpp v118, v97, v99, vcc row_ror:8 row_mask:0xf bank_mask:0xf
    v_cndmask_b32_dpp v119, v101, v103, vcc row_ror:8 row_mask:0xf bank_mask:0xf
    v_mfma_f32_16x16x32_bf16 a[20:23], v[52:55], v[28:31], a[20:23]
    v_perm_b32 v56, v113, v112, s65
    v_perm_b32 v57, v115, v114, s65
    v_mfma_f32_16x16x32_bf16 a[16:19], v[48:51], v[28:31], a[16:19]
    v_perm_b32 v58, v117, v116, s65
    v_perm_b32 v59, v119, v118, s65
    v_mfma_f32_16x16x32_bf16 a[32:35], v[48:51], v[32:35], a[32:35]
    v_perm_b32 v60, v113, v112, s66
    v_perm_b32 v61, v115, v114, s66
    v_mfma_f32_16x16x32_bf16 a[36:39], v[52:55], v[32:35], a[36:39]
    buffer_load_dwordx4 v[172:175], v252, s[40:43], s62 offen offset:3200
    v_mfma_f32_16x16x32_bf16 a[52:55], v[52:55], v[36:39], a[52:55]
    v_perm_b32 v62, v117, v116, s66
    v_perm_b32 v63, v119, v118, s66
    v_add_u32 v224, s71, v254
    v_mfma_f32_16x16x32_bf16 a[48:51], v[48:51], v[36:39], a[48:51]
    s_lshl_b32 s71, s101, 16
    s_add_u32 s40, s99, s71
    s_addc_u32 s41, s100, 0
    v_mfma_f32_16x16x32_bf16 a[64:67], v[48:51], v[40:43], a[64:67]
    s_add_u32 s101, s101, 1
    ds_read_b128 v[0:3], v224 offset:0
    ds_read_b128 v[4:7], v224 offset:1024
    v_mfma_f32_16x16x32_bf16 a[68:71], v[52:55], v[40:43], a[68:71]
    s_and_b32 s101, s101, 7
    ds_read_b128 v[8:11], v224 offset:2048
    ds_read_b128 v[12:15], v224 offset:3072
    v_mfma_f32_16x16x32_bf16 a[84:87], v[52:55], v[44:47], a[84:87]
    ds_read_b128 v[16:19], v224 offset:4096
    ds_read_b128 v[20:23], v224 offset:5120
    v_mfma_f32_16x16x32_bf16 a[80:83], v[48:51], v[44:47], a[80:83]
    buffer_load_dwordx4 v[72:75], v252, s[40:43], 0 offen offset:128
    v_mfma_f32_16x16x32_bf16 a[88:91], v[56:59], v[44:47], a[88:91]
    s_waitcnt vmcnt(17)
    s_not_b64 vcc, vcc
    v_cndmask_b32_dpp v104, v194, v192, vcc row_ror:8 row_mask:0xf bank_mask:0xf
    v_mfma_f32_16x16x32_bf16 a[92:95], v[60:63], v[44:47], a[92:95]
    v_cndmask_b32_dpp v105, v198, v196, vcc row_ror:8 row_mask:0xf bank_mask:0xf
    v_cndmask_b32_dpp v106, v202, v200, vcc row_ror:8 row_mask:0xf bank_mask:0xf
    v_cndmask_b32_dpp v107, v206, v204, vcc row_ror:8 row_mask:0xf bank_mask:0xf
    v_mfma_f32_16x16x32_bf16 a[76:79], v[60:63], v[40:43], a[76:79]
    v_cndmask_b32_dpp v108, v210, v208, vcc row_ror:8 row_mask:0xf bank_mask:0xf
    v_cndmask_b32_dpp v109, v214, v212, vcc row_ror:8 row_mask:0xf bank_mask:0xf
    v_cndmask_b32_dpp v110, v218, v216, vcc row_ror:8 row_mask:0xf bank_mask:0xf
    v_mfma_f32_16x16x32_bf16 a[72:75], v[56:59], v[40:43], a[72:75]
    v_cndmask_b32_dpp v111, v222, v220, vcc row_ror:8 row_mask:0xf bank_mask:0xf
    v_perm_b32 v48, v105, v104, s65
    v_perm_b32 v49, v107, v106, s65
    v_mfma_f32_16x16x32_bf16 a[56:59], v[56:59], v[36:39], a[56:59]
    v_perm_b32 v50, v109, v108, s65
    v_perm_b32 v51, v111, v110, s65
    v_mfma_f32_16x16x32_bf16 a[60:63], v[60:63], v[36:39], a[60:63]
    buffer_load_dwordx4 v[76:79], v252, s[40:43], 0 offen offset:1152
    v_mfma_f32_16x16x32_bf16 a[44:47], v[60:63], v[32:35], a[44:47]
    v_perm_b32 v52, v105, v104, s66
    v_perm_b32 v53, v107, v106, s66
    v_mfma_f32_16x16x32_bf16 a[40:43], v[56:59], v[32:35], a[40:43]
    v_perm_b32 v54, v109, v108, s66
    v_perm_b32 v55, v111, v110, s66
    v_mfma_f32_16x16x32_bf16 a[24:27], v[56:59], v[28:31], a[24:27]
    v_accvgpr_read_b32 v236, a0
    v_cndmask_b32_dpp v112, v195, v193, vcc row_ror:8 row_mask:0xf bank_mask:0xf
    v_mfma_f32_16x16x32_bf16 a[28:31], v[60:63], v[28:31], a[28:31]
    v_cndmask_b32_dpp v113, v199, v197, vcc row_ror:8 row_mask:0xf bank_mask:0xf
    v_cndmask_b32_dpp v114, v203, v201, vcc row_ror:8 row_mask:0xf bank_mask:0xf
    v_cndmask_b32_dpp v115, v207, v205, vcc row_ror:8 row_mask:0xf bank_mask:0xf
    v_mfma_f32_16x16x32_bf16 a[12:15], v[60:63], v[24:27], a[12:15]
    s_add_u32 s71, s58, 1
    v_accvgpr_read_b32 v237, a4
    v_cndmask_b32_dpp v116, v211, v209, vcc row_ror:8 row_mask:0xf bank_mask:0xf
    v_cndmask_b32_dpp v117, v215, v213, vcc row_ror:8 row_mask:0xf bank_mask:0xf
    v_mfma_f32_16x16x32_bf16 a[8:11], v[56:59], v[24:27], a[8:11]
    s_waitcnt lgkmcnt(0)
    buffer_load_dwordx4 v[80:83], v252, s[40:43], 0 offen offset:2176
    v_mfma_f32_16x16x32_bf16 a[96:99], v[48:51], v[0:3], 0
    s_and_b32 s71, s71, 15
    v_cndmask_b32_dpp v118, v219, v217, vcc row_ror:8 row_mask:0xf bank_mask:0xf
    v_cndmask_b32_dpp v119, v223, v221, vcc row_ror:8 row_mask:0xf bank_mask:0xf
    v_perm_b32 v56, v113, v112, s65
    v_mfma_f32_16x16x32_bf16 a[100:103], v[52:55], v[0:3], 0
    s_mul_i32 s71, s71, 6144
    v_cvt_pk_bf16_f32 v64, v236, v237
    v_perm_b32 v57, v115, v114, s65
    v_perm_b32 v58, v117, v116, s65
    v_mfma_f32_16x16x32_bf16 a[116:119], v[52:55], v[4:7], 0
    v_perm_b32 v59, v119, v118, s65
    v_perm_b32 v60, v113, v112, s66
    v_mfma_f32_16x16x32_bf16 a[112:115], v[48:51], v[4:7], 0
    s_not_b64 vcc, vcc
    v_accvgpr_read_b32 v238, a8
    v_perm_b32 v61, v115, v114, s66
    v_mfma_f32_16x16x32_bf16 a[128:131], v[48:51], v[8:11], 0
    v_perm_b32 v62, v117, v116, s66
    v_perm_b32 v63, v119, v118, s66
    v_add_u32 v224, s71, v254
    v_mfma_f32_16x16x32_bf16 a[132:135], v[52:55], v[8:11], 0
    buffer_load_dwordx4 v[84:87], v252, s[40:43], 0 offen offset:3200
    v_mfma_f32_16x16x32_bf16 a[148:151], v[52:55], v[12:15], 0
    v_accvgpr_read_b32 v239, a12
    v_cvt_pk_bf16_f32 v65, v238, v239
    v_cndmask_b32_dpp v104, v192, v194, vcc row_ror:8 row_mask:0xf bank_mask:0xf
    v_mfma_f32_16x16x32_bf16 a[144:147], v[48:51], v[12:15], 0
    v_cndmask_b32_dpp v105, v196, v198, vcc row_ror:8 row_mask:0xf bank_mask:0xf
    v_cndmask_b32_dpp v106, v200, v202, vcc row_ror:8 row_mask:0xf bank_mask:0xf
    v_accvgpr_read_b32 v240, a1
    v_mfma_f32_16x16x32_bf16 a[160:163], v[48:51], v[16:19], 0
    ds_read_b128 v[24:27], v224 offset:0
    v_cndmask_b32_dpp v107, v204, v206, vcc row_ror:8 row_mask:0xf bank_mask:0xf
    v_mfma_f32_16x16x32_bf16 a[164:167], v[52:55], v[16:19], 0
    ds_read_b128 v[28:31], v224 offset:1024
    v_cndmask_b32_dpp v108, v208, v210, vcc row_ror:8 row_mask:0xf bank_mask:0xf
    v_mfma_f32_16x16x32_bf16 a[180:183], v[52:55], v[20:23], 0
    ds_read_b128 v[32:35], v224 offset:2048
    v_cndmask_b32_dpp v109, v212, v214, vcc row_ror:8 row_mask:0xf bank_mask:0xf
    v_mfma_f32_16x16x32_bf16 a[176:179], v[48:51], v[20:23], 0
    ds_read_b128 v[36:39], v224 offset:3072
    v_cndmask_b32_dpp v110, v216, v218, vcc row_ror:8 row_mask:0xf bank_mask:0xf
    v_mfma_f32_16x16x32_bf16 a[184:187], v[56:59], v[20:23], 0
    ds_read_b128 v[40:43], v224 offset:4096
    v_accvgpr_read_b32 v241, a5
    v_mfma_f32_16x16x32_bf16 a[188:191], v[60:63], v[20:23], 0
    ds_read_b128 v[44:47], v224 offset:5120
    v_cndmask_b32_dpp v111, v220, v222, vcc row_ror:8 row_mask:0xf bank_mask:0xf
    v_mfma_f32_16x16x32_bf16 a[172:175], v[60:63], v[16:19], 0
    buffer_load_dwordx4 v[88:91], v252, s[40:43], s62 offen offset:128
    v_mfma_f32_16x16x32_bf16 a[168:171], v[56:59], v[16:19], 0
    v_perm_b32 v48, v105, v104, s65
    v_cvt_pk_bf16_f32 v66, v240, v241
    v_perm_b32 v49, v107, v106, s65
    v_mfma_f32_16x16x32_bf16 a[152:155], v[56:59], v[12:15], 0
    v_perm_b32 v50, v109, v108, s65
    v_perm_b32 v51, v111, v110, s65
    v_perm_b32 v52, v105, v104, s66
    v_mfma_f32_16x16x32_bf16 a[156:159], v[60:63], v[12:15], 0
    buffer_load_dwordx4 v[92:95], v252, s[40:43], s62 offen offset:1152
    v_mfma_f32_16x16x32_bf16 a[140:143], v[60:63], v[8:11], 0
    v_accvgpr_read_b32 v242, a9
    v_perm_b32 v53, v107, v106, s66
    v_perm_b32 v54, v109, v108, s66
    v_mfma_f32_16x16x32_bf16 a[136:139], v[56:59], v[8:11], 0
    v_perm_b32 v55, v111, v110, s66
    v_accvgpr_read_b32 v243, a13
    v_cndmask_b32_dpp v112, v193, v195, vcc row_ror:8 row_mask:0xf bank_mask:0xf
    v_mfma_f32_16x16x32_bf16 a[120:123], v[56:59], v[4:7], 0
    v_cndmask_b32_dpp v113, v197, v199, vcc row_ror:8 row_mask:0xf bank_mask:0xf
    v_cndmask_b32_dpp v114, v201, v203, vcc row_ror:8 row_mask:0xf bank_mask:0xf
    v_cndmask_b32_dpp v115, v205, v207, vcc row_ror:8 row_mask:0xf bank_mask:0xf
    v_mfma_f32_16x16x32_bf16 a[124:127], v[60:63], v[4:7], 0
    v_cvt_pk_bf16_f32 v67, v242, v243
    v_cndmask_b32_dpp v116, v209, v211, vcc row_ror:8 row_mask:0xf bank_mask:0xf
    v_cndmask_b32_dpp v117, v213, v215, vcc row_ror:8 row_mask:0xf bank_mask:0xf
    v_mfma_f32_16x16x32_bf16 a[108:111], v[60:63], v[0:3], 0
    s_add_u32 s71, s58, 2
    v_cndmask_b32_dpp v118, v217, v219, vcc row_ror:8 row_mask:0xf bank_mask:0xf
    v_cndmask_b32_dpp v119, v221, v223, vcc row_ror:8 row_mask:0xf bank_mask:0xf
    v_mfma_f32_16x16x32_bf16 a[104:107], v[56:59], v[0:3], 0
    s_waitcnt lgkmcnt(0)
    buffer_load_dwordx4 v[96:99], v252, s[40:43], s62 offen offset:2176
    v_mfma_f32_16x16x32_bf16 a[96:99], v[48:51], v[24:27], a[96:99]
    s_and_b32 s71, s71, 15
    v_perm_b32 v56, v113, v112, s65
    v_perm_b32 v57, v115, v114, s65
    v_perm_b32 v58, v117, v116, s65
    v_mfma_f32_16x16x32_bf16 a[100:103], v[52:55], v[24:27], a[100:103]
    s_mul_i32 s71, s71, 6144
    v_perm_b32 v59, v119, v118, s65
    v_perm_b32 v60, v113, v112, s66
    v_mfma_f32_16x16x32_bf16 a[116:119], v[52:55], v[28:31], a[116:119]
    v_accvgpr_read_b32 v236, a2
    v_perm_b32 v61, v115, v114, s66
    v_mfma_f32_16x16x32_bf16 a[112:115], v[48:51], v[28:31], a[112:115]
    buffer_store_dwordx4 v[64:67], v230, s[36:39], 0 offen offset:0 sc1
    v_perm_b32 v62, v117, v116, s66
    v_mfma_f32_16x16x32_bf16 a[128:131], v[48:51], v[32:35], a[128:131]
    ds_write_b128 v228, v[64:67] offset:0
    v_perm_b32 v63, v119, v118, s66
    v_mfma_f32_16x16x32_bf16 a[132:135], v[52:55], v[32:35], a[132:135]
    buffer_load_dwordx4 v[100:103], v252, s[40:43], s62 offen offset:3200
    v_mfma_f32_16x16x32_bf16 a[148:151], v[52:55], v[36:39], a[148:151]
    v_add_u32 v224, s71, v254
    v_accvgpr_read_b32 v237, a6
    v_cvt_pk_bf16_f32 v68, v236, v237
    v_mfma_f32_16x16x32_bf16 a[144:147], v[48:51], v[36:39], a[144:147]
    s_lshl_b32 s71, s101, 16
    s_add_u32 s40, s99, s71
    s_addc_u32 s41, s100, 0
    v_mfma_f32_16x16x32_bf16 a[160:163], v[48:51], v[40:43], a[160:163]
    s_add_u32 s101, s101, 1
    ds_read_b128 v[0:3], v224 offset:0
    ds_read_b128 v[4:7], v224 offset:1024
    v_mfma_f32_16x16x32_bf16 a[164:167], v[52:55], v[40:43], a[164:167]
    s_and_b32 s101, s101, 7
    ds_read_b128 v[8:11], v224 offset:2048
    ds_read_b128 v[12:15], v224 offset:3072
    v_mfma_f32_16x16x32_bf16 a[180:183], v[52:55], v[44:47], a[180:183]
    ds_read_b128 v[16:19], v224 offset:4096
    ds_read_b128 v[20:23], v224 offset:5120
    v_mfma_f32_16x16x32_bf16 a[176:179], v[48:51], v[44:47], a[176:179]
    buffer_load_dwordx4 v[192:195], v252, s[40:43], 0 offen offset:128
    v_mfma_f32_16x16x32_bf16 a[184:187], v[56:59], v[44:47], a[184:187]
    s_waitcnt vmcnt(18)
    s_not_b64 vcc, vcc
    v_cndmask_b32_dpp v104, v178, v176, vcc row_ror:8 row_mask:0xf bank_mask:0xf
    v_mfma_f32_16x16x32_bf16 a[188:191], v[60:63], v[44:47], a[188:191]
    v_cndmask_b32_dpp v105, v182, v180, vcc row_ror:8 row_mask:0xf bank_mask:0xf
    v_cndmask_b32_dpp v106, v186, v184, vcc row_ror:8 row_mask:0xf bank_mask:0xf
    v_accvgpr_read_b32 v238, a10
    v_mfma_f32_16x16x32_bf16 a[172:175], v[60:63], v[40:43], a[172:175]
    v_cndmask_b32_dpp v107, v190, v188, vcc row_ror:8 row_mask:0xf bank_mask:0xf
    v_cndmask_b32_dpp v108, v130, v128, vcc row_ror:8 row_mask:0xf bank_mask:0xf
    v_cndmask_b32_dpp v109, v134, v132, vcc row_ror:8 row_mask:0xf bank_mask:0xf
    v_mfma_f32_16x16x32_bf16 a[168:171], v[56:59], v[40:43], a[168:171]
    v_cndmask_b32_dpp v110, v138, v136, vcc row_ror:8 row_mask:0xf bank_mask:0xf
    v_accvgpr_read_b32 v239, a14
    v_cndmask_b32_dpp v111, v142, v140, vcc row_ror:8 row_mask:0xf bank_mask:0xf
    v_mfma_f32_16x16x32_bf16 a[152:155], v[56:59], v[36:39], a[152:155]
    v_perm_b32 v48, v105, v104, s65
    v_cvt_pk_bf16_f32 v69, v238, v239
    v_perm_b32 v49, v107, v106, s65
    v_mfma_f32_16x16x32_bf16 a[156:159], v[60:63], v[36:39], a[156:159]
    buffer_load_dwordx4 v[196:199], v252, s[40:43], 0 offen offset:1152
    v_mfma_f32_16x16x32_bf16 a[140:143], v[60:63], v[32:35], a[140:143]
    v_perm_b32 v50, v109, v108, s65
    v_perm_b32 v51, v111, v110, s65
    v_perm_b32 v52, v105, v104, s66
    v_mfma_f32_16x16x32_bf16 a[136:139], v[56:59], v[32:35], a[136:139]
    v_accvgpr_read_b32 v240, a3
    v_perm_b32 v53, v107, v106, s66
    v_perm_b32 v54, v109, v108, s66
    v_mfma_f32_16x16x32_bf16 a[120:123], v[56:59], v[28:31], a[120:123]
    v_perm_b32 v55, v111, v110, s66
    v_accvgpr_read_b32 v241, a7
    v_cndmask_b32_dpp v112, v179, v177, vcc row_ror:8 row_mask:0xf bank_mask:0xf
    v_mfma_f32_16x16x32_bf16 a[124:127], v[60:63], v[28:31], a[124:127]
    v_cndmask_b32_dpp v113, v183, v181, vcc row_ror:8 row_mask:0xf bank_mask:0xf
    v_cndmask_b32_dpp v114, v187, v185, vcc row_ror:8 row_mask:0xf bank_mask:0xf
    v_cndmask_b32_dpp v115, v191, v189, vcc row_ror:8 row_mask:0xf bank_mask:0xf
    v_mfma_f32_16x16x32_bf16 a[108:111], v[60:63], v[24:27], a[108:111]
    s_add_u32 s71, s58, 3
    v_cvt_pk_bf16_f32 v70, v240, v241
    v_cndmask_b32_dpp v116, v131, v129, vcc row_ror:8 row_mask:0xf bank_mask:0xf
    v_cndmask_b32_dpp v117, v135, v133, vcc row_ror:8 row_mask:0xf bank_mask:0xf
    v_mfma_f32_16x16x32_bf16 a[104:107], v[56:59], v[24:27], a[104:107]
    s_waitcnt lgkmcnt(0)
    buffer_load_dwordx4 v[200:203], v252, s[40:43], 0 offen offset:2176
    v_mfma_f32_16x16x32_bf16 a[96:99], v[48:51], v[0:3], a[96:99]
    s_and_b32 s71, s71, 15
    v_cndmask_b32_dpp v118, v139, v137, vcc row_ror:8 row_mask:0xf bank_mask:0xf
    v_cndmask_b32_dpp v119, v143, v141, vcc row_ror:8 row_mask:0xf bank_mask:0xf
    v_perm_b32 v56, v113, v112, s65
    v_mfma_f32_16x16x32_bf16 a[100:103], v[52:55], v[0:3], a[100:103]
    s_mul_i32 s71, s71, 6144
    v_accvgpr_read_b32 v242, a11
    v_perm_b32 v57, v115, v114, s65
    v_perm_b32 v58, v117, v116, s65
    v_mfma_f32_16x16x32_bf16 a[116:119], v[52:55], v[4:7], a[116:119]
    v_perm_b32 v59, v119, v118, s65
    v_perm_b32 v60, v113, v112, s66
    v_accvgpr_read_b32 v243, a15
    v_mfma_f32_16x16x32_bf16 a[112:115], v[48:51], v[4:7], a[112:115]
    s_not_b64 vcc, vcc
    v_perm_b32 v61, v115, v114, s66
    v_perm_b32 v62, v117, v116, s66
    v_mfma_f32_16x16x32_bf16 a[128:131], v[48:51], v[8:11], a[128:131]
    v_perm_b32 v63, v119, v118, s66
    v_add_u32 v224, s71, v254
    v_cvt_pk_bf16_f32 v71, v242, v243
    v_mfma_f32_16x16x32_bf16 a[132:135], v[52:55], v[8:11], a[132:135]
    buffer_load_dwordx4 v[204:207], v252, s[40:43], 0 offen offset:3200
    v_mfma_f32_16x16x32_bf16 a[148:151], v[52:55], v[12:15], a[148:151]
    v_cndmask_b32_dpp v104, v176, v178, vcc row_ror:8 row_mask:0xf bank_mask:0xf
    v_cndmask_b32_dpp v105, v180, v182, vcc row_ror:8 row_mask:0xf bank_mask:0xf
    v_cndmask_b32_dpp v106, v184, v186, vcc row_ror:8 row_mask:0xf bank_mask:0xf
    v_mfma_f32_16x16x32_bf16 a[144:147], v[48:51], v[12:15], a[144:147]
    v_accvgpr_read_b32 v236, a16
    v_cndmask_b32_dpp v107, v188, v190, vcc row_ror:8 row_mask:0xf bank_mask:0xf
    v_cndmask_b32_dpp v108, v128, v130, vcc row_ror:8 row_mask:0xf bank_mask:0xf
    v_mfma_f32_16x16x32_bf16 a[160:163], v[48:51], v[16:19], a[160:163]
    ds_read_b128 v[24:27], v224 offset:0
    v_cndmask_b32_dpp v109, v132, v134, vcc row_ror:8 row_mask:0xf bank_mask:0xf
    v_mfma_f32_16x16x32_bf16 a[164:167], v[52:55], v[16:19], a[164:167]
    ds_read_b128 v[28:31], v224 offset:1024
    v_cndmask_b32_dpp v110, v136, v138, vcc row_ror:8 row_mask:0xf bank_mask:0xf
    v_mfma_f32_16x16x32_bf16 a[180:183], v[52:55], v[20:23], a[180:183]
    ds_read_b128 v[32:35], v224 offset:2048
    v_accvgpr_read_b32 v237, a20
    v_mfma_f32_16x16x32_bf16 a[176:179], v[48:51], v[20:23], a[176:179]
    ds_read_b128 v[36:39], v224 offset:3072
    v_cndmask_b32_dpp v111, v140, v142, vcc row_ror:8 row_mask:0xf bank_mask:0xf
    v_mfma_f32_16x16x32_bf16 a[184:187], v[56:59], v[20:23], a[184:187]
    ds_read_b128 v[40:43], v224 offset:4096
    v_perm_b32 v48, v105, v104, s65
    v_mfma_f32_16x16x32_bf16 a[188:191], v[60:63], v[20:23], a[188:191]
    ds_read_b128 v[44:47], v224 offset:5120
    v_cvt_pk_bf16_f32 v244, v236, v237
    v_mfma_f32_16x16x32_bf16 a[172:175], v[60:63], v[16:19], a[172:175]
    buffer_store_dwordx4 v[68:71], v230, s[36:39], 0 offen offset:1024 sc1
    v_perm_b32 v49, v107, v106, s65
    v_mfma_f32_16x16x32_bf16 a[168:171], v[56:59], v[16:19], a[168:171]
    ds_write_b128 v228, v[68:71] offset:1024
    v_perm_b32 v50, v109, v108, s65
    v_mfma_f32_16x16x32_bf16 a[152:155], v[56:59], v[12:15], a[152:155]
    buffer_load_dwordx4 v[208:211], v252, s[40:43], s62 offen offset:128
    v_mfma_f32_16x16x32_bf16 a[156:159], v[60:63], v[12:15], a[156:159]
    buffer_load_dwordx4 v[212:215], v252, s[40:43], s62 offen offset:1152
    v_mfma_f32_16x16x32_bf16 a[140:143], v[60:63], v[8:11], a[140:143]
    v_perm_b32 v51, v111, v110, s65
    v_perm_b32 v52, v105, v104, s66
    v_accvgpr_read_b32 v238, a24
    v_mfma_f32_16x16x32_bf16 a[136:139], v[56:59], v[8:11], a[136:139]
    v_perm_b32 v53, v107, v106, s66
    v_perm_b32 v54, v109, v108, s66
    v_perm_b32 v55, v111, v110, s66
    v_mfma_f32_16x16x32_bf16 a[120:123], v[56:59], v[4:7], a[120:123]
    v_accvgpr_read_b32 v239, a28
    v_cndmask_b32_dpp v112, v177, v179, vcc row_ror:8 row_mask:0xf bank_mask:0xf
    v_cndmask_b32_dpp v113, v181, v183, vcc row_ror:8 row_mask:0xf bank_mask:0xf
    v_mfma_f32_16x16x32_bf16 a[124:127], v[60:63], v[4:7], a[124:127]
    v_cndmask_b32_dpp v114, v185, v187, vcc row_ror:8 row_mask:0xf bank_mask:0xf
    v_cndmask_b32_dpp v115, v189, v191, vcc row_ror:8 row_mask:0xf bank_mask:0xf
    v_cvt_pk_bf16_f32 v245, v238, v239
    v_mfma_f32_16x16x32_bf16 a[108:111], v[60:63], v[0:3], a[108:111]
    s_add_u32 s71, s58, 4
    v_cndmask_b32_dpp v116, v129, v131, vcc row_ror:8 row_mask:0xf bank_mask:0xf
    v_cndmask_b32_dpp v117, v133, v135, vcc row_ror:8 row_mask:0xf bank_mask:0xf
    v_cndmask_b32_dpp v118, v137, v139, vcc row_ror:8 row_mask:0xf bank_mask:0xf
    v_mfma_f32_16x16x32_bf16 a[104:107], v[56:59], v[0:3], a[104:107]
    s_waitcnt lgkmcnt(1)
    buffer_load_dwordx4 v[216:219], v252, s[40:43], s62 offen offset:2176
    v_mfma_f32_16x16x32_bf16 a[96:99], v[48:51], v[24:27], a[96:99]
    s_and_b32 s71, s71, 15
    v_cndmask_b32_dpp v119, v141, v143, vcc row_ror:8 row_mask:0xf bank_mask:0xf
    v_perm_b32 v56, v113, v112, s65
    v_accvgpr_read_b32 v240, a17
    v_mfma_f32_16x16x32_bf16 a[100:103], v[52:55], v[24:27], a[100:103]
    s_mul_i32 s71, s71, 6144
    v_perm_b32 v57, v115, v114, s65
    v_perm_b32 v58, v117, v116, s65
    v_perm_b32 v59, v119, v118, s65
    v_mfma_f32_16x16x32_bf16 a[116:119], v[52:55], v[28:31], a[116:119]
    v_perm_b32 v60, v113, v112, s66
    v_accvgpr_read_b32 v241, a21
    v_mfma_f32_16x16x32_bf16 a[112:115], v[48:51], v[28:31], a[112:115]
    v_perm_b32 v61, v115, v114, s66
    v_perm_b32 v62, v117, v116, s66
    v_mfma_f32_16x16x32_bf16 a[128:131], v[48:51], v[32:35], a[128:131]
    v_perm_b32 v63, v119, v118, s66
    v_add_u32 v224, s71, v254
    v_cvt_pk_bf16_f32 v246, v240, v241
    v_mfma_f32_16x16x32_bf16 a[132:135], v[52:55], v[32:35], a[132:135]
    buffer_load_dwordx4 v[220:223], v252, s[40:43], s62 offen offset:3200
    v_mfma_f32_16x16x32_bf16 a[148:151], v[52:55], v[36:39], a[148:151]
    s_lshl_b32 s71, s101, 16
    s_add_u32 s40, s99, s71
    v_accvgpr_read_b32 v242, a25
    v_mfma_f32_16x16x32_bf16 a[144:147], v[48:51], v[36:39], a[144:147]
    s_addc_u32 s41, s100, 0
    s_add_u32 s101, s101, 1
    s_and_b32 s101, s101, 7
    v_mfma_f32_16x16x32_bf16 a[160:163], v[48:51], v[40:43], a[160:163]
    ds_read_b128 v[0:3], v224 offset:0
    ds_read_b128 v[4:7], v224 offset:1024
    v_mfma_f32_16x16x32_bf16 a[164:167], v[52:55], v[40:43], a[164:167]
    ds_read_b128 v[8:11], v224 offset:2048
    ds_read_b128 v[12:15], v224 offset:3072
    v_mfma_f32_16x16x32_bf16 a[180:183], v[52:55], v[44:47], a[180:183]
    ds_read_b128 v[16:19], v224 offset:4096
    ds_read_b128 v[20:23], v224 offset:5120
    v_mfma_f32_16x16x32_bf16 a[176:179], v[48:51], v[44:47], a[176:179]
    buffer_load_dwordx4 v[176:179], v252, s[40:43], 0 offen offset:128
    v_mfma_f32_16x16x32_bf16 a[184:187], v[56:59], v[44:47], a[184:187]
    s_waitcnt vmcnt(19)
    s_not_b64 vcc, vcc
    v_cndmask_b32_dpp v104, v146, v144, vcc row_ror:8 row_mask:0xf bank_mask:0xf
    v_mfma_f32_16x16x32_bf16 a[188:191], v[60:63], v[44:47], a[188:191]
    v_cndmask_b32_dpp v105, v150, v148, vcc row_ror:8 row_mask:0xf bank_mask:0xf
    v_cndmask_b32_dpp v106, v154, v152, vcc row_ror:8 row_mask:0xf bank_mask:0xf
    v_accvgpr_read_b32 v243, a29
    v_mfma_f32_16x16x32_bf16 a[172:175], v[60:63], v[40:43], a[172:175]
    v_cndmask_b32_dpp v107, v158, v156, vcc row_ror:8 row_mask:0xf bank_mask:0xf
    v_cndmask_b32_dpp v108, v162, v160, vcc row_ror:8 row_mask:0xf bank_mask:0xf
    v_cndmask_b32_dpp v109, v166, v164, vcc row_ror:8 row_mask:0xf bank_mask:0xf
    v_mfma_f32_16x16x32_bf16 a[168:171], v[56:59], v[40:43], a[168:171]
    v_cndmask_b32_dpp v110, v170, v168, vcc row_ror:8 row_mask:0xf bank_mask:0xf
    v_cvt_pk_bf16_f32 v247, v242, v243
    v_cndmask_b32_dpp v111, v174, v172, vcc row_ror:8 row_mask:0xf bank_mask:0xf
    v_mfma_f32_16x16x32_bf16 a[152:155], v[56:59], v[36:39], a[152:155]
    v_perm_b32 v48, v105, v104, s65
    v_perm_b32 v49, v107, v106, s65
    v_perm_b32 v50, v109, v108, s65
    v_mfma_f32_16x16x32_bf16 a[156:159], v[60:63], v[36:39], a[156:159]
    buffer_load_dwordx4 v[180:183], v252, s[40:43], 0 offen offset:1152
    v_mfma_f32_16x16x32_bf16 a[140:143], v[60:63], v[32:35], a[140:143]
    buffer_store_dwordx4 v[244:247], v230, s[36:39], 0 offen offset:2048 sc1
    v_perm_b32 v51, v111, v110, s65
    v_mfma_f32_16x16x32_bf16 a[136:139], v[56:59], v[32:35], a[136:139]
    ds_write_b128 v228, v[244:247] offset:2048
    v_perm_b32 v52, v105, v104, s66
    v_mfma_f32_16x16x32_bf16 a[120:123], v[56:59], v[28:31], a[120:123]
    v_accvgpr_read_b32 v236, a18
    v_perm_b32 v53, v107, v106, s66
    v_perm_b32 v54, v109, v108, s66
    v_mfma_f32_16x16x32_bf16 a[124:127], v[60:63], v[28:31], a[124:127]
    v_perm_b32 v55, v111, v110, s66
    v_accvgpr_read_b32 v237, a22
    v_cndmask_b32_dpp v112, v147, v145, vcc row_ror:8 row_mask:0xf bank_mask:0xf
    v_mfma_f32_16x16x32_bf16 a[108:111], v[60:63], v[24:27], a[108:111]
    s_add_u32 s71, s58, 5
    v_cndmask_b32_dpp v113, v151, v149, vcc row_ror:8 row_mask:0xf bank_mask:0xf
    v_cndmask_b32_dpp v114, v155, v153, vcc row_ror:8 row_mask:0xf bank_mask:0xf
    v_cndmask_b32_dpp v115, v159, v157, vcc row_ror:8 row_mask:0xf bank_mask:0xf
    v_mfma_f32_16x16x32_bf16 a[104:107], v[56:59], v[24:27], a[104:107]
    s_waitcnt lgkmcnt(1)
    buffer_load_dwordx4 v[184:187], v252, s[40:43], 0 offen offset:2176
    v_mfma_f32_16x16x32_bf16 a[96:99], v[48:51], v[0:3], a[96:99]
    s_and_b32 s71, s71, 15
    v_cvt_pk_bf16_f32 v248, v236, v237
    v_cndmask_b32_dpp v116, v163, v161, vcc row_ror:8 row_mask:0xf bank_mask:0xf
    v_cndmask_b32_dpp v117, v167, v165, vcc row_ror:8 row_mask:0xf bank_mask:0xf
    v_mfma_f32_16x16x32_bf16 a[100:103], v[52:55], v[0:3], a[100:103]
    s_mul_i32 s71, s71, 6144
    v_cndmask_b32_dpp v118, v171, v169, vcc row_ror:8 row_mask:0xf bank_mask:0xf
    v_cndmask_b32_dpp v119, v175, v173, vcc row_ror:8 row_mask:0xf bank_mask:0xf
    v_perm_b32 v56, v113, v112, s65
    v_mfma_f32_16x16x32_bf16 a[116:119], v[52:55], v[4:7], a[116:119]
    v_accvgpr_read_b32 v238, a26
    v_perm_b32 v57, v115, v114, s65
    v_perm_b32 v58, v117, v116, s65
    v_mfma_f32_16x16x32_bf16 a[112:115], v[48:51], v[4:7], a[112:115]
    s_not_b64 vcc, vcc
    v_perm_b32 v59, v119, v118, s65
    v_perm_b32 v60, v113, v112, s66
    v_accvgpr_read_b32 v239, a30
    v_mfma_f32_16x16x32_bf16 a[128:131], v[48:51], v[8:11], a[128:131]
    v_perm_b32 v61, v115, v114, s66
    v_perm_b32 v62, v117, v116, s66
    v_perm_b32 v63, v119, v118, s66
    v_mfma_f32_16x16x32_bf16 a[132:135], v[52:55], v[8:11], a[132:135]
    buffer_load_dwordx4 v[188:191], v252, s[40:43], 0 offen offset:3200
    v_mfma_f32_16x16x32_bf16 a[148:151], v[52:55], v[12:15], a[148:151]
    v_add_u32 v224, s71, v254
    v_cvt_pk_bf16_f32 v249, v238, v239
    v_accvgpr_read_b32 v240, a19
    v_mfma_f32_16x16x32_bf16 a[144:147], v[48:51], v[12:15], a[144:147]
    v_cndmask_b32_dpp v104, v144, v146, vcc row_ror:8 row_mask:0xf bank_mask:0xf
    v_cndmask_b32_dpp v105, v148, v150, vcc row_ror:8 row_mask:0xf bank_mask:0xf
    v_cndmask_b32_dpp v106, v152, v154, vcc row_ror:8 row_mask:0xf bank_mask:0xf
    v_mfma_f32_16x16x32_bf16 a[160:163], v[48:51], v[16:19], a[160:163]
    ds_read_b128 v[24:27], v224 offset:0
    v_accvgpr_read_b32 v241, a23
    v_mfma_f32_16x16x32_bf16 a[164:167], v[52:55], v[16:19], a[164:167]
    ds_read_b128 v[28:31], v224 offset:1024
    v_cndmask_b32_dpp v107, v156, v158, vcc row_ror:8 row_mask:0xf bank_mask:0xf
    v_mfma_f32_16x16x32_bf16 a[180:183], v[52:55], v[20:23], a[180:183]
    ds_read_b128 v[32:35], v224 offset:2048
    v_cndmask_b32_dpp v108, v160, v162, vcc row_ror:8 row_mask:0xf bank_mask:0xf
    v_mfma_f32_16x16x32_bf16 a[176:179], v[48:51], v[20:23], a[176:179]
    ds_read_b128 v[36:39], v224 offset:3072
    v_cndmask_b32_dpp v109, v164, v166, vcc row_ror:8 row_mask:0xf bank_mask:0xf
    v_mfma_f32_16x16x32_bf16 a[184:187], v[56:59], v[20:23], a[184:187]
    ds_read_b128 v[40:43], v224 offset:4096
    v_cndmask_b32_dpp v110, v168, v170, vcc row_ror:8 row_mask:0xf bank_mask:0xf
    v_mfma_f32_16x16x32_bf16 a[188:191], v[60:63], v[20:23], a[188:191]
    ds_read_b128 v[44:47], v224 offset:5120
    v_cvt_pk_bf16_f32 v250, v240, v241
    v_mfma_f32_16x16x32_bf16 a[172:175], v[60:63], v[16:19], a[172:175]
    buffer_load_dwordx4 v[128:131], v252, s[40:43], s62 offen offset:128
    v_mfma_f32_16x16x32_bf16 a[168:171], v[56:59], v[16:19], a[168:171]
    v_cndmask_b32_dpp v111, v172, v174, vcc row_ror:8 row_mask:0xf bank_mask:0xf
    v_perm_b32 v48, v105, v104, s65
    v_accvgpr_read_b32 v242, a27
    v_mfma_f32_16x16x32_bf16 a[152:155], v[56:59], v[12:15], a[152:155]
    v_perm_b32 v49, v107, v106, s65
    v_perm_b32 v50, v109, v108, s65
    v_perm_b32 v51, v111, v110, s65
    v_mfma_f32_16x16x32_bf16 a[156:159], v[60:63], v[12:15], a[156:159]
    buffer_load_dwordx4 v[132:135], v252, s[40:43], s62 offen offset:1152
    v_mfma_f32_16x16x32_bf16 a[140:143], v[60:63], v[8:11], a[140:143]
    v_perm_b32 v52, v105, v104, s66
    v_accvgpr_read_b32 v243, a31
    v_perm_b32 v53, v107, v106, s66
    v_mfma_f32_16x16x32_bf16 a[136:139], v[56:59], v[8:11], a[136:139]
    v_perm_b32 v54, v109, v108, s66
    v_perm_b32 v55, v111, v110, s66
    v_cvt_pk_bf16_f32 v251, v242, v243
    v_mfma_f32_16x16x32_bf16 a[120:123], v[56:59], v[4:7], a[120:123]
    v_cndmask_b32_dpp v112, v145, v147, vcc row_ror:8 row_mask:0xf bank_mask:0xf
    v_cndmask_b32_dpp v113, v149, v151, vcc row_ror:8 row_mask:0xf bank_mask:0xf
    v_cndmask_b32_dpp v114, v153, v155, vcc row_ror:8 row_mask:0xf bank_mask:0xf
    v_mfma_f32_16x16x32_bf16 a[124:127], v[60:63], v[4:7], a[124:127]
    v_cndmask_b32_dpp v115, v157, v159, vcc row_ror:8 row_mask:0xf bank_mask:0xf
    v_cndmask_b32_dpp v116, v161, v163, vcc row_ror:8 row_mask:0xf bank_mask:0xf
    v_cndmask_b32_dpp v117, v165, v167, vcc row_ror:8 row_mask:0xf bank_mask:0xf
    v_mfma_f32_16x16x32_bf16 a[108:111], v[60:63], v[0:3], a[108:111]
    s_add_u32 s71, s58, 6
    v_cndmask_b32_dpp v118, v169, v171, vcc row_ror:8 row_mask:0xf bank_mask:0xf
    v_cndmask_b32_dpp v119, v173, v175, vcc row_ror:8 row_mask:0xf bank_mask:0xf
    v_mfma_f32_16x16x32_bf16 a[104:107], v[56:59], v[0:3], a[104:107]
    s_waitcnt lgkmcnt(0)
    buffer_load_dwordx4 v[136:139], v252, s[40:43], s62 offen offset:2176
    v_mfma_f32_16x16x32_bf16 a[96:99], v[48:51], v[24:27], a[96:99]
    s_and_b32 s71, s71, 15
    v_perm_b32 v56, v113, v112, s65
    v_accvgpr_read_b32 v236, a32
    v_perm_b32 v57, v115, v114, s65
    v_mfma_f32_16x16x32_bf16 a[100:103], v[52:55], v[24:27], a[100:103]
    buffer_store_dwordx4 v[248:251], v230, s[36:39], 0 offen offset:3072 sc1
    v_perm_b32 v58, v117, v116, s65
    v_mfma_f32_16x16x32_bf16 a[116:119], v[52:55], v[28:31], a[116:119]
    ds_write_b128 v228, v[248:251] offset:3072
    v_perm_b32 v59, v119, v118, s65
    v_mfma_f32_16x16x32_bf16 a[112:115], v[48:51], v[28:31], a[112:115]
    s_mul_i32 s71, s71, 6144
    v_perm_b32 v60, v113, v112, s66
    v_accvgpr_read_b32 v237, a36
    v_mfma_f32_16x16x32_bf16 a[128:131], v[48:51], v[32:35], a[128:131]
    v_perm_b32 v61, v115, v114, s66
    v_perm_b32 v62, v117, v116, s66
    v_perm_b32 v63, v119, v118, s66
    v_mfma_f32_16x16x32_bf16 a[132:135], v[52:55], v[32:35], a[132:135]
    buffer_load_dwordx4 v[140:143], v252, s[40:43], s62 offen offset:3200
    v_mfma_f32_16x16x32_bf16 a[148:151], v[52:55], v[36:39], a[148:151]
    v_add_u32 v224, s71, v254
    v_cvt_pk_bf16_f32 v64, v236, v237
    v_accvgpr_read_b32 v238, a40
    v_mfma_f32_16x16x32_bf16 a[144:147], v[48:51], v[36:39], a[144:147]
    s_lshl_b32 s71, s101, 16
    s_add_u32 s40, s99, s71
    s_addc_u32 s41, s100, 0
    v_mfma_f32_16x16x32_bf16 a[160:163], v[48:51], v[40:43], a[160:163]
    s_add_u32 s101, s101, 1
    ds_read_b128 v[0:3], v224 offset:0
    ds_read_b128 v[4:7], v224 offset:1024
    v_mfma_f32_16x16x32_bf16 a[164:167], v[52:55], v[40:43], a[164:167]
    s_and_b32 s101, s101, 7
    ds_read_b128 v[8:11], v224 offset:2048
    ds_read_b128 v[12:15], v224 offset:3072
    v_mfma_f32_16x16x32_bf16 a[180:183], v[52:55], v[44:47], a[180:183]
    ds_read_b128 v[16:19], v224 offset:4096
    ds_read_b128 v[20:23], v224 offset:5120
    v_mfma_f32_16x16x32_bf16 a[176:179], v[48:51], v[44:47], a[176:179]
    buffer_load_dwordx4 v[144:147], v252, s[40:43], 0 offen offset:128
    v_mfma_f32_16x16x32_bf16 a[184:187], v[56:59], v[44:47], a[184:187]
    s_waitcnt vmcnt(20)
    s_not_b64 vcc, vcc
    v_cndmask_b32_dpp v104, v74, v72, vcc row_ror:8 row_mask:0xf bank_mask:0xf
    v_mfma_f32_16x16x32_bf16 a[188:191], v[60:63], v[44:47], a[188:191]
    v_cndmask_b32_dpp v105, v78, v76, vcc row_ror:8 row_mask:0xf bank_mask:0xf
    v_cndmask_b32_dpp v106, v82, v80, vcc row_ror:8 row_mask:0xf bank_mask:0xf
    v_accvgpr_read_b32 v239, a44
    v_mfma_f32_16x16x32_bf16 a[172:175], v[60:63], v[40:43], a[172:175]
    v_cndmask_b32_dpp v107, v86, v84, vcc row_ror:8 row_mask:0xf bank_mask:0xf
    v_cndmask_b32_dpp v108, v90, v88, vcc row_ror:8 row_mask:0xf bank_mask:0xf
    v_cndmask_b32_dpp v109, v94, v92, vcc row_ror:8 row_mask:0xf bank_mask:0xf
    v_mfma_f32_16x16x32_bf16 a[168:171], v[56:59], v[40:43], a[168:171]
    v_cndmask_b32_dpp v110, v98, v96, vcc row_ror:8 row_mask:0xf bank_mask:0xf
    v_cvt_pk_bf16_f32 v65, v238, v239
    v_cndmask_b32_dpp v111, v102, v100, vcc row_ror:8 row_mask:0xf bank_mask:0xf
    v_mfma_f32_16x16x32_bf16 a[152:155], v[56:59], v[36:39], a[152:155]
    v_perm_b32 v48, v105, v104, s65
    v_accvgpr_read_b32 v240, a33
    v_perm_b32 v49, v107, v106, s65
    v_mfma_f32_16x16x32_bf16 a[156:159], v[60:63], v[36:39], a[156:159]
    buffer_load_dwordx4 v[148:151], v252, s[40:43], 0 offen offset:1152
    v_mfma_f32_16x16x32_bf16 a[140:143], v[60:63], v[32:35], a[140:143]
    v_perm_b32 v50, v109, v108, s65
    v_perm_b32 v51, v111, v110, s65
    v_perm_b32 v52, v105, v104, s66
    v_mfma_f32_16x16x32_bf16 a[136:139], v[56:59], v[32:35], a[136:139]
    v_accvgpr_read_b32 v241, a37
    v_perm_b32 v53, v107, v106, s66
    v_perm_b32 v54, v109, v108, s66
    v_mfma_f32_16x16x32_bf16 a[120:123], v[56:59], v[28:31], a[120:123]
    v_perm_b32 v55, v111, v110, s66
    v_cvt_pk_bf16_f32 v66, v240, v241
    v_cndmask_b32_dpp v112, v75, v73, vcc row_ror:8 row_mask:0xf bank_mask:0xf
    v_mfma_f32_16x16x32_bf16 a[124:127], v[60:63], v[28:31], a[124:127]
    v_cndmask_b32_dpp v113, v79, v77, vcc row_ror:8 row_mask:0xf bank_mask:0xf
    v_cndmask_b32_dpp v114, v83, v81, vcc row_ror:8 row_mask:0xf bank_mask:0xf
    v_cndmask_b32_dpp v115, v87, v85, vcc row_ror:8 row_mask:0xf bank_mask:0xf
    v_mfma_f32_16x16x32_bf16 a[108:111], v[60:63], v[24:27], a[108:111]
    s_add_u32 s71, s58, 7
    v_accvgpr_read_b32 v242, a41
    v_cndmask_b32_dpp v116, v91, v89, vcc row_ror:8 row_mask:0xf bank_mask:0xf
    v_cndmask_b32_dpp v117, v95, v93, vcc row_ror:8 row_mask:0xf bank_mask:0xf
    v_mfma_f32_16x16x32_bf16 a[104:107], v[56:59], v[24:27], a[104:107]
    s_waitcnt lgkmcnt(0)
    buffer_load_dwordx4 v[152:155], v252, s[40:43], 0 offen offset:2176
    v_mfma_f32_16x16x32_bf16 a[96:99], v[48:51], v[0:3], a[96:99]
    s_and_b32 s71, s71, 15
    v_cndmask_b32_dpp v118, v99, v97, vcc row_ror:8 row_mask:0xf bank_mask:0xf
    v_cndmask_b32_dpp v119, v103, v101, vcc row_ror:8 row_mask:0xf bank_mask:0xf
    v_perm_b32 v56, v113, v112, s65
    v_mfma_f32_16x16x32_bf16 a[100:103], v[52:55], v[0:3], a[100:103]
    s_mul_i32 s71, s71, 6144
    v_accvgpr_read_b32 v243, a45
    v_perm_b32 v57, v115, v114, s65
    v_perm_b32 v58, v117, v116, s65
    v_mfma_f32_16x16x32_bf16 a[116:119], v[52:55], v[4:7], a[116:119]
    v_perm_b32 v59, v119, v118, s65
    v_perm_b32 v60, v113, v112, s66
    v_cvt_pk_bf16_f32 v67, v242, v243
    v_mfma_f32_16x16x32_bf16 a[112:115], v[48:51], v[4:7], a[112:115]
    s_not_b64 vcc, vcc
    v_perm_b32 v61, v115, v114, s66
    v_perm_b32 v62, v117, v116, s66
    v_mfma_f32_16x16x32_bf16 a[128:131], v[48:51], v[8:11], a[128:131]
    v_perm_b32 v63, v119, v118, s66
    v_add_u32 v224, s71, v254
    v_accvgpr_read_b32 v236, a34
    v_mfma_f32_16x16x32_bf16 a[132:135], v[52:55], v[8:11], a[132:135]
    buffer_load_dwordx4 v[156:159], v252, s[40:43], 0 offen offset:3200
    v_mfma_f32_16x16x32_bf16 a[148:151], v[52:55], v[12:15], a[148:151]
    v_cndmask_b32_dpp v104, v72, v74, vcc row_ror:8 row_mask:0xf bank_mask:0xf
    v_cndmask_b32_dpp v105, v76, v78, vcc row_ror:8 row_mask:0xf bank_mask:0xf
    v_cndmask_b32_dpp v106, v80, v82, vcc row_ror:8 row_mask:0xf bank_mask:0xf
    v_mfma_f32_16x16x32_bf16 a[144:147], v[48:51], v[12:15], a[144:147]
    v_accvgpr_read_b32 v237, a38
    v_cndmask_b32_dpp v107, v84, v86, vcc row_ror:8 row_mask:0xf bank_mask:0xf
    v_cndmask_b32_dpp v108, v88, v90, vcc row_ror:8 row_mask:0xf bank_mask:0xf
    v_mfma_f32_16x16x32_bf16 a[160:163], v[48:51], v[16:19], a[160:163]
    ds_read_b128 v[24:27], v224 offset:0
    v_cndmask_b32_dpp v109, v92, v94, vcc row_ror:8 row_mask:0xf bank_mask:0xf
    v_mfma_f32_16x16x32_bf16 a[164:167], v[52:55], v[16:19], a[164:167]
    buffer_store_dwordx4 v[64:67], v230, s[36:39], s59 offen offset:0 sc1
    v_cndmask_b32_dpp v110, v96, v98, vcc row_ror:8 row_mask:0xf bank_mask:0xf
    v_mfma_f32_16x16x32_bf16 a[180:183], v[52:55], v[20:23], a[180:183]
    ds_write_b128 v228, v[64:67] offset:4096
    v_cvt_pk_bf16_f32 v68, v236, v237
    v_mfma_f32_16x16x32_bf16 a[176:179], v[48:51], v[20:23], a[176:179]
    ds_read_b128 v[28:31], v224 offset:1024
    v_cndmask_b32_dpp v111, v100, v102, vcc row_ror:8 row_mask:0xf bank_mask:0xf
    v_mfma_f32_16x16x32_bf16 a[184:187], v[56:59], v[20:23], a[184:187]
    ds_read_b128 v[32:35], v224 offset:2048
    v_perm_b32 v48, v105, v104, s65
    v_mfma_f32_16x16x32_bf16 a[188:191], v[60:63], v[20:23], a[188:191]
    ds_read_b128 v[36:39], v224 offset:3072
    v_accvgpr_read_b32 v238, a42
    v_mfma_f32_16x16x32_bf16 a[172:175], v[60:63], v[16:19], a[172:175]
    ds_read_b128 v[40:43], v224 offset:4096
    v_perm_b32 v49, v107, v106, s65
    v_mfma_f32_16x16x32_bf16 a[168:171], v[56:59], v[16:19], a[168:171]
    ds_read_b128 v[44:47], v224 offset:5120
    v_perm_b32 v50, v109, v108, s65
    v_mfma_f32_16x16x32_bf16 a[152:155], v[56:59], v[12:15], a[152:155]
    buffer_load_dwordx4 v[160:163], v252, s[40:43], s62 offen offset:128
    v_mfma_f32_16x16x32_bf16 a[156:159], v[60:63], v[12:15], a[156:159]
    buffer_load_dwordx4 v[164:167], v252, s[40:43], s62 offen offset:1152
    v_mfma_f32_16x16x32_bf16 a[140:143], v[60:63], v[8:11], a[140:143]
    v_perm_b32 v51, v111, v110, s65
    v_perm_b32 v52, v105, v104, s66
    v_accvgpr_read_b32 v239, a46
    v_mfma_f32_16x16x32_bf16 a[136:139], v[56:59], v[8:11], a[136:139]
    v_perm_b32 v53, v107, v106, s66
    v_perm_b32 v54, v109, v108, s66
    v_perm_b32 v55, v111, v110, s66
    v_mfma_f32_16x16x32_bf16 a[120:123], v[56:59], v[4:7], a[120:123]
    v_cvt_pk_bf16_f32 v69, v238, v239
    v_cndmask_b32_dpp v112, v73, v75, vcc row_ror:8 row_mask:0xf bank_mask:0xf
    v_cndmask_b32_dpp v113, v77, v79, vcc row_ror:8 row_mask:0xf bank_mask:0xf
    v_mfma_f32_16x16x32_bf16 a[124:127], v[60:63], v[4:7], a[124:127]
    v_cndmask_b32_dpp v114, v81, v83, vcc row_ror:8 row_mask:0xf bank_mask:0xf
    v_cndmask_b32_dpp v115, v85, v87, vcc row_ror:8 row_mask:0xf bank_mask:0xf
    v_accvgpr_read_b32 v240, a35
    v_mfma_f32_16x16x32_bf16 a[108:111], v[60:63], v[0:3], a[108:111]
    s_add_u32 s71, s58, 8
    v_cndmask_b32_dpp v116, v89, v91, vcc row_ror:8 row_mask:0xf bank_mask:0xf
    v_cndmask_b32_dpp v117, v93, v95, vcc row_ror:8 row_mask:0xf bank_mask:0xf
    v_cndmask_b32_dpp v118, v97, v99, vcc row_ror:8 row_mask:0xf bank_mask:0xf
    v_mfma_f32_16x16x32_bf16 a[104:107], v[56:59], v[0:3], a[104:107]
    s_waitcnt lgkmcnt(0)
    buffer_load_dwordx4 v[168:171], v252, s[40:43], s62 offen offset:2176
    v_mfma_f32_16x16x32_bf16 a[96:99], v[48:51], v[24:27], a[96:99]
    s_and_b32 s71, s71, 15
    v_cndmask_b32_dpp v119, v101, v103, vcc row_ror:8 row_mask:0xf bank_mask:0xf
    v_perm_b32 v56, v113, v112, s65
    v_accvgpr_read_b32 v241, a39
    v_mfma_f32_16x16x32_bf16 a[100:103], v[52:55], v[24:27], a[100:103]
    s_mul_i32 s71, s71, 6144
    v_perm_b32 v57, v115, v114, s65
    v_perm_b32 v58, v117, v116, s65
    v_perm_b32 v59, v119, v118, s65
    v_mfma_f32_16x16x32_bf16 a[116:119], v[52:55], v[28:31], a[116:119]
    v_perm_b32 v60, v113, v112, s66
    v_cvt_pk_bf16_f32 v70, v240, v241
    v_mfma_f32_16x16x32_bf16 a[112:115], v[48:51], v[28:31], a[112:115]
    v_perm_b32 v61, v115, v114, s66
    v_perm_b32 v62, v117, v116, s66
    v_mfma_f32_16x16x32_bf16 a[128:131], v[48:51], v[32:35], a[128:131]
    v_perm_b32 v63, v119, v118, s66
    v_add_u32 v224, s71, v254
    v_accvgpr_read_b32 v242, a43
    v_mfma_f32_16x16x32_bf16 a[132:135], v[52:55], v[32:35], a[132:135]
    buffer_load_dwordx4 v[172:175], v252, s[40:43], s62 offen offset:3200
    v_mfma_f32_16x16x32_bf16 a[148:151], v[52:55], v[36:39], a[148:151]
    s_lshl_b32 s71, s101, 16
    s_add_u32 s40, s99, s71
    v_accvgpr_read_b32 v243, a47
    v_mfma_f32_16x16x32_bf16 a[144:147], v[48:51], v[36:39], a[144:147]
    s_addc_u32 s41, s100, 0
    s_add_u32 s101, s101, 1
    s_and_b32 s101, s101, 7
    v_mfma_f32_16x16x32_bf16 a[160:163], v[48:51], v[40:43], a[160:163]
    ds_read_b128 v[0:3], v224 offset:0
    ds_read_b128 v[4:7], v224 offset:1024
    v_mfma_f32_16x16x32_bf16 a[164:167], v[52:55], v[40:43], a[164:167]
    ds_read_b128 v[8:11], v224 offset:2048
    ds_read_b128 v[12:15], v224 offset:3072
    v_mfma_f32_16x16x32_bf16 a[180:183], v[52:55], v[44:47], a[180:183]
    ds_read_b128 v[16:19], v224 offset:4096
    ds_read_b128 v[20:23], v224 offset:5120
    v_mfma_f32_16x16x32_bf16 a[176:179], v[48:51], v[44:47], a[176:179]
    buffer_load_dwordx4 v[72:75], v252, s[40:43], 0 offen offset:128
    v_mfma_f32_16x16x32_bf16 a[184:187], v[56:59], v[44:47], a[184:187]
    s_waitcnt vmcnt(20)
    s_not_b64 vcc, vcc
    v_cndmask_b32_dpp v104, v194, v192, vcc row_ror:8 row_mask:0xf bank_mask:0xf
    v_mfma_f32_16x16x32_bf16 a[188:191], v[60:63], v[44:47], a[188:191]
    v_cndmask_b32_dpp v105, v198, v196, vcc row_ror:8 row_mask:0xf bank_mask:0xf
    v_cndmask_b32_dpp v106, v202, v200, vcc row_ror:8 row_mask:0xf bank_mask:0xf
    v_cvt_pk_bf16_f32 v71, v242, v243
    v_mfma_f32_16x16x32_bf16 a[172:175], v[60:63], v[40:43], a[172:175]
    v_cndmask_b32_dpp v107, v206, v204, vcc row_ror:8 row_mask:0xf bank_mask:0xf
    v_cndmask_b32_dpp v108, v210, v208, vcc row_ror:8 row_mask:0xf bank_mask:0xf
    v_cndmask_b32_dpp v109, v214, v212, vcc row_ror:8 row_mask:0xf bank_mask:0xf
    v_mfma_f32_16x16x32_bf16 a[168:171], v[56:59], v[40:43], a[168:171]
    v_cndmask_b32_dpp v110, v218, v216, vcc row_ror:8 row_mask:0xf bank_mask:0xf
    v_cndmask_b32_dpp v111, v222, v220, vcc row_ror:8 row_mask:0xf bank_mask:0xf
    v_perm_b32 v48, v105, v104, s65
    v_mfma_f32_16x16x32_bf16 a[152:155], v[56:59], v[36:39], a[152:155]
    buffer_store_dwordx4 v[68:71], v230, s[36:39], s59 offen offset:1024 sc1
    v_accvgpr_read_b32 v236, a48
    v_mfma_f32_16x16x32_bf16 a[156:159], v[60:63], v[36:39], a[156:159]
    ds_write_b128 v228, v[68:71] offset:5120
    v_perm_b32 v49, v107, v106, s65
    v_mfma_f32_16x16x32_bf16 a[140:143], v[60:63], v[32:35], a[140:143]
    buffer_load_dwordx4 v[76:79], v252, s[40:43], 0 offen offset:1152
    v_mfma_f32_16x16x32_bf16 a[136:139], v[56:59], v[32:35], a[136:139]
    v_perm_b32 v50, v109, v108, s65
    v_perm_b32 v51, v111, v110, s65
    v_perm_b32 v52, v105, v104, s66
    v_mfma_f32_16x16x32_bf16 a[120:123], v[56:59], v[28:31], a[120:123]
    v_accvgpr_read_b32 v237, a52
    v_perm_b32 v53, v107, v106, s66
    v_perm_b32 v54, v109, v108, s66
    v_mfma_f32_16x16x32_bf16 a[124:127], v[60:63], v[28:31], a[124:127]
    v_perm_b32 v55, v111, v110, s66
    v_cvt_pk_bf16_f32 v244, v236, v237
    v_cndmask_b32_dpp v112, v195, v193, vcc row_ror:8 row_mask:0xf bank_mask:0xf
    v_mfma_f32_16x16x32_bf16 a[108:111], v[60:63], v[24:27], a[108:111]
    s_add_u32 s71, s58, 9
    v_cndmask_b32_dpp v113, v199, v197, vcc row_ror:8 row_mask:0xf bank_mask:0xf
    v_cndmask_b32_dpp v114, v203, v201, vcc row_ror:8 row_mask:0xf bank_mask:0xf
    v_cndmask_b32_dpp v115, v207, v205, vcc row_ror:8 row_mask:0xf bank_mask:0xf
    v_mfma_f32_16x16x32_bf16 a[104:107], v[56:59], v[24:27], a[104:107]
    s_waitcnt lgkmcnt(1)
    buffer_load_dwordx4 v[80:83], v252, s[40:43], 0 offen offset:2176
    v_mfma_f32_16x16x32_bf16 a[96:99], v[48:51], v[0:3], a[96:99]
    s_and_b32 s71, s71, 15
    v_accvgpr_read_b32 v238, a56
    v_cndmask_b32_dpp v116, v211, v209, vcc row_ror:8 row_mask:0xf bank_mask:0xf
    v_cndmask_b32_dpp v117, v215, v213, vcc row_ror:8 row_mask:0xf bank_mask:0xf
    v_mfma_f32_16x16x32_bf16 a[100:103], v[52:55], v[0:3], a[100:103]
    s_mul_i32 s71, s71, 6144
    v_cndmask_b32_dpp v118, v219, v217, vcc row_ror:8 row_mask:0xf bank_mask:0xf
    v_cndmask_b32_dpp v119, v223, v221, vcc row_ror:8 row_mask:0xf bank_mask:0xf
    v_perm_b32 v56, v113, v112, s65
    v_mfma_f32_16x16x32_bf16 a[116:119], v[52:55], v[4:7], a[116:119]
    v_accvgpr_read_b32 v239, a60
    v_perm_b32 v57, v115, v114, s65
    v_perm_b32 v58, v117, v116, s65
    v_mfma_f32_16x16x32_bf16 a[112:115], v[48:51], v[4:7], a[112:115]
    s_not_b64 vcc, vcc
    v_perm_b32 v59, v119, v118, s65
    v_perm_b32 v60, v113, v112, s66
    v_cvt_pk_bf16_f32 v245, v238, v239
    v_mfma_f32_16x16x32_bf16 a[128:131], v[48:51], v[8:11], a[128:131]
    v_perm_b32 v61, v115, v114, s66
    v_perm_b32 v62, v117, v116, s66
    v_perm_b32 v63, v119, v118, s66
    v_mfma_f32_16x16x32_bf16 a[132:135], v[52:55], v[8:11], a[132:135]
    buffer_load_dwordx4 v[84:87], v252, s[40:43], 0 offen offset:3200
    v_mfma_f32_16x16x32_bf16 a[148:151], v[52:55], v[12:15], a[148:151]
    v_add_u32 v224, s71, v254
    v_accvgpr_read_b32 v240, a49
    v_accvgpr_read_b32 v241, a53
    v_mfma_f32_16x16x32_bf16 a[144:147], v[48:51], v[12:15], a[144:147]
    v_cndmask_b32_dpp v104, v192, v194, vcc row_ror:8 row_mask:0xf bank_mask:0xf
    v_cndmask_b32_dpp v105, v196, v198, vcc row_ror:8 row_mask:0xf bank_mask:0xf
    v_cndmask_b32_dpp v106, v200, v202, vcc row_ror:8 row_mask:0xf bank_mask:0xf
    v_mfma_f32_16x16x32_bf16 a[160:163], v[48:51], v[16:19], a[160:163]
    ds_read_b128 v[24:27], v224 offset:0
    v_cvt_pk_bf16_f32 v246, v240, v241
    v_mfma_f32_16x16x32_bf16 a[164:167], v[52:55], v[16:19], a[164:167]
    ds_read_b128 v[28:31], v224 offset:1024
    v_cndmask_b32_dpp v107, v204, v206, vcc row_ror:8 row_mask:0xf bank_mask:0xf
    v_mfma_f32_16x16x32_bf16 a[180:183], v[52:55], v[20:23], a[180:183]
    ds_read_b128 v[32:35], v224 offset:2048
    v_cndmask_b32_dpp v108, v208, v210, vcc row_ror:8 row_mask:0xf bank_mask:0xf
    v_mfma_f32_16x16x32_bf16 a[176:179], v[48:51], v[20:23], a[176:179]
    ds_read_b128 v[36:39], v224 offset:3072
    v_cndmask_b32_dpp v109, v212, v214, vcc row_ror:8 row_mask:0xf bank_mask:0xf
    v_mfma_f32_16x16x32_bf16 a[184:187], v[56:59], v[20:23], a[184:187]
    ds_read_b128 v[40:43], v224 offset:4096
    v_cndmask_b32_dpp v110, v216, v218, vcc row_ror:8 row_mask:0xf bank_mask:0xf
    v_mfma_f32_16x16x32_bf16 a[188:191], v[60:63], v[20:23], a[188:191]
    ds_read_b128 v[44:47], v224 offset:5120
    v_accvgpr_read_b32 v242, a57
    v_mfma_f32_16x16x32_bf16 a[172:175], v[60:63], v[16:19], a[172:175]
    buffer_load_dwordx4 v[88:91], v252, s[40:43], s62 offen offset:128
    v_mfma_f32_16x16x32_bf16 a[168:171], v[56:59], v[16:19], a[168:171]
    v_cndmask_b32_dpp v111, v220, v222, vcc row_ror:8 row_mask:0xf bank_mask:0xf
    v_perm_b32 v48, v105, v104, s65
    v_accvgpr_read_b32 v243, a61
    v_mfma_f32_16x16x32_bf16 a[152:155], v[56:59], v[12:15], a[152:155]
    v_perm_b32 v49, v107, v106, s65
    v_perm_b32 v50, v109, v108, s65
    v_perm_b32 v51, v111, v110, s65
    v_mfma_f32_16x16x32_bf16 a[156:159], v[60:63], v[12:15], a[156:159]
    buffer_load_dwordx4 v[92:95], v252, s[40:43], s62 offen offset:1152
    v_mfma_f32_16x16x32_bf16 a[140:143], v[60:63], v[8:11], a[140:143]
    v_perm_b32 v52, v105, v104, s66
    v_cvt_pk_bf16_f32 v247, v242, v243
    v_perm_b32 v53, v107, v106, s66
    v_mfma_f32_16x16x32_bf16 a[136:139], v[56:59], v[8:11], a[136:139]
    v_perm_b32 v54, v109, v108, s66
    v_perm_b32 v55, v111, v110, s66
    v_cndmask_b32_dpp v112, v193, v195, vcc row_ror:8 row_mask:0xf bank_mask:0xf
    v_mfma_f32_16x16x32_bf16 a[120:123], v[56:59], v[4:7], a[120:123]
    v_cndmask_b32_dpp v113, v197, v199, vcc row_ror:8 row_mask:0xf bank_mask:0xf
    v_cndmask_b32_dpp v114, v201, v203, vcc row_ror:8 row_mask:0xf bank_mask:0xf
    v_cndmask_b32_dpp v115, v205, v207, vcc row_ror:8 row_mask:0xf bank_mask:0xf
    v_mfma_f32_16x16x32_bf16 a[124:127], v[60:63], v[4:7], a[124:127]
    v_accvgpr_read_b32 v236, a50
    v_cndmask_b32_dpp v116, v209, v211, vcc row_ror:8 row_mask:0xf bank_mask:0xf
    v_mfma_f32_16x16x32_bf16 a[108:111], v[60:63], v[0:3], a[108:111]
    s_add_u32 s71, s58, 10
    v_cndmask_b32_dpp v117, v213, v215, vcc row_ror:8 row_mask:0xf bank_mask:0xf
    v_cndmask_b32_dpp v118, v217, v219, vcc row_ror:8 row_mask:0xf bank_mask:0xf
    v_mfma_f32_16x16x32_bf16 a[104:107], v[56:59], v[0:3], a[104:107]
    s_waitcnt lgkmcnt(0)
    buffer_store_dwordx4 v[244:247], v231, s[36:39], s59 offen offset:2048 sc1
    v_cndmask_b32_dpp v119, v221, v223, vcc row_ror:8 row_mask:0xf bank_mask:0xf
    v_mfma_f32_16x16x32_bf16 a[96:99], v[48:51], v[24:27], a[96:99]
    ds_write_b128 v229, v[244:247] offset:0
    v_perm_b32 v56, v113, v112, s65
    v_mfma_f32_16x16x32_bf16 a[100:103], v[52:55], v[24:27], a[100:103]
    buffer_load_dwordx4 v[96:99], v252, s[40:43], s62 offen offset:2176
    v_mfma_f32_16x16x32_bf16 a[116:119], v[52:55], v[28:31], a[116:119]
    s_and_b32 s71, s71, 15
    v_accvgpr_read_b32 v237, a54
    v_perm_b32 v57, v115, v114, s65
    v_mfma_f32_16x16x32_bf16 a[112:115], v[48:51], v[28:31], a[112:115]
    s_mul_i32 s71, s71, 6144
    v_perm_b32 v58, v117, v116, s65
    v_perm_b32 v59, v119, v118, s65
    v_mfma_f32_16x16x32_bf16 a[128:131], v[48:51], v[32:35], a[128:131]
    s_not_b64 vcc, vcc
    v_perm_b32 v60, v113, v112, s66
    v_cvt_pk_bf16_f32 v248, v236, v237
    v_mfma_f32_16x16x32_bf16 a[132:135], v[52:55], v[32:35], a[132:135]
    buffer_load_dwordx4 v[100:103], v252, s[40:43], s62 offen offset:3200
    v_mfma_f32_16x16x32_bf16 a[148:151], v[52:55], v[36:39], a[148:151]
    v_perm_b32 v61, v115, v114, s66
    v_perm_b32 v62, v117, v116, s66
    v_mfma_f32_16x16x32_bf16 a[144:147], v[48:51], v[36:39], a[144:147]
    v_perm_b32 v63, v119, v118, s66
    v_add_u32 v224, s71, v254
    v_mfma_f32_16x16x32_bf16 a[160:163], v[48:51], v[40:43], a[160:163]
    ds_read_b128 v[0:3], v224 offset:0
    v_accvgpr_read_b32 v238, a58
    v_mfma_f32_16x16x32_bf16 a[164:167], v[52:55], v[40:43], a[164:167]
    ds_read_b128 v[4:7], v224 offset:1024
    v_accvgpr_read_b32 v239, a62
    v_mfma_f32_16x16x32_bf16 a[180:183], v[52:55], v[44:47], a[180:183]
    s_waitcnt vmcnt(19)
    ds_read_b128 v[8:11], v224 offset:2048
    v_cndmask_b32_dpp v104, v178, v176, vcc row_ror:8 row_mask:0xf bank_mask:0xf
    v_mfma_f32_16x16x32_bf16 a[176:179], v[48:51], v[44:47], a[176:179]
    ds_read_b128 v[12:15], v224 offset:3072
    v_cndmask_b32_dpp v105, v182, v180, vcc row_ror:8 row_mask:0xf bank_mask:0xf
    v_mfma_f32_16x16x32_bf16 a[184:187], v[56:59], v[44:47], a[184:187]
    ds_read_b128 v[16:19], v224 offset:4096
    v_cndmask_b32_dpp v106, v186, v184, vcc row_ror:8 row_mask:0xf bank_mask:0xf
    v_mfma_f32_16x16x32_bf16 a[188:191], v[60:63], v[44:47], a[188:191]
    ds_read_b128 v[20:23], v224 offset:5120
    v_cndmask_b32_dpp v107, v190, v188, vcc row_ror:8 row_mask:0xf bank_mask:0xf
    v_mfma_f32_16x16x32_bf16 a[172:175], v[60:63], v[40:43], a[172:175]
    v_cvt_pk_bf16_f32 v249, v238, v239
    v_cndmask_b32_dpp v108, v130, v128, vcc row_ror:8 row_mask:0xf bank_mask:0xf
    v_cndmask_b32_dpp v109, v134, v132, vcc row_ror:8 row_mask:0xf bank_mask:0xf
    v_mfma_f32_16x16x32_bf16 a[168:171], v[56:59], v[40:43], a[168:171]
    v_cndmask_b32_dpp v110, v138, v136, vcc row_ror:8 row_mask:0xf bank_mask:0xf
    v_accvgpr_read_b32 v240, a51
    v_cndmask_b32_dpp v111, v142, v140, vcc row_ror:8 row_mask:0xf bank_mask:0xf
    v_mfma_f32_16x16x32_bf16 a[152:155], v[56:59], v[36:39], a[152:155]
    v_perm_b32 v48, v105, v104, s65
    v_perm_b32 v49, v107, v106, s65
    v_accvgpr_read_b32 v241, a55
    v_mfma_f32_16x16x32_bf16 a[156:159], v[60:63], v[36:39], a[156:159]
    v_perm_b32 v50, v109, v108, s65
    v_perm_b32 v51, v111, v110, s65
    v_mfma_f32_16x16x32_bf16 a[140:143], v[60:63], v[32:35], a[140:143]
    v_perm_b32 v52, v105, v104, s66
    v_cvt_pk_bf16_f32 v250, v240, v241
    v_mfma_f32_16x16x32_bf16 a[136:139], v[56:59], v[32:35], a[136:139]
    v_perm_b32 v53, v107, v106, s66
    v_perm_b32 v54, v109, v108, s66
    v_mfma_f32_16x16x32_bf16 a[120:123], v[56:59], v[28:31], a[120:123]
    v_perm_b32 v55, v111, v110, s66
    v_accvgpr_read_b32 v242, a59
    v_mfma_f32_16x16x32_bf16 a[124:127], v[60:63], v[28:31], a[124:127]
    v_cndmask_b32_dpp v112, v179, v177, vcc row_ror:8 row_mask:0xf bank_mask:0xf
    v_cndmask_b32_dpp v113, v183, v181, vcc row_ror:8 row_mask:0xf bank_mask:0xf
    v_mfma_f32_16x16x32_bf16 a[108:111], v[60:63], v[24:27], a[108:111]
    s_add_u32 s71, s58, 11
    v_cndmask_b32_dpp v114, v187, v185, vcc row_ror:8 row_mask:0xf bank_mask:0xf
    v_cndmask_b32_dpp v115, v191, v189, vcc row_ror:8 row_mask:0xf bank_mask:0xf
    v_mfma_f32_16x16x32_bf16 a[104:107], v[56:59], v[24:27], a[104:107]
    s_waitcnt lgkmcnt(0)
    v_cndmask_b32_dpp v116, v131, v129, vcc row_ror:8 row_mask:0xf bank_mask:0xf
    v_accvgpr_read_b32 v243, a63
    v_mfma_f32_16x16x32_bf16 a[96:99], v[48:51], v[0:3], a[96:99]
    s_and_b32 s71, s71, 15
    v_cndmask_b32_dpp v117, v135, v133, vcc row_ror:8 row_mask:0xf bank_mask:0xf
    v_cndmask_b32_dpp v118, v139, v137, vcc row_ror:8 row_mask:0xf bank_mask:0xf
    v_mfma_f32_16x16x32_bf16 a[100:103], v[52:55], v[0:3], a[100:103]
    s_mul_i32 s71, s71, 6144
    v_cndmask_b32_dpp v119, v143, v141, vcc row_ror:8 row_mask:0xf bank_mask:0xf
    v_perm_b32 v56, v113, v112, s65
    v_mfma_f32_16x16x32_bf16 a[116:119], v[52:55], v[4:7], a[116:119]
    s_not_b64 vcc, vcc
    v_perm_b32 v57, v115, v114, s65
    v_cvt_pk_bf16_f32 v251, v242, v243
    v_mfma_f32_16x16x32_bf16 a[112:115], v[48:51], v[4:7], a[112:115]
    v_perm_b32 v58, v117, v116, s65
    v_perm_b32 v59, v119, v118, s65
    v_mfma_f32_16x16x32_bf16 a[128:131], v[48:51], v[8:11], a[128:131]
    v_perm_b32 v60, v113, v112, s66
    v_perm_b32 v61, v115, v114, s66
    v_mfma_f32_16x16x32_bf16 a[132:135], v[52:55], v[8:11], a[132:135]
    v_perm_b32 v62, v117, v116, s66
    v_perm_b32 v63, v119, v118, s66
    v_mfma_f32_16x16x32_bf16 a[148:151], v[52:55], v[12:15], a[148:151]
    buffer_store_dwordx4 v[248:251], v231, s[36:39], s59 offen offset:3072 sc1
    v_add_u32 v224, s71, v254
    v_mfma_f32_16x16x32_bf16 a[144:147], v[48:51], v[12:15], a[144:147]
    ds_write_b128 v229, v[248:251] offset:1024
    v_accvgpr_read_b32 v236, a64
    v_mfma_f32_16x16x32_bf16 a[160:163], v[48:51], v[16:19], a[160:163]
    ds_read_b128 v[24:27], v224 offset:0
    v_accvgpr_read_b32 v237, a68
    v_mfma_f32_16x16x32_bf16 a[164:167], v[52:55], v[16:19], a[164:167]
    ds_read_b128 v[28:31], v224 offset:1024
    v_cndmask_b32_dpp v104, v176, v178, vcc row_ror:8 row_mask:0xf bank_mask:0xf
    v_mfma_f32_16x16x32_bf16 a[180:183], v[52:55], v[20:23], a[180:183]
    ds_read_b128 v[32:35], v224 offset:2048
    v_cndmask_b32_dpp v105, v180, v182, vcc row_ror:8 row_mask:0xf bank_mask:0xf
    v_mfma_f32_16x16x32_bf16 a[176:179], v[48:51], v[20:23], a[176:179]
    ds_read_b128 v[36:39], v224 offset:3072
    v_cndmask_b32_dpp v106, v184, v186, vcc row_ror:8 row_mask:0xf bank_mask:0xf
    v_mfma_f32_16x16x32_bf16 a[184:187], v[56:59], v[20:23], a[184:187]
    ds_read_b128 v[40:43], v224 offset:4096
    v_cndmask_b32_dpp v107, v188, v190, vcc row_ror:8 row_mask:0xf bank_mask:0xf
    v_mfma_f32_16x16x32_bf16 a[188:191], v[60:63], v[20:23], a[188:191]
    ds_read_b128 v[44:47], v224 offset:5120
    v_cvt_pk_bf16_f32 v64, v236, v237
    v_mfma_f32_16x16x32_bf16 a[172:175], v[60:63], v[16:19], a[172:175]
    v_cndmask_b32_dpp v108, v128, v130, vcc row_ror:8 row_mask:0xf bank_mask:0xf
    v_cndmask_b32_dpp v109, v132, v134, vcc row_ror:8 row_mask:0xf bank_mask:0xf
    v_mfma_f32_16x16x32_bf16 a[168:171], v[56:59], v[16:19], a[168:171]
    v_cndmask_b32_dpp v110, v136, v138, vcc row_ror:8 row_mask:0xf bank_mask:0xf
    v_accvgpr_read_b32 v238, a72
    v_mfma_f32_16x16x32_bf16 a[152:155], v[56:59], v[12:15], a[152:155]
    v_cndmask_b32_dpp v111, v140, v142, vcc row_ror:8 row_mask:0xf bank_mask:0xf
    v_perm_b32 v48, v105, v104, s65
    v_mfma_f32_16x16x32_bf16 a[156:159], v[60:63], v[12:15], a[156:159]
    v_perm_b32 v49, v107, v106, s65
    v_accvgpr_read_b32 v239, a76
    v_mfma_f32_16x16x32_bf16 a[140:143], v[60:63], v[8:11], a[140:143]
    v_perm_b32 v50, v109, v108, s65
    v_perm_b32 v51, v111, v110, s65
    v_mfma_f32_16x16x32_bf16 a[136:139], v[56:59], v[8:11], a[136:139]
    v_perm_b32 v52, v105, v104, s66
    v_cvt_pk_bf16_f32 v65, v238, v239
    v_mfma_f32_16x16x32_bf16 a[120:123], v[56:59], v[4:7], a[120:123]
    v_perm_b32 v53, v107, v106, s66
    v_perm_b32 v54, v109, v108, s66
    v_mfma_f32_16x16x32_bf16 a[124:127], v[60:63], v[4:7], a[124:127]
    v_perm_b32 v55, v111, v110, s66
    v_accvgpr_read_b32 v240, a65
    v_mfma_f32_16x16x32_bf16 a[108:111], v[60:63], v[0:3], a[108:111]
    s_add_u32 s71, s58, 12
    v_cndmask_b32_dpp v112, v177, v179, vcc row_ror:8 row_mask:0xf bank_mask:0xf
    v_cndmask_b32_dpp v113, v181, v183, vcc row_ror:8 row_mask:0xf bank_mask:0xf
    v_mfma_f32_16x16x32_bf16 a[104:107], v[56:59], v[0:3], a[104:107]
    s_waitcnt lgkmcnt(0)
    v_cndmask_b32_dpp v114, v185, v187, vcc row_ror:8 row_mask:0xf bank_mask:0xf
    v_cndmask_b32_dpp v115, v189, v191, vcc row_ror:8 row_mask:0xf bank_mask:0xf
    v_mfma_f32_16x16x32_bf16 a[96:99], v[48:51], v[24:27], a[96:99]
    s_and_b32 s71, s71, 15
    v_cndmask_b32_dpp v116, v129, v131, vcc row_ror:8 row_mask:0xf bank_mask:0xf
    v_accvgpr_read_b32 v241, a69
    v_mfma_f32_16x16x32_bf16 a[100:103], v[52:55], v[24:27], a[100:103]
    s_mul_i32 s71, s71, 6144
    v_cndmask_b32_dpp v117, v133, v135, vcc row_ror:8 row_mask:0xf bank_mask:0xf
    v_cndmask_b32_dpp v118, v137, v139, vcc row_ror:8 row_mask:0xf bank_mask:0xf
    v_mfma_f32_16x16x32_bf16 a[116:119], v[52:55], v[28:31], a[116:119]
    v_cndmask_b32_dpp v119, v141, v143, vcc row_ror:8 row_mask:0xf bank_mask:0xf
    v_perm_b32 v56, v113, v112, s65
    v_mfma_f32_16x16x32_bf16 a[112:115], v[48:51], v[28:31], a[112:115]
    s_not_b64 vcc, vcc
    v_perm_b32 v57, v115, v114, s65
    v_cvt_pk_bf16_f32 v66, v240, v241
    v_mfma_f32_16x16x32_bf16 a[128:131], v[48:51], v[32:35], a[128:131]
    v_perm_b32 v58, v117, v116, s65
    v_perm_b32 v59, v119, v118, s65
    v_mfma_f32_16x16x32_bf16 a[132:135], v[52:55], v[32:35], a[132:135]
    v_perm_b32 v60, v113, v112, s66
    v_perm_b32 v61, v115, v114, s66
    v_mfma_f32_16x16x32_bf16 a[148:151], v[52:55], v[36:39], a[148:151]
    v_accvgpr_read_b32 v242, a73
    v_perm_b32 v62, v117, v116, s66
    v_mfma_f32_16x16x32_bf16 a[144:147], v[48:51], v[36:39], a[144:147]
    v_perm_b32 v63, v119, v118, s66
    v_add_u32 v224, s71, v254
    v_mfma_f32_16x16x32_bf16 a[160:163], v[48:51], v[40:43], a[160:163]
    ds_read_b128 v[0:3], v224 offset:0
    v_accvgpr_read_b32 v243, a77
    v_mfma_f32_16x16x32_bf16 a[164:167], v[52:55], v[40:43], a[164:167]
    ds_read_b128 v[4:7], v224 offset:1024
    v_cvt_pk_bf16_f32 v67, v242, v243
    v_mfma_f32_16x16x32_bf16 a[180:183], v[52:55], v[44:47], a[180:183]
    s_waitcnt vmcnt(11)
    ds_read_b128 v[8:11], v224 offset:2048
    v_cndmask_b32_dpp v104, v146, v144, vcc row_ror:8 row_mask:0xf bank_mask:0xf
    v_mfma_f32_16x16x32_bf16 a[176:179], v[48:51], v[44:47], a[176:179]
    ds_read_b128 v[12:15], v224 offset:3072
    v_cndmask_b32_dpp v105, v150, v148, vcc row_ror:8 row_mask:0xf bank_mask:0xf
    v_mfma_f32_16x16x32_bf16 a[184:187], v[56:59], v[44:47], a[184:187]
    ds_read_b128 v[16:19], v224 offset:4096
    v_cndmask_b32_dpp v106, v154, v152, vcc row_ror:8 row_mask:0xf bank_mask:0xf
    v_mfma_f32_16x16x32_bf16 a[188:191], v[60:63], v[44:47], a[188:191]
    ds_read_b128 v[20:23], v224 offset:5120
    v_cndmask_b32_dpp v107, v158, v156, vcc row_ror:8 row_mask:0xf bank_mask:0xf
    v_mfma_f32_16x16x32_bf16 a[172:175], v[60:63], v[40:43], a[172:175]
    buffer_store_dwordx4 v[64:67], v231, s[36:39], s60 offen offset:0 sc1
    v_cndmask_b32_dpp v108, v162, v160, vcc row_ror:8 row_mask:0xf bank_mask:0xf
    v_mfma_f32_16x16x32_bf16 a[168:171], v[56:59], v[40:43], a[168:171]
    ds_write_b128 v229, v[64:67] offset:2048
    v_cndmask_b32_dpp v109, v166, v164, vcc row_ror:8 row_mask:0xf bank_mask:0xf
    v_mfma_f32_16x16x32_bf16 a[152:155], v[56:59], v[36:39], a[152:155]
    v_cndmask_b32_dpp v110, v170, v168, vcc row_ror:8 row_mask:0xf bank_mask:0xf
    v_accvgpr_read_b32 v236, a66
    v_cndmask_b32_dpp v111, v174, v172, vcc row_ror:8 row_mask:0xf bank_mask:0xf
    v_mfma_f32_16x16x32_bf16 a[156:159], v[60:63], v[36:39], a[156:159]
    v_perm_b32 v48, v105, v104, s65
    v_perm_b32 v49, v107, v106, s65
    v_accvgpr_read_b32 v237, a70
    v_mfma_f32_16x16x32_bf16 a[140:143], v[60:63], v[32:35], a[140:143]
    v_perm_b32 v50, v109, v108, s65
    v_perm_b32 v51, v111, v110, s65
    v_mfma_f32_16x16x32_bf16 a[136:139], v[56:59], v[32:35], a[136:139]
    v_perm_b32 v52, v105, v104, s66
    v_cvt_pk_bf16_f32 v68, v236, v237
    v_mfma_f32_16x16x32_bf16 a[120:123], v[56:59], v[28:31], a[120:123]
    v_perm_b32 v53, v107, v106, s66
    v_perm_b32 v54, v109, v108, s66
    v_mfma_f32_16x16x32_bf16 a[124:127], v[60:63], v[28:31], a[124:127]
    v_perm_b32 v55, v111, v110, s66
    v_accvgpr_read_b32 v238, a74
    v_mfma_f32_16x16x32_bf16 a[108:111], v[60:63], v[24:27], a[108:111]
    s_add_u32 s71, s58, 13
    v_cndmask_b32_dpp v112, v147, v145, vcc row_ror:8 row_mask:0xf bank_mask:0xf
    v_cndmask_b32_dpp v113, v151, v149, vcc row_ror:8 row_mask:0xf bank_mask:0xf
    v_mfma_f32_16x16x32_bf16 a[104:107], v[56:59], v[24:27], a[104:107]
    s_waitcnt lgkmcnt(1)
    v_cndmask_b32_dpp v114, v155, v153, vcc row_ror:8 row_mask:0xf bank_mask:0xf
    v_cndmask_b32_dpp v115, v159, v157, vcc row_ror:8 row_mask:0xf bank_mask:0xf
    v_mfma_f32_16x16x32_bf16 a[96:99], v[48:51], v[0:3], a[96:99]
    s_and_b32 s71, s71, 15
    v_cndmask_b32_dpp v116, v163, v161, vcc row_ror:8 row_mask:0xf bank_mask:0xf
    v_accvgpr_read_b32 v239, a78
    v_mfma_f32_16x16x32_bf16 a[100:103], v[52:55], v[0:3], a[100:103]
    s_mul_i32 s71, s71, 6144
    v_cndmask_b32_dpp v117, v167, v165, vcc row_ror:8 row_mask:0xf bank_mask:0xf
    v_cndmask_b32_dpp v118, v171, v169, vcc row_ror:8 row_mask:0xf bank_mask:0xf
    v_mfma_f32_16x16x32_bf16 a[116:119], v[52:55], v[4:7], a[116:119]
    v_cndmask_b32_dpp v119, v175, v173, vcc row_ror:8 row_mask:0xf bank_mask:0xf
    v_perm_b32 v56, v113, v112, s65
    v_mfma_f32_16x16x32_bf16 a[112:115], v[48:51], v[4:7], a[112:115]
    s_not_b64 vcc, vcc
    v_perm_b32 v57, v115, v114, s65
    v_cvt_pk_bf16_f32 v69, v238, v239
    v_mfma_f32_16x16x32_bf16 a[128:131], v[48:51], v[8:11], a[128:131]
    v_perm_b32 v58, v117, v116, s65
    v_perm_b32 v59, v119, v118, s65
    v_mfma_f32_16x16x32_bf16 a[132:135], v[52:55], v[8:11], a[132:135]
    v_perm_b32 v60, v113, v112, s66
    v_perm_b32 v61, v115, v114, s66
    v_mfma_f32_16x16x32_bf16 a[148:151], v[52:55], v[12:15], a[148:151]
    v_accvgpr_read_b32 v240, a67
    v_perm_b32 v62, v117, v116, s66
    v_mfma_f32_16x16x32_bf16 a[144:147], v[48:51], v[12:15], a[144:147]
    v_perm_b32 v63, v119, v118, s66
    v_add_u32 v224, s71, v254
    v_mfma_f32_16x16x32_bf16 a[160:163], v[48:51], v[16:19], a[160:163]
    ds_read_b128 v[24:27], v224 offset:0
    v_accvgpr_read_b32 v241, a71
    v_mfma_f32_16x16x32_bf16 a[164:167], v[52:55], v[16:19], a[164:167]
    ds_read_b128 v[28:31], v224 offset:1024
    v_cvt_pk_bf16_f32 v70, v240, v241
    v_mfma_f32_16x16x32_bf16 a[180:183], v[52:55], v[20:23], a[180:183]
    ds_read_b128 v[32:35], v224 offset:2048
    v_cndmask_b32_dpp v104, v144, v146, vcc row_ror:8 row_mask:0xf bank_mask:0xf
    v_mfma_f32_16x16x32_bf16 a[176:179], v[48:51], v[20:23], a[176:179]
    ds_read_b128 v[36:39], v224 offset:3072
    v_cndmask_b32_dpp v105, v148, v150, vcc row_ror:8 row_mask:0xf bank_mask:0xf
    v_mfma_f32_16x16x32_bf16 a[184:187], v[56:59], v[20:23], a[184:187]
    ds_read_b128 v[40:43], v224 offset:4096
    v_cndmask_b32_dpp v106, v152, v154, vcc row_ror:8 row_mask:0xf bank_mask:0xf
    v_mfma_f32_16x16x32_bf16 a[188:191], v[60:63], v[20:23], a[188:191]
    ds_read_b128 v[44:47], v224 offset:5120
    v_cndmask_b32_dpp v107, v156, v158, vcc row_ror:8 row_mask:0xf bank_mask:0xf
    v_mfma_f32_16x16x32_bf16 a[172:175], v[60:63], v[16:19], a[172:175]
    v_accvgpr_read_b32 v242, a75
    v_cndmask_b32_dpp v108, v160, v162, vcc row_ror:8 row_mask:0xf bank_mask:0xf
    v_cndmask_b32_dpp v109, v164, v166, vcc row_ror:8 row_mask:0xf bank_mask:0xf
    v_mfma_f32_16x16x32_bf16 a[168:171], v[56:59], v[16:19], a[168:171]
    v_cndmask_b32_dpp v110, v168, v170, vcc row_ror:8 row_mask:0xf bank_mask:0xf
    v_accvgpr_read_b32 v243, a79
    v_cndmask_b32_dpp v111, v172, v174, vcc row_ror:8 row_mask:0xf bank_mask:0xf
    v_mfma_f32_16x16x32_bf16 a[152:155], v[56:59], v[12:15], a[152:155]
    v_perm_b32 v48, v105, v104, s65
    v_perm_b32 v49, v107, v106, s65
    v_cvt_pk_bf16_f32 v71, v242, v243
    v_mfma_f32_16x16x32_bf16 a[156:159], v[60:63], v[12:15], a[156:159]
    v_perm_b32 v50, v109, v108, s65
    v_perm_b32 v51, v111, v110, s65
    v_mfma_f32_16x16x32_bf16 a[140:143], v[60:63], v[8:11], a[140:143]
    v_perm_b32 v52, v105, v104, s66
    v_perm_b32 v53, v107, v106, s66
    v_mfma_f32_16x16x32_bf16 a[136:139], v[56:59], v[8:11], a[136:139]
    v_perm_b32 v54, v109, v108, s66
    v_perm_b32 v55, v111, v110, s66
    v_mfma_f32_16x16x32_bf16 a[120:123], v[56:59], v[4:7], a[120:123]
    buffer_store_dwordx4 v[68:71], v231, s[36:39], s60 offen offset:1024 sc1
    v_accvgpr_read_b32 v236, a80
    v_mfma_f32_16x16x32_bf16 a[124:127], v[60:63], v[4:7], a[124:127]
    ds_write_b128 v229, v[68:71] offset:3072
    v_cndmask_b32_dpp v112, v145, v147, vcc row_ror:8 row_mask:0xf bank_mask:0xf
    v_mfma_f32_16x16x32_bf16 a[108:111], v[60:63], v[0:3], a[108:111]
    s_add_u32 s71, s58, 14
    v_cndmask_b32_dpp v113, v149, v151, vcc row_ror:8 row_mask:0xf bank_mask:0xf
    v_cndmask_b32_dpp v114, v153, v155, vcc row_ror:8 row_mask:0xf bank_mask:0xf
    v_mfma_f32_16x16x32_bf16 a[104:107], v[56:59], v[0:3], a[104:107]
    s_waitcnt lgkmcnt(1)
    v_cndmask_b32_dpp v115, v157, v159, vcc row_ror:8 row_mask:0xf bank_mask:0xf
    v_cndmask_b32_dpp v116, v161, v163, vcc row_ror:8 row_mask:0xf bank_mask:0xf
    v_mfma_f32_16x16x32_bf16 a[96:99], v[48:51], v[24:27], a[96:99]
    s_and_b32 s71, s71, 15
    v_accvgpr_read_b32 v237, a84
    v_cndmask_b32_dpp v117, v165, v167, vcc row_ror:8 row_mask:0xf bank_mask:0xf
    v_mfma_f32_16x16x32_bf16 a[100:103], v[52:55], v[24:27], a[100:103]
    s_mul_i32 s71, s71, 6144
    v_cndmask_b32_dpp v118, v169, v171, vcc row_ror:8 row_mask:0xf bank_mask:0xf
    v_cndmask_b32_dpp v119, v173, v175, vcc row_ror:8 row_mask:0xf bank_mask:0xf
    v_mfma_f32_16x16x32_bf16 a[116:119], v[52:55], v[28:31], a[116:119]
    s_not_b64 vcc, vcc
    v_perm_b32 v56, v113, v112, s65
    v_perm_b32 v57, v115, v114, s65
    v_mfma_f32_16x16x32_bf16 a[112:115], v[48:51], v[28:31], a[112:115]
    v_cvt_pk_bf16_f32 v244, v236, v237
    v_perm_b32 v58, v117, v116, s65
    v_mfma_f32_16x16x32_bf16 a[128:131], v[48:51], v[32:35], a[128:131]
    v_perm_b32 v59, v119, v118, s65
    v_perm_b32 v60, v113, v112, s66
    v_mfma_f32_16x16x32_bf16 a[132:135], v[52:55], v[32:35], a[132:135]
    v_perm_b32 v61, v115, v114, s66
    v_accvgpr_read_b32 v238, a88
    v_mfma_f32_16x16x32_bf16 a[148:151], v[52:55], v[36:39], a[148:151]
    v_perm_b32 v62, v117, v116, s66
    v_perm_b32 v63, v119, v118, s66
    v_mfma_f32_16x16x32_bf16 a[144:147], v[48:51], v[36:39], a[144:147]
    v_add_u32 v224, s71, v254
    v_accvgpr_read_b32 v239, a92
    v_mfma_f32_16x16x32_bf16 a[160:163], v[48:51], v[40:43], a[160:163]
    ds_read_b128 v[0:3], v224 offset:0
    v_cvt_pk_bf16_f32 v245, v238, v239
    v_mfma_f32_16x16x32_bf16 a[164:167], v[52:55], v[40:43], a[164:167]
    s_waitcnt vmcnt(3)
    ds_read_b128 v[4:7], v224 offset:1024
    v_cndmask_b32_dpp v104, v74, v72, vcc row_ror:8 row_mask:0xf bank_mask:0xf
    v_mfma_f32_16x16x32_bf16 a[180:183], v[52:55], v[44:47], a[180:183]
    ds_read_b128 v[8:11], v224 offset:2048
    v_cndmask_b32_dpp v105, v78, v76, vcc row_ror:8 row_mask:0xf bank_mask:0xf
    v_mfma_f32_16x16x32_bf16 a[176:179], v[48:51], v[44:47], a[176:179]
    ds_read_b128 v[12:15], v224 offset:3072
    v_cndmask_b32_dpp v106, v82, v80, vcc row_ror:8 row_mask:0xf bank_mask:0xf
    v_mfma_f32_16x16x32_bf16 a[184:187], v[56:59], v[44:47], a[184:187]
    ds_read_b128 v[16:19], v224 offset:4096
    v_cndmask_b32_dpp v107, v86, v84, vcc row_ror:8 row_mask:0xf bank_mask:0xf
    v_mfma_f32_16x16x32_bf16 a[188:191], v[60:63], v[44:47], a[188:191]
    ds_read_b128 v[20:23], v224 offset:5120
    v_accvgpr_read_b32 v240, a81
    v_mfma_f32_16x16x32_bf16 a[172:175], v[60:63], v[40:43], a[172:175]
    v_cndmask_b32_dpp v108, v90, v88, vcc row_ror:8 row_mask:0xf bank_mask:0xf
    v_cndmask_b32_dpp v109, v94, v92, vcc row_ror:8 row_mask:0xf bank_mask:0xf
    v_cndmask_b32_dpp v110, v98, v96, vcc row_ror:8 row_mask:0xf bank_mask:0xf
    v_mfma_f32_16x16x32_bf16 a[168:171], v[56:59], v[40:43], a[168:171]
    v_accvgpr_read_b32 v241, a85
    v_cndmask_b32_dpp v111, v102, v100, vcc row_ror:8 row_mask:0xf bank_mask:0xf
    v_perm_b32 v48, v105, v104, s65
    v_mfma_f32_16x16x32_bf16 a[152:155], v[56:59], v[36:39], a[152:155]
    v_perm_b32 v49, v107, v106, s65
    v_cvt_pk_bf16_f32 v246, v240, v241
    v_mfma_f32_16x16x32_bf16 a[156:159], v[60:63], v[36:39], a[156:159]
    v_perm_b32 v50, v109, v108, s65
    v_perm_b32 v51, v111, v110, s65
    v_mfma_f32_16x16x32_bf16 a[140:143], v[60:63], v[32:35], a[140:143]
    v_perm_b32 v52, v105, v104, s66
    v_accvgpr_read_b32 v242, a89
    v_mfma_f32_16x16x32_bf16 a[136:139], v[56:59], v[32:35], a[136:139]
    v_perm_b32 v53, v107, v106, s66
    v_perm_b32 v54, v109, v108, s66
    v_mfma_f32_16x16x32_bf16 a[120:123], v[56:59], v[28:31], a[120:123]
    v_perm_b32 v55, v111, v110, s66
    v_accvgpr_read_b32 v243, a93
    v_mfma_f32_16x16x32_bf16 a[124:127], v[60:63], v[28:31], a[124:127]
    v_cndmask_b32_dpp v112, v75, v73, vcc row_ror:8 row_mask:0xf bank_mask:0xf
    v_cndmask_b32_dpp v113, v79, v77, vcc row_ror:8 row_mask:0xf bank_mask:0xf
    v_mfma_f32_16x16x32_bf16 a[108:111], v[60:63], v[24:27], a[108:111]
    s_add_u32 s71, s58, 15
    v_cndmask_b32_dpp v114, v83, v81, vcc row_ror:8 row_mask:0xf bank_mask:0xf
    v_cndmask_b32_dpp v115, v87, v85, vcc row_ror:8 row_mask:0xf bank_mask:0xf
    v_mfma_f32_16x16x32_bf16 a[104:107], v[56:59], v[24:27], a[104:107]
    s_waitcnt lgkmcnt(0)
    v_cndmask_b32_dpp v116, v91, v89, vcc row_ror:8 row_mask:0xf bank_mask:0xf
    v_cvt_pk_bf16_f32 v247, v242, v243
    v_mfma_f32_16x16x32_bf16 a[96:99], v[48:51], v[0:3], a[96:99]
    s_and_b32 s71, s71, 15
    v_cndmask_b32_dpp v117, v95, v93, vcc row_ror:8 row_mask:0xf bank_mask:0xf
    v_cndmask_b32_dpp v118, v99, v97, vcc row_ror:8 row_mask:0xf bank_mask:0xf
    v_mfma_f32_16x16x32_bf16 a[100:103], v[52:55], v[0:3], a[100:103]
    s_mul_i32 s71, s71, 6144
    v_cndmask_b32_dpp v119, v103, v101, vcc row_ror:8 row_mask:0xf bank_mask:0xf
    v_perm_b32 v56, v113, v112, s65
    v_mfma_f32_16x16x32_bf16 a[116:119], v[52:55], v[4:7], a[116:119]
    s_not_b64 vcc, vcc
    v_perm_b32 v57, v115, v114, s65
    v_perm_b32 v58, v117, v116, s65
    v_mfma_f32_16x16x32_bf16 a[112:115], v[48:51], v[4:7], a[112:115]
    v_perm_b32 v59, v119, v118, s65
    v_perm_b32 v60, v113, v112, s66
    v_mfma_f32_16x16x32_bf16 a[128:131], v[48:51], v[8:11], a[128:131]
    buffer_store_dwordx4 v[244:247], v231, s[36:39], s60 offen offset:2048 sc1
    v_perm_b32 v61, v115, v114, s66
    v_mfma_f32_16x16x32_bf16 a[132:135], v[52:55], v[8:11], a[132:135]
    ds_write_b128 v229, v[244:247] offset:4096
    v_accvgpr_read_b32 v236, a82
    v_mfma_f32_16x16x32_bf16 a[148:151], v[52:55], v[12:15], a[148:151]
    v_perm_b32 v62, v117, v116, s66
    v_perm_b32 v63, v119, v118, s66
    v_mfma_f32_16x16x32_bf16 a[144:147], v[48:51], v[12:15], a[144:147]
    v_add_u32 v224, s71, v254
    v_accvgpr_read_b32 v237, a86
    v_mfma_f32_16x16x32_bf16 a[160:163], v[48:51], v[16:19], a[160:163]
    ds_read_b128 v[24:27], v224 offset:0
    v_cvt_pk_bf16_f32 v248, v236, v237
    v_mfma_f32_16x16x32_bf16 a[164:167], v[52:55], v[16:19], a[164:167]
    ds_read_b128 v[28:31], v224 offset:1024
    v_cndmask_b32_dpp v104, v72, v74, vcc row_ror:8 row_mask:0xf bank_mask:0xf
    v_mfma_f32_16x16x32_bf16 a[180:183], v[52:55], v[20:23], a[180:183]
    ds_read_b128 v[32:35], v224 offset:2048
    v_cndmask_b32_dpp v105, v76, v78, vcc row_ror:8 row_mask:0xf bank_mask:0xf
    v_mfma_f32_16x16x32_bf16 a[176:179], v[48:51], v[20:23], a[176:179]
    ds_read_b128 v[36:39], v224 offset:3072
    v_cndmask_b32_dpp v106, v80, v82, vcc row_ror:8 row_mask:0xf bank_mask:0xf
    v_mfma_f32_16x16x32_bf16 a[184:187], v[56:59], v[20:23], a[184:187]
    ds_read_b128 v[40:43], v224 offset:4096
    v_cndmask_b32_dpp v107, v84, v86, vcc row_ror:8 row_mask:0xf bank_mask:0xf
    v_mfma_f32_16x16x32_bf16 a[188:191], v[60:63], v[20:23], a[188:191]
    ds_read_b128 v[44:47], v224 offset:5120
    v_accvgpr_read_b32 v238, a90
    v_mfma_f32_16x16x32_bf16 a[172:175], v[60:63], v[16:19], a[172:175]
    v_cndmask_b32_dpp v108, v88, v90, vcc row_ror:8 row_mask:0xf bank_mask:0xf
    v_cndmask_b32_dpp v109, v92, v94, vcc row_ror:8 row_mask:0xf bank_mask:0xf
    v_mfma_f32_16x16x32_bf16 a[168:171], v[56:59], v[16:19], a[168:171]
    v_cndmask_b32_dpp v110, v96, v98, vcc row_ror:8 row_mask:0xf bank_mask:0xf
    v_accvgpr_read_b32 v239, a94
    v_mfma_f32_16x16x32_bf16 a[152:155], v[56:59], v[12:15], a[152:155]
    v_cndmask_b32_dpp v111, v100, v102, vcc row_ror:8 row_mask:0xf bank_mask:0xf
    v_perm_b32 v48, v105, v104, s65
    v_mfma_f32_16x16x32_bf16 a[156:159], v[60:63], v[12:15], a[156:159]
    v_perm_b32 v49, v107, v106, s65
    v_cvt_pk_bf16_f32 v249, v238, v239
    v_mfma_f32_16x16x32_bf16 a[140:143], v[60:63], v[8:11], a[140:143]
    v_perm_b32 v50, v109, v108, s65
    v_perm_b32 v51, v111, v110, s65
    v_mfma_f32_16x16x32_bf16 a[136:139], v[56:59], v[8:11], a[136:139]
    v_perm_b32 v52, v105, v104, s66
    v_accvgpr_read_b32 v240, a83
    v_mfma_f32_16x16x32_bf16 a[120:123], v[56:59], v[4:7], a[120:123]
    v_perm_b32 v53, v107, v106, s66
    v_perm_b32 v54, v109, v108, s66
    v_mfma_f32_16x16x32_bf16 a[124:127], v[60:63], v[4:7], a[124:127]
    v_perm_b32 v55, v111, v110, s66
    v_accvgpr_read_b32 v241, a87
    v_mfma_f32_16x16x32_bf16 a[108:111], v[60:63], v[0:3], a[108:111]
    v_cndmask_b32_dpp v112, v73, v75, vcc row_ror:8 row_mask:0xf bank_mask:0xf
    v_cndmask_b32_dpp v113, v77, v79, vcc row_ror:8 row_mask:0xf bank_mask:0xf
    v_mfma_f32_16x16x32_bf16 a[104:107], v[56:59], v[0:3], a[104:107]
    s_waitcnt lgkmcnt(0)
    v_cndmask_b32_dpp v114, v81, v83, vcc row_ror:8 row_mask:0xf bank_mask:0xf
    v_cndmask_b32_dpp v115, v85, v87, vcc row_ror:8 row_mask:0xf bank_mask:0xf
    v_mfma_f32_16x16x32_bf16 a[96:99], v[48:51], v[24:27], a[96:99]
    v_cvt_pk_bf16_f32 v250, v240, v241
    v_cndmask_b32_dpp v116, v89, v91, vcc row_ror:8 row_mask:0xf bank_mask:0xf
    v_mfma_f32_16x16x32_bf16 a[100:103], v[52:55], v[24:27], a[100:103]
    v_cndmask_b32_dpp v117, v93, v95, vcc row_ror:8 row_mask:0xf bank_mask:0xf
    v_cndmask_b32_dpp v118, v97, v99, vcc row_ror:8 row_mask:0xf bank_mask:0xf
    v_mfma_f32_16x16x32_bf16 a[116:119], v[52:55], v[28:31], a[116:119]
    v_accvgpr_read_b32 v242, a91
    v_cndmask_b32_dpp v119, v101, v103, vcc row_ror:8 row_mask:0xf bank_mask:0xf
    v_mfma_f32_16x16x32_bf16 a[112:115], v[48:51], v[28:31], a[112:115]
    v_perm_b32 v56, v113, v112, s65
    v_perm_b32 v57, v115, v114, s65
    v_mfma_f32_16x16x32_bf16 a[128:131], v[48:51], v[32:35], a[128:131]
    v_accvgpr_read_b32 v243, a95
    v_perm_b32 v58, v117, v116, s65
    v_mfma_f32_16x16x32_bf16 a[132:135], v[52:55], v[32:35], a[132:135]
    v_perm_b32 v59, v119, v118, s65
    v_perm_b32 v60, v113, v112, s66
    v_mfma_f32_16x16x32_bf16 a[148:151], v[52:55], v[36:39], a[148:151]
    v_cvt_pk_bf16_f32 v251, v242, v243
    v_perm_b32 v61, v115, v114, s66
    v_mfma_f32_16x16x32_bf16 a[144:147], v[48:51], v[36:39], a[144:147]
    v_perm_b32 v62, v117, v116, s66
    v_perm_b32 v63, v119, v118, s66
    v_mfma_f32_16x16x32_bf16 a[160:163], v[48:51], v[40:43], a[160:163]
    v_mfma_f32_16x16x32_bf16 a[164:167], v[52:55], v[40:43], a[164:167]
    v_mfma_f32_16x16x32_bf16 a[180:183], v[52:55], v[44:47], a[180:183]
    v_mfma_f32_16x16x32_bf16 a[176:179], v[48:51], v[44:47], a[176:179]
    buffer_store_dwordx4 v[248:251], v231, s[36:39], s60 offen offset:3072 sc1
    v_mfma_f32_16x16x32_bf16 a[184:187], v[56:59], v[44:47], a[184:187]
    ds_write_b128 v229, v[248:251] offset:5120
    v_mfma_f32_16x16x32_bf16 a[188:191], v[60:63], v[44:47], a[188:191]
    v_mfma_f32_16x16x32_bf16 a[172:175], v[60:63], v[40:43], a[172:175]
    v_mfma_f32_16x16x32_bf16 a[168:171], v[56:59], v[40:43], a[168:171]
    v_mfma_f32_16x16x32_bf16 a[152:155], v[56:59], v[36:39], a[152:155]
    v_mfma_f32_16x16x32_bf16 a[156:159], v[60:63], v[36:39], a[156:159]
    v_mfma_f32_16x16x32_bf16 a[140:143], v[60:63], v[32:35], a[140:143]
    v_mfma_f32_16x16x32_bf16 a[136:139], v[56:59], v[32:35], a[136:139]
    v_mfma_f32_16x16x32_bf16 a[120:123], v[56:59], v[28:31], a[120:123]
    v_mfma_f32_16x16x32_bf16 a[124:127], v[60:63], v[28:31], a[124:127]
    v_mfma_f32_16x16x32_bf16 a[108:111], v[60:63], v[24:27], a[108:111]
    v_mfma_f32_16x16x32_bf16 a[104:107], v[56:59], v[24:27], a[104:107]
    v_accvgpr_read_b32 v236, a96
    v_accvgpr_read_b32 v237, a100
    v_cvt_pk_bf16_f32 v64, v236, v237
    s_nop 4
    v_accvgpr_read_b32 v238, a104
    v_accvgpr_read_b32 v239, a108
    v_cvt_pk_bf16_f32 v65, v238, v239
    v_accvgpr_read_b32 v240, a97
    v_accvgpr_read_b32 v241, a101
    v_cvt_pk_bf16_f32 v66, v240, v241
    v_accvgpr_read_b32 v242, a105
    v_accvgpr_read_b32 v243, a109
    v_cvt_pk_bf16_f32 v67, v242, v243
    buffer_store_dwordx4 v[64:67], v230, s[36:39], s61 offen offset:0 sc1
    ds_write_b128 v228, v[64:67] offset:6144
    v_accvgpr_read_b32 v236, a98
    v_accvgpr_read_b32 v237, a102
    v_cvt_pk_bf16_f32 v68, v236, v237
    v_accvgpr_read_b32 v238, a106
    v_accvgpr_read_b32 v239, a110
    v_cvt_pk_bf16_f32 v69, v238, v239
    v_accvgpr_read_b32 v240, a99
    v_accvgpr_read_b32 v241, a103
    v_cvt_pk_bf16_f32 v70, v240, v241
    v_accvgpr_read_b32 v242, a107
    v_accvgpr_read_b32 v243, a111
    v_cvt_pk_bf16_f32 v71, v242, v243
    buffer_store_dwordx4 v[68:71], v230, s[36:39], s61 offen offset:1024 sc1
    ds_write_b128 v228, v[68:71] offset:7168
    v_accvgpr_read_b32 v236, a112
    v_accvgpr_read_b32 v237, a116
    v_cvt_pk_bf16_f32 v244, v236, v237
    v_accvgpr_read_b32 v238, a120
    v_accvgpr_read_b32 v239, a124
    v_cvt_pk_bf16_f32 v245, v238, v239
    v_accvgpr_read_b32 v240, a113
    v_accvgpr_read_b32 v241, a117
    v_cvt_pk_bf16_f32 v246, v240, v241
    v_accvgpr_read_b32 v242, a121
    v_accvgpr_read_b32 v243, a125
    v_cvt_pk_bf16_f32 v247, v242, v243
    buffer_store_dwordx4 v[244:247], v230, s[36:39], s61 offen offset:2048 sc1
    ds_write_b128 v228, v[244:247] offset:8192
    v_accvgpr_read_b32 v236, a114
    v_accvgpr_read_b32 v237, a118
    s_waitcnt lgkmcnt(3)
    v_cvt_pk_bf16_f32 v248, v236, v237
    v_accvgpr_read_b32 v238, a122
    v_accvgpr_read_b32 v239, a126
    v_cvt_pk_bf16_f32 v249, v238, v239
    v_accvgpr_read_b32 v240, a115
    v_accvgpr_read_b32 v241, a119
    v_cvt_pk_bf16_f32 v250, v240, v241
    v_accvgpr_read_b32 v242, a123
    v_accvgpr_read_b32 v243, a127
    v_cvt_pk_bf16_f32 v251, v242, v243
    buffer_store_dwordx4 v[248:251], v230, s[36:39], s61 offen offset:3072 sc1
    ds_write_b128 v228, v[248:251] offset:9216
    v_accvgpr_read_b32 v236, a128
    v_accvgpr_read_b32 v237, a132
    s_waitcnt lgkmcnt(3)
    v_cvt_pk_bf16_f32 v64, v236, v237
    v_accvgpr_read_b32 v238, a136
    v_accvgpr_read_b32 v239, a140
    v_cvt_pk_bf16_f32 v65, v238, v239
    v_accvgpr_read_b32 v240, a129
    v_accvgpr_read_b32 v241, a133
    v_cvt_pk_bf16_f32 v66, v240, v241
    v_accvgpr_read_b32 v242, a137
    v_accvgpr_read_b32 v243, a141
    v_cvt_pk_bf16_f32 v67, v242, v243
    buffer_store_dwordx4 v[64:67], v230, s[36:39], s62 offen offset:0 sc1
    ds_write_b128 v228, v[64:67] offset:10240
    v_accvgpr_read_b32 v236, a130
    v_accvgpr_read_b32 v237, a134
    s_waitcnt lgkmcnt(3)
    v_cvt_pk_bf16_f32 v68, v236, v237
    v_accvgpr_read_b32 v238, a138
    v_accvgpr_read_b32 v239, a142
    v_cvt_pk_bf16_f32 v69, v238, v239
    v_accvgpr_read_b32 v240, a131
    v_accvgpr_read_b32 v241, a135
    v_cvt_pk_bf16_f32 v70, v240, v241
    v_accvgpr_read_b32 v242, a139
    v_accvgpr_read_b32 v243, a143
    v_cvt_pk_bf16_f32 v71, v242, v243
    buffer_store_dwordx4 v[68:71], v230, s[36:39], s62 offen offset:1024 sc1
    ds_write_b128 v228, v[68:71] offset:11264
    v_accvgpr_read_b32 v236, a144
    v_accvgpr_read_b32 v237, a148
    s_waitcnt lgkmcnt(3)
    v_cvt_pk_bf16_f32 v244, v236, v237
    v_accvgpr_read_b32 v238, a152
    v_accvgpr_read_b32 v239, a156
    v_cvt_pk_bf16_f32 v245, v238, v239
    v_accvgpr_read_b32 v240, a145
    v_accvgpr_read_b32 v241, a149
    v_cvt_pk_bf16_f32 v246, v240, v241
    v_accvgpr_read_b32 v242, a153
    v_accvgpr_read_b32 v243, a157
    v_cvt_pk_bf16_f32 v247, v242, v243
    buffer_store_dwordx4 v[244:247], v231, s[36:39], s62 offen offset:2048 sc1
    ds_write_b128 v229, v[244:247] offset:6144
    v_accvgpr_read_b32 v236, a146
    v_accvgpr_read_b32 v237, a150
    s_waitcnt lgkmcnt(3)
    v_cvt_pk_bf16_f32 v248, v236, v237
    v_accvgpr_read_b32 v238, a154
    v_accvgpr_read_b32 v239, a158
    v_cvt_pk_bf16_f32 v249, v238, v239
    v_accvgpr_read_b32 v240, a147
    v_accvgpr_read_b32 v241, a151
    v_cvt_pk_bf16_f32 v250, v240, v241
    v_accvgpr_read_b32 v242, a155
    v_accvgpr_read_b32 v243, a159
    v_cvt_pk_bf16_f32 v251, v242, v243
    buffer_store_dwordx4 v[248:251], v231, s[36:39], s62 offen offset:3072 sc1
    ds_write_b128 v229, v[248:251] offset:7168
    v_accvgpr_read_b32 v236, a160
    v_accvgpr_read_b32 v237, a164
    s_waitcnt lgkmcnt(3)
    v_cvt_pk_bf16_f32 v64, v236, v237
    v_accvgpr_read_b32 v238, a168
    v_accvgpr_read_b32 v239, a172
    v_cvt_pk_bf16_f32 v65, v238, v239
    v_accvgpr_read_b32 v240, a161
    v_accvgpr_read_b32 v241, a165
    v_cvt_pk_bf16_f32 v66, v240, v241
    v_accvgpr_read_b32 v242, a169
    v_accvgpr_read_b32 v243, a173
    v_cvt_pk_bf16_f32 v67, v242, v243
    buffer_store_dwordx4 v[64:67], v231, s[36:39], s63 offen offset:0 sc1
    ds_write_b128 v229, v[64:67] offset:8192
    v_accvgpr_read_b32 v236, a162
    v_accvgpr_read_b32 v237, a166
    s_waitcnt lgkmcnt(3)
    v_cvt_pk_bf16_f32 v68, v236, v237
    v_accvgpr_read_b32 v238, a170
    v_accvgpr_read_b32 v239, a174
    v_cvt_pk_bf16_f32 v69, v238, v239
    v_accvgpr_read_b32 v240, a163
    v_accvgpr_read_b32 v241, a167
    v_cvt_pk_bf16_f32 v70, v240, v241
    v_accvgpr_read_b32 v242, a171
    v_accvgpr_read_b32 v243, a175
    v_cvt_pk_bf16_f32 v71, v242, v243
    buffer_store_dwordx4 v[68:71], v231, s[36:39], s63 offen offset:1024 sc1
    ds_write_b128 v229, v[68:71] offset:9216
    v_accvgpr_read_b32 v236, a176
    v_accvgpr_read_b32 v237, a180
    s_waitcnt lgkmcnt(3)
    v_cvt_pk_bf16_f32 v244, v236, v237
    v_accvgpr_read_b32 v238, a184
    v_accvgpr_read_b32 v239, a188
    v_cvt_pk_bf16_f32 v245, v238, v239
    v_accvgpr_read_b32 v240, a177
    v_accvgpr_read_b32 v241, a181
    v_cvt_pk_bf16_f32 v246, v240, v241
    v_accvgpr_read_b32 v242, a185
    v_accvgpr_read_b32 v243, a189
    v_cvt_pk_bf16_f32 v247, v242, v243
    buffer_store_dwordx4 v[244:247], v231, s[36:39], s63 offen offset:2048 sc1
    ds_write_b128 v229, v[244:247] offset:10240
    v_accvgpr_read_b32 v236, a178
    v_accvgpr_read_b32 v237, a182
    s_waitcnt lgkmcnt(3)
    v_cvt_pk_bf16_f32 v248, v236, v237
    v_accvgpr_read_b32 v238, a186
    v_accvgpr_read_b32 v239, a190
    v_cvt_pk_bf16_f32 v249, v238, v239
    v_accvgpr_read_b32 v240, a179
    v_accvgpr_read_b32 v241, a183
    v_cvt_pk_bf16_f32 v250, v240, v241
    v_accvgpr_read_b32 v242, a187
    v_accvgpr_read_b32 v243, a191
    v_cvt_pk_bf16_f32 v251, v242, v243
    buffer_store_dwordx4 v[248:251], v231, s[36:39], s63 offen offset:3072 sc1
    ds_write_b128 v229, v[248:251] offset:11264
    s_add_u32 s20, s16, 0x2000000
    s_addc_u32 s21, s17, 0
    s_mov_b32 s22, 8192
    s_mov_b32 s23, 0x20000
    s_mov_b32 s24, s76
    s_mov_b32 s25, s77
    s_mov_b32 s26, 3145728
    s_mov_b32 s27, 0x20000
    s_mul_i32 s3, s47, 786432
    s_add_u32 s28, s16, s3
    s_addc_u32 s29, s17, 0
    s_mov_b32 s30, 786432
    s_mov_b32 s31, 0x20000
    s_add_u32 s50, s46, 0
    s_and_b32 s50, s50, 7
    s_mul_i32 s50, s50, 98304
    s_add_u32 s51, s46, 1
    s_and_b32 s51, s51, 7
    s_mul_i32 s51, s51, 98304
    s_add_u32 s52, s46, 2
    s_and_b32 s52, s52, 7
    s_mul_i32 s52, s52, 98304
    s_add_u32 s53, s46, 3
    s_and_b32 s53, s53, 7
    s_mul_i32 s53, s53, 98304
    s_add_u32 s54, s46, 4
    s_and_b32 s54, s54, 7
    s_mul_i32 s54, s54, 98304
    s_add_u32 s55, s46, 5
    s_and_b32 s55, s55, 7
    s_mul_i32 s55, s55, 98304
    s_add_u32 s56, s46, 6
    s_and_b32 s56, s56, 7
    s_mul_i32 s56, s56, 98304
    s_add_u32 s57, s46, 7
    s_and_b32 s57, s57, 7
    s_mul_i32 s57, s57, 98304
    s_mov_b32 s67, 0xffff0000
    s_mul_i32 s68, s48, 196608
    s_lshl_b32 s3, s49, 10
    s_add_u32 s68, s68, s3
    s_mul_i32 s13, s46, 3
    s_add_u32 s13, s13, s44
    s_lshl_b32 s12, s47, 8
    v_mov_b32 v226, s6
    v_mov_b32 v227, s7
    s_mov_b32 s22, 16384
    s_lshl_b32 s12, s47, 9
    s_waitcnt lgkmcnt(0)
    v_and_b32 v250, 15, v255
    v_lshrrev_b32 v251, 4, v255
    v_and_b32 v224, 1, v251
    v_lshrrev_b32 v251, 1, v251
    v_lshlrev_b32 v251, 5, v251
    v_lshl_add_u32 v224, v224, 6, v251
    v_lshl_add_u32 v224, v250, 11, v224
    v_and_b32 v234, 7, v255
    v_lshl_add_u32 v234, v234, 3, s12
    v_lshl_add_u32 v235, v255, 3, s12
    v_mov_b32 v236, v226
    s_lshl_b32 s3, s46, 3
    s_add_u32 s3, s3, s12
    v_mov_b32 v225, s3
    s_lshl_b32 s3, s13, 3
    s_add_u32 s11, s3, s12
    v_mov_b32 v236, v234
    s_mov_b32 s14, 0
    s_waitcnt vmcnt(12) lgkmcnt(0)
    s_barrier
    s_cmp_eq_u32 s44, 3
    s_cbranch_scc1 L_t_post
    buffer_load_dwordx2 v[232:233], v236, s[20:23], 0 offen sc1
    s_waitcnt vmcnt(1)
    s_barrier
    s_waitcnt vmcnt(0)
    v_cmp_eq_u32 vcc, v226, v232
    v_cmp_eq_u32 s[70:71], v227, v233
    s_nop 3
    s_and_b64 s[70:71], s[70:71], vcc
    s_cmp_eq_u64 s[70:71], -1
    s_cbranch_scc1 L_t_red
L_t_poll:
    s_mov_b32 s73, 400
L_t_spin:
    buffer_load_dwordx2 v[232:233], v236, s[20:23], 0 offen sc1
    s_waitcnt vmcnt(0)
    v_cmp_eq_u32 vcc, v226, v232
    v_cmp_eq_u32 s[70:71], v227, v233
    s_nop 3
    s_and_b64 s[70:71], s[70:71], vcc
    s_cmp_eq_u64 s[70:71], -1
    s_cbranch_scc1 L_t_red
    s_sleep 1
    s_sub_u32 s73, s73, 1
    s_cmp_lg_u32 s73, 0
    s_cbranch_scc1 L_t_spin
    s_mul_i32 s3, s13, 43
    s_lshr_b32 s70, s3, 8
    s_mul_i32 s3, s70, 6
    s_sub_u32 s71, s13, s3
    s_mul_i32 s74, s70, 24576
    s_mul_i32 s3, s14, 12288
    s_add_u32 s74, s74, s3
    s_lshl_b32 s3, s71, 11
    s_add_u32 s74, s74, s3
    v_add_u32 v250, s74, v254
    s_mul_i32 s3, s14, 3
    s_add_u32 s3, s3, s44
    s_lshl_b32 s3, s3, 11
    s_add_u32 s3, s3, 98304
    v_add_u32 v249, s3, v254
    ds_read_b128 v[72:75], v249 offset:0
    ds_read_b128 v[76:79], v249 offset:1024
    s_waitcnt lgkmcnt(0)
    buffer_store_dwordx4 v[72:75], v250, s[28:31], s50 offen offset:0 sc1
    buffer_store_dwordx4 v[76:79], v250, s[28:31], s50 offen offset:1024 sc1
    s_waitcnt vmcnt(0)
    s_lshl_b32 s3, s14, 8
    s_add_u32 s3, s3, s11
    v_mov_b32 v237, s3
    buffer_store_dwordx2 v[226:227], v237, s[20:23], 0 offen offset:64 sc1
    s_lshl_b32 s3, s14, 8
    v_add_u32 v236, s3, v234
    s_waitcnt vmcnt(0)
    buffer_load_dwordx2 v[232:233], v236, s[20:23], 0 offen sc1
    s_waitcnt vmcnt(0)
    v_cmp_eq_u32 vcc, v226, v232
    v_cmp_eq_u32 s[70:71], v227, v233
    s_nop 3
    s_and_b64 s[70:71], s[70:71], vcc
    s_cmp_eq_u64 s[70:71], -1
    s_cbranch_scc1 L_t_red
    s_cmp_eq_u32 s14, 1
    s_cbranch_scc1 L_k1_fin
    s_mov_b32 s14, 1
    v_add_u32 v236, 256, v234
    s_branch L_t_poll
L_t_post:
    buffer_store_dwordx2 v[226:227], v225, s[20:23], 0 offen sc1
    s_waitcnt vmcnt(1) lgkmcnt(0)
    s_barrier
    buffer_store_dwordx2 v[226:227], v225, s[20:23], 0 offen offset:256 sc1
    s_waitcnt vmcnt(0)
L_t_watch:
    buffer_load_dwordx2 v[232:233], v235, s[20:23], 0 offen sc1
    s_waitcnt vmcnt(0)
    v_cmp_eq_u32 vcc, v226, v232
    v_cmp_eq_u32 s[70:71], v227, v233
    s_nop 3
    s_and_b64 s[70:71], s[70:71], vcc
    s_lshr_b32 s8, s70, 8
    s_and_b32 s70, s70, 0xff
    s_cmp_eq_u32 s70, 0xff
    s_cselect_b32 s8, s8, 0
    s_lshr_b32 s9, s71, 8
    s_and_b32 s71, s71, 0xff
    s_cmp_eq_u32 s71, 0xff
    s_cselect_b32 s9, s9, 0
L_t_next:
    s_cmp_eq_u64 s[8:9], 0
    s_cbranch_scc1 L_k1_fin
    s_ff1_i32_b64 s13, s[8:9]
    s_bitset0_b64 s[8:9], s13
    s_lshr_b32 s14, s13, 5
    s_and_b32 s13, s13, 31
L_t_red:
    s_mul_i32 s3, s13, 43
    s_lshr_b32 s70, s3, 8
    s_mul_i32 s3, s70, 6
    s_sub_u32 s71, s13, s3
    s_mul_i32 s74, s70, 24576
    s_mul_i32 s3, s14, 12288
    s_add_u32 s74, s74, s3
    s_lshl_b32 s3, s71, 11
    s_add_u32 s74, s74, s3
    v_add_u32 v250, s74, v254
    s_cmp_eq_u32 s44, 3
    s_cbranch_scc1 L_t_og
    s_mul_i32 s3, s14, 3
    s_add_u32 s3, s3, s44
    s_lshl_b32 s3, s3, 11
    s_add_u32 s3, s3, 98304
    v_add_u32 v249, s3, v254
    ds_read_b128 v[72:75], v249 offset:0
    ds_read_b128 v[76:79], v249 offset:1024
    s_branch L_t_ox
L_t_og:
    buffer_load_dwordx4 v[72:75], v250, s[28:31], s50 offen offset:0 sc1
    buffer_load_dwordx4 v[76:79], v250, s[28:31], s50 offen offset:1024 sc1
L_t_ox:
    buffer_load_dwordx4 v[80:83], v250, s[28:31], s51 offen offset:0 sc1
    buffer_load_dwordx4 v[84:87], v250, s[28:31], s51 offen offset:1024 sc1
    buffer_load_dwordx4 v[88:91], v250, s[28:31], s52 offen offset:0 sc1
    buffer_load_dwordx4 v[92:95], v250, s[28:31], s52 offen offset:1024 sc1
    buffer_load_dwordx4 v[96:99], v250, s[28:31], s53 offen offset:0 sc1
    buffer_load_dwordx4 v[100:103], v250, s[28:31], s53 offen offset:1024 sc1
    buffer_load_dwordx4 v[104:107], v250, s[28:31], s54 offen offset:0 sc1
    buffer_load_dwordx4 v[108:111], v250, s[28:31], s54 offen offset:1024 sc1
    buffer_load_dwordx4 v[112:115], v250, s[28:31], s55 offen offset:0 sc1
    buffer_load_dwordx4 v[116:119], v250, s[28:31], s55 offen offset:1024 sc1
    buffer_load_dwordx4 v[120:123], v250, s[28:31], s56 offen offset:0 sc1
    buffer_load_dwordx4 v[124:127], v250, s[28:31], s56 offen offset:1024 sc1
    buffer_load_dwordx4 v[128:131], v250, s[28:31], s57 offen offset:0 sc1
    buffer_load_dwordx4 v[132:135], v250, s[28:31], s57 offen offset:1024 sc1
L_t_red2:
    buffer_load_dwordx2 v[232:233], v234, s[20:23], 0 offen offset:256 sc1
    s_lshl_b32 s75, s71, 15
    s_add_u32 s75, s75, s68
    s_lshl_b32 s3, s70, 8
    s_add_u32 s75, s75, s3
    s_lshl_b32 s3, s14, 7
    s_add_u32 s75, s75, s3
    v_add_u32 v251, s75, v224
    s_waitcnt vmcnt(15) lgkmcnt(0)
    v_lshlrev_b32 v200, 16, v72
    v_and_b32 v201, s67, v72
    v_lshlrev_b32 v202, 16, v73
    v_and_b32 v203, s67, v73
    v_lshlrev_b32 v204, 16, v74
    v_and_b32 v205, s67, v74
    v_lshlrev_b32 v206, 16, v75
    v_and_b32 v207, s67, v75
    v_lshlrev_b32 v208, 16, v76
    v_and_b32 v209, s67, v76
    v_lshlrev_b32 v210, 16, v77
    v_and_b32 v211, s67, v77
    v_lshlrev_b32 v212, 16, v78
    v_and_b32 v213, s67, v78
    v_lshlrev_b32 v214, 16, v79
    v_and_b32 v215, s67, v79
    s_waitcnt vmcnt(14)
    v_lshlrev_b32 v228, 16, v80
    v_and_b32 v229, s67, v80
    v_pk_add_f32 v[200:201], v[200:201], v[228:229]
    v_lshlrev_b32 v230, 16, v81
    v_and_b32 v231, s67, v81
    v_pk_add_f32 v[202:203], v[202:203], v[230:231]
    v_lshlrev_b32 v228, 16, v82
    v_and_b32 v229, s67, v82
    v_pk_add_f32 v[204:205], v[204:205], v[228:229]
    v_lshlrev_b32 v230, 16, v83
    v_and_b32 v231, s67, v83
    v_pk_add_f32 v[206:207], v[206:207], v[230:231]
    s_waitcnt vmcnt(13)
    v_lshlrev_b32 v228, 16, v84
    v_and_b32 v229, s67, v84
    v_pk_add_f32 v[208:209], v[208:209], v[228:229]
    v_lshlrev_b32 v230, 16, v85
    v_and_b32 v231, s67, v85
    v_pk_add_f32 v[210:211], v[210:211], v[230:231]
    v_lshlrev_b32 v228, 16, v86
    v_and_b32 v229, s67, v86
    v_pk_add_f32 v[212:213], v[212:213], v[228:229]
    v_lshlrev_b32 v230, 16, v87
    v_and_b32 v231, s67, v87
    v_pk_add_f32 v[214:215], v[214:215], v[230:231]
    s_waitcnt vmcnt(12)
    v_lshlrev_b32 v228, 16, v88
    v_and_b32 v229, s67, v88
    v_pk_add_f32 v[200:201], v[200:201], v[228:229]
    v_lshlrev_b32 v230, 16, v89
    v_and_b32 v231, s67, v89
    v_pk_add_f32 v[202:203], v[202:203], v[230:231]
    v_lshlrev_b32 v228, 16, v90
    v_and_b32 v229, s67, v90
    v_pk_add_f32 v[204:205], v[204:205], v[228:229]
    v_lshlrev_b32 v230, 16, v91
    v_and_b32 v231, s67, v91
    v_pk_add_f32 v[206:207], v[206:207], v[230:231]
    s_waitcnt vmcnt(11)
    v_lshlrev_b32 v228, 16, v92
    v_and_b32 v229, s67, v92
    v_pk_add_f32 v[208:209], v[208:209], v[228:229]
    v_lshlrev_b32 v230, 16, v93
    v_and_b32 v231, s67, v93
    v_pk_add_f32 v[210:211], v[210:211], v[230:231]
    v_lshlrev_b32 v228, 16, v94
    v_and_b32 v229, s67, v94
    v_pk_add_f32 v[212:213], v[212:213], v[228:229]
    v_lshlrev_b32 v230, 16, v95
    v_and_b32 v231, s67, v95
    v_pk_add_f32 v[214:215], v[214:215], v[230:231]
    s_waitcnt vmcnt(10)
    v_lshlrev_b32 v228, 16, v96
    v_and_b32 v229, s67, v96
    v_pk_add_f32 v[200:201], v[200:201], v[228:229]
    v_lshlrev_b32 v230, 16, v97
    v_and_b32 v231, s67, v97
    v_pk_add_f32 v[202:203], v[202:203], v[230:231]
    v_lshlrev_b32 v228, 16, v98
    v_and_b32 v229, s67, v98
    v_pk_add_f32 v[204:205], v[204:205], v[228:229]
    v_lshlrev_b32 v230, 16, v99
    v_and_b32 v231, s67, v99
    v_pk_add_f32 v[206:207], v[206:207], v[230:231]
    s_waitcnt vmcnt(9)
    v_lshlrev_b32 v228, 16, v100
    v_and_b32 v229, s67, v100
    v_pk_add_f32 v[208:209], v[208:209], v[228:229]
    v_lshlrev_b32 v230, 16, v101
    v_and_b32 v231, s67, v101
    v_pk_add_f32 v[210:211], v[210:211], v[230:231]
    v_lshlrev_b32 v228, 16, v102
    v_and_b32 v229, s67, v102
    v_pk_add_f32 v[212:213], v[212:213], v[228:229]
    v_lshlrev_b32 v230, 16, v103
    v_and_b32 v231, s67, v103
    v_pk_add_f32 v[214:215], v[214:215], v[230:231]
    s_waitcnt vmcnt(8)
    v_lshlrev_b32 v228, 16, v104
    v_and_b32 v229, s67, v104
    v_pk_add_f32 v[200:201], v[200:201], v[228:229]
    v_lshlrev_b32 v230, 16, v105
    v_and_b32 v231, s67, v105
    v_pk_add_f32 v[202:203], v[202:203], v[230:231]
    v_lshlrev_b32 v228, 16, v106
    v_and_b32 v229, s67, v106
    v_pk_add_f32 v[204:205], v[204:205], v[228:229]
    v_lshlrev_b32 v230, 16, v107
    v_and_b32 v231, s67, v107
    v_pk_add_f32 v[206:207], v[206:207], v[230:231]
    s_waitcnt vmcnt(7)
    v_lshlrev_b32 v228, 16, v108
    v_and_b32 v229, s67, v108
    v_pk_add_f32 v[208:209], v[208:209], v[228:229]
    v_lshlrev_b32 v230, 16, v109
    v_and_b32 v231, s67, v109
    v_pk_add_f32 v[210:211], v[210:211], v[230:231]
    v_lshlrev_b32 v228, 16, v110
    v_and_b32 v229, s67, v110
    v_pk_add_f32 v[212:213], v[212:213], v[228:229]
    v_lshlrev_b32 v230, 16, v111
    v_and_b32 v231, s67, v111
    v_pk_add_f32 v[214:215], v[214:215], v[230:231]
    s_waitcnt vmcnt(6)
    v_lshlrev_b32 v228, 16, v112
    v_and_b32 v229, s67, v112
    v_pk_add_f32 v[200:201], v[200:201], v[228:229]
    v_lshlrev_b32 v230, 16, v113
    v_and_b32 v231, s67, v113
    v_pk_add_f32 v[202:203], v[202:203], v[230:231]
    v_lshlrev_b32 v228, 16, v114
    v_and_b32 v229, s67, v114
    v_pk_add_f32 v[204:205], v[204:205], v[228:229]
    v_lshlrev_b32 v230, 16, v115
    v_and_b32 v231, s67, v115
    v_pk_add_f32 v[206:207], v[206:207], v[230:231]
    s_waitcnt vmcnt(5)
    v_lshlrev_b32 v228, 16, v116
    v_and_b32 v229, s67, v116
    v_pk_add_f32 v[208:209], v[208:209], v[228:229]
    v_lshlrev_b32 v230, 16, v117
    v_and_b32 v231, s67, v117
    v_pk_add_f32 v[210:211], v[210:211], v[230:231]
    v_lshlrev_b32 v228, 16, v118
    v_and_b32 v229, s67, v118
    v_pk_add_f32 v[212:213], v[212:213], v[228:229]
    v_lshlrev_b32 v230, 16, v119
    v_and_b32 v231, s67, v119
    v_pk_add_f32 v[214:215], v[214:215], v[230:231]
    s_waitcnt vmcnt(4)
    v_lshlrev_b32 v228, 16, v120
    v_and_b32 v229, s67, v120
    v_pk_add_f32 v[200:201], v[200:201], v[228:229]
    v_lshlrev_b32 v230, 16, v121
    v_and_b32 v231, s67, v121
    v_pk_add_f32 v[202:203], v[202:203], v[230:231]
    v_lshlrev_b32 v228, 16, v122
    v_and_b32 v229, s67, v122
    v_pk_add_f32 v[204:205], v[204:205], v[228:229]
    v_lshlrev_b32 v230, 16, v123
    v_and_b32 v231, s67, v123
    v_pk_add_f32 v[206:207], v[206:207], v[230:231]
    s_waitcnt vmcnt(3)
    v_lshlrev_b32 v228, 16, v124
    v_and_b32 v229, s67, v124
    v_pk_add_f32 v[208:209], v[208:209], v[228:229]
    v_lshlrev_b32 v230, 16, v125
    v_and_b32 v231, s67, v125
    v_pk_add_f32 v[210:211], v[210:211], v[230:231]
    v_lshlrev_b32 v228, 16, v126
    v_and_b32 v229, s67, v126
    v_pk_add_f32 v[212:213], v[212:213], v[228:229]
    v_lshlrev_b32 v230, 16, v127
    v_and_b32 v231, s67, v127
    v_pk_add_f32 v[214:215], v[214:215], v[230:231]
    s_waitcnt vmcnt(2)
    v_lshlrev_b32 v228, 16, v128
    v_and_b32 v229, s67, v128
    v_pk_add_f32 v[200:201], v[200:201], v[228:229]
    v_lshlrev_b32 v230, 16, v129
    v_and_b32 v231, s67, v129
    v_pk_add_f32 v[202:203], v[202:203], v[230:231]
    v_lshlrev_b32 v228, 16, v130
    v_and_b32 v229, s67, v130
    v_pk_add_f32 v[204:205], v[204:205], v[228:229]
    v_lshlrev_b32 v230, 16, v131
    v_and_b32 v231, s67, v131
    v_pk_add_f32 v[206:207], v[206:207], v[230:231]
    s_waitcnt vmcnt(1)
    v_lshlrev_b32 v228, 16, v132
    v_and_b32 v229, s67, v132
    v_pk_add_f32 v[208:209], v[208:209], v[228:229]
    v_lshlrev_b32 v230, 16, v133
    v_and_b32 v231, s67, v133
    v_pk_add_f32 v[210:211], v[210:211], v[230:231]
    v_lshlrev_b32 v228, 16, v134
    v_and_b32 v229, s67, v134
    v_pk_add_f32 v[212:213], v[212:213], v[228:229]
    v_lshlrev_b32 v230, 16, v135
    v_and_b32 v231, s67, v135
    v_pk_add_f32 v[214:215], v[214:215], v[230:231]
    v_cvt_pk_bf16_f32 v216, v200, v201
    v_cvt_pk_bf16_f32 v217, v202, v203
    v_cvt_pk_bf16_f32 v220, v204, v205
    v_cvt_pk_bf16_f32 v221, v206, v207
    v_cvt_pk_bf16_f32 v218, v208, v209
    v_cvt_pk_bf16_f32 v219, v210, v211
    v_cvt_pk_bf16_f32 v222, v212, v213
    v_cvt_pk_bf16_f32 v223, v214, v215
    s_nop 1
    v_permlane32_swap_b32 v216, v218
    v_permlane32_swap_b32 v217, v219
    v_permlane32_swap_b32 v220, v222
    v_permlane32_swap_b32 v221, v223
    s_nop 1
    buffer_store_dwordx4 v[216:219], v251, s[24:27], 0 offen offset:0
    buffer_store_dwordx4 v[220:223], v251, s[24:27], 0 offen offset:16
    s_cmp_eq_u32 s44, 3
    s_cbranch_scc1 L_t_next
    s_cmp_eq_u32 s14, 1
    s_cbranch_scc1 L_k1_fin
    s_mov_b32 s14, 1
    v_add_u32 v236, 256, v234
    s_waitcnt vmcnt(2)
    v_cmp_eq_u32 vcc, v226, v232
    v_cmp_eq_u32 s[70:71], v227, v233
    s_nop 3
    s_and_b64 s[70:71], s[70:71], vcc
    s_cmp_eq_u64 s[70:71], -1
    s_cbranch_scc1 L_t_red
    s_branch L_t_poll
L_k1_fin:
L_k1_end:
    s_endpgm
L_tkf:
    s_mov_b64 s[12:13], s[4:5]
    s_atomic_cmpswap_x2 s[4:7], s[78:79], 0 glc
    s_waitcnt lgkmcnt(0)
    s_or_b32 s3, s4, s5
    s_cselect_b64 s[12:13], s[4:5], s[12:13]
    s_branch L_tkb
L_k1_code_end:
.section .rodata,"a"
.p2align 6
.amdhsa_kernel concat_heads__gqa_block_cached__gqa_block_cached__near_ridge_kernel
  .amdhsa_next_free_vgpr 512
  .amdhsa_next_free_sgpr 102
  .amdhsa_accum_offset 256
  .amdhsa_group_segment_fixed_size 0
  .amdhsa_kernarg_size 104
  .amdhsa_user_sgpr_count 2
  .amdhsa_user_sgpr_kernarg_segment_ptr 1
  .amdhsa_system_sgpr_workgroup_id_x 1
.end_amdhsa_kernel
```
